```python
import torch

def _softmax(x, axis=-1):
    return torch.softmax(x, dim=axis)
def _gelu(x):
    return torch.nn.functional.gelu(x, approximate="tanh")
def _silu(x):
    return torch.nn.functional.silu(x)
def _sigmoid(x):
    return torch.sigmoid(x)
def _layernorm(x, axis=-1, eps=1e-5):
    m = x.mean(dim=axis, keepdim=True)
    v = x.var(dim=axis, keepdim=True, unbiased=False)
    return (x - m) / torch.sqrt(v + eps)
def _scatter_add(tgt, idx, src, axis=0):
    return tgt.clone().index_add_(axis, idx, src)
def _segment_sum(src, seg, n):
    out = torch.zeros((n,) + src.shape[1:], dtype=src.dtype)
    return out.index_add_(0, seg, src)
def _pad(x, pw):
    flat = tuple(v for pair in reversed(pw) for v in pair)
    return torch.nn.functional.pad(x, flat)

kernel_name = 'interleave_layers__ssm_conv_h3__geglu_ffn__prompt'

def setup_inputs():

    _w = (lambda a: (lambda t: t.to(torch.bfloat16) if t.is_floating_point() else t)(torch.as_tensor(a)))
    def _A_setup():
        B, S, D = 1, 2048, 1024
        ks = 4
        return {
            "q": _w((lambda *s: torch.randn(*s, dtype=torch.bfloat16) * 0.05)(B, S, D)),
            "k": _w((lambda *s: torch.randn(*s, dtype=torch.bfloat16) * 0.8)(B, S, D)),
            "v": _w((lambda *s: torch.randn(*s, dtype=torch.bfloat16) * 0.8)(B, S, D)),
            "shift_k": _w((lambda *s: torch.randn(*s, dtype=torch.bfloat16) * 0.8)(D, ks) * 0.5),
            "ssm_k": _w((lambda *s: torch.randn(*s, dtype=torch.bfloat16) * 0.8)(D, S) * (1.0 / S ** 0.5)),
            "ssm_D": _w((lambda *s: torch.randn(*s, dtype=torch.bfloat16) * 0.8)(D)),
        }
    _A_in = _A_setup()

    def _B_setup():
        B, S, D, F = 1, 2048, 1024, 3584
        return {
            "x": _w((lambda *s: torch.randn(*s, dtype=torch.bfloat16) * 0.05)(B, S, D)),
            "w_gate": _w((lambda *s: torch.randn(*s, dtype=torch.bfloat16) * 0.05)(D, F)),
            "w_up": _w((lambda *s: torch.randn(*s, dtype=torch.bfloat16) * 0.05)(D, F)),
            "w_down": _w((lambda *s: torch.randn(*s, dtype=torch.bfloat16) * 0.05)(F, D)),
        }
    _B_in = _B_setup()

    return {
        "A_q": _A_in["q"],
        "A_k": _A_in["k"],
        "A_v": _A_in["v"],
        "A_shift_k": _A_in["shift_k"],
        "A_ssm_k": _A_in["ssm_k"],
        "A_ssm_D": _A_in["ssm_D"],
        "B_x": _B_in["x"],
        "B_w_gate": _B_in["w_gate"],
        "B_w_up": _B_in["w_up"],
        "B_w_down": _B_in["w_down"],
    }

def reference(A_q, A_k, A_v, A_shift_k, A_ssm_k, A_ssm_D, B_x, B_w_gate, B_w_up, B_w_down):
    def _A_ref(q, k, v, shift_k, ssm_k, ssm_D):
        B, S, D = q.shape
        ks = shift_k.shape[-1]
        k_pad = _pad(k, ((0, 0), (ks - 1, 0), (0, 0)))
        k_shift = torch.zeros_like(k)
        for t in range(ks):
            k_shift = k_shift + k_pad[:, t:t + S, :] * shift_k[:, ks - 1 - t][None, None, :]
        kv = k_shift * v
        L = 2 * S
        kv_pad = _pad(kv, ((0, 0), (0, S), (0, 0)))
        kf_pad = _pad(ssm_k, ((0, 0), (0, S)))
        kv_f = (lambda x, axes=(-2,-1): torch.fft.rfft2(x.float(), dim=axes))(kv_pad[:, None, :, :], axes=(1, 2))
        kf_f = (lambda x, axes=(-2,-1): torch.fft.rfft2(x.float(), dim=axes))(kf_pad[:, None, :], axes=(1, 2))
        kf_f = (lambda x, *d: x.permute(*d))(kf_f, 1, 2, 0)
        y_f = kv_f * kf_f[None, :, :, :]
        y = (lambda x, s, axes=(-2,-1): torch.fft.irfft2(x, s=s, dim=axes).to(torch.bfloat16))(y_f, (1, L), axes=(1, 2))[:, 0, :S, :]
        y = y + kv * ssm_D[None, None, :]
        return q * y

    def _B_ref(x, w_gate, w_up, w_down):
        return (_gelu(x @ w_gate) * (x @ w_up)) @ w_down

    x = A_q
    x = x + _A_ref(_layernorm(x, axis=-1), A_k, A_v, A_shift_k, A_ssm_k, A_ssm_D)
    x = x + _B_ref(_layernorm(x, axis=-1), B_w_gate, B_w_up, B_w_down)
    x = x + _A_ref(_layernorm(x, axis=-1), A_k, A_v, A_shift_k, A_ssm_k, A_ssm_D)
    x = x + _B_ref(_layernorm(x, axis=-1), B_w_gate, B_w_up, B_w_down)
    return x
```

```asm
; @launch grid=(256,1,1) block=(256,1,1) lds=155648
.amdgcn_target "amdgcn-amd-amdhsa--gfx950"
.text
.globl interleave_layers__ssm_conv_h3__geglu_ffn__prompt_kernel
.p2align 8
.type interleave_layers__ssm_conv_h3__geglu_ffn__prompt_kernel,@function
interleave_layers__ssm_conv_h3__geglu_ffn__prompt_kernel:
s_cmp_ge_u32 s2, 256
s_cbranch_scc1 interleave_layers__ssm_conv_h3__geglu_ffn__prompt_kernel_end
s_load_dwordx2 s[80:81], s[0:1], 0
s_load_dwordx2 s[24:25], s[0:1], 96
s_load_dwordx4 s[4:7], s[0:1], 56
s_load_dwordx2 s[52:53], s[0:1], 72
s_load_dwordx2 s[82:83], s[0:1], 80
s_load_dwordx8 s[8:15], s[0:1], 8
s_load_dwordx2 s[16:17], s[0:1], 40
s_load_dwordx2 s[72:73], s[0:1], 88
v_lshrrev_b32 v1, 6, v0
s_mov_b32 s60, 1
s_mov_b32 s84, 0
v_readfirstlane_b32 s26, v1
v_and_b32 v31, 63, v0
v_lshrrev_b32 v19, 3, v0
v_and_b32 v20, 7, v0
v_lshlrev_b32 v3, 4, v31
s_and_b32 s27, s2, 15
s_lshr_b32 s28, s2, 4
s_lshl_b32 s29, s28, 18
s_lshl_b32 s30, s27, 7
s_add_u32 s29, s29, s30
v_lshlrev_b32 v248, 13, v19
v_lshl_add_u32 v248, v20, 4, v248
v_add_u32 v248, s29, v248
v_subrev_u32 v249, 6144, v248
v_subrev_u32 v250, 2048, v248
v_add_u32 v251, 4096, v248
v_lshlrev_b32 v252, 6, v20
s_lshl_b32 s31, s27, 9
v_sub_u32 v21, 31, v19
v_lshrrev_b32 v26, 1, v21
v_xor_b32 v26, v26, v20
v_and_b32 v21, 1, v21
v_lshlrev_b32 v21, 3, v21
v_lshl_add_u32 v253, v26, 4, v21
v_lshl_add_u32 v253, v20, 11, v253
v_add_u32 v253, 137728, v253
s_waitcnt lgkmcnt(0)
s_mov_b32 s86, s24
s_mov_b32 s87, s25
s_add_u32 s88, s24, 117440512
s_addc_u32 s89, s25, 0
s_mov_b32 s90, 2801664
s_mov_b32 s91, 0x20000
s_mov_b32 s74, 256
s_mov_b32 s75, 0x20000
s_mul_i32 s97, s2, 10368
s_add_u32 s97, s97, 147456
s_mov_b32 s85, 0
s_lshl_b32 s33, s26, 8
s_add_u32 s33, s33, s2
s_cmp_ge_u32 s33, 64
s_cbranch_scc1 interleave_layers__ssm_conv_h3__geglu_ffn__prompt_kernel_nz
v_mov_b32 v20, 0
v_mov_b32 v21, 0
s_mul_i32 s34, s2, 41472
s_add_u32 s34, s34, 147456
v_lshrrev_b32 v26, 2, v31
v_mul_u32_u24 v26, 10368, v26
v_and_b32 v27, 3, v31
v_lshl_add_u32 v26, v27, 7, v26
v_add_u32 v26, s34, v26
s_and_b32 s34, s2, 15
s_lshl_b32 s34, s34, 7
s_add_u32 s34, s34, 57344
v_writelane_b32 v26, s34, 16
s_mov_b64 exec, 0x1ffff
buffer_store_dwordx2 v[20:21], v26, s[88:91], 0 offen sc1
s_mov_b64 exec, -1
interleave_layers__ssm_conv_h3__geglu_ffn__prompt_kernel_nz:
s_mov_b32 s32, s8
s_mov_b32 s33, s9
s_mov_b32 s34, 4194304
s_mov_b32 s35, 0x20000
s_mov_b32 s36, s10
s_mov_b32 s37, s11
s_mov_b32 s38, 4194304
s_mov_b32 s39, 0x20000
s_mov_b32 s40, s12
s_mov_b32 s41, s13
s_mov_b32 s42, 8192
s_mov_b32 s43, 0x20000
buffer_load_dwordx4 v[172:175], v252, s[40:43], s31 offen offset:0
buffer_load_dwordx4 v[176:179], v252, s[40:43], s31 offen offset:16
buffer_load_dwordx4 v[180:183], v252, s[40:43], s31 offen offset:32
buffer_load_dwordx4 v[184:187], v252, s[40:43], s31 offen offset:48
buffer_load_dwordx4 v[140:143], v248, s[32:35], 0 offen offset:0 nt
buffer_load_dwordx4 v[144:147], v248, s[32:35], 0 offen offset:2048 nt
buffer_load_dwordx4 v[148:151], v251, s[32:35], 0 offen offset:0 nt
buffer_load_dwordx4 v[152:155], v251, s[32:35], 0 offen offset:2048 nt
buffer_load_dwordx4 v[156:159], v248, s[36:39], 0 offen offset:0 nt
buffer_load_dwordx4 v[160:163], v248, s[36:39], 0 offen offset:2048 nt
buffer_load_dwordx4 v[164:167], v251, s[36:39], 0 offen offset:0 nt
buffer_load_dwordx4 v[168:171], v251, s[36:39], 0 offen offset:2048 nt
buffer_load_dwordx4 v[128:131], v249, s[32:35], 0 offen offset:0 nt
buffer_load_dwordx4 v[132:135], v249, s[32:35], 0 offen offset:2048 nt
buffer_load_dwordx4 v[136:139], v250, s[32:35], 0 offen offset:0 nt
s_cmp_lg_u32 s26, 1
s_cbranch_scc1 interleave_layers__ssm_conv_h3__geglu_ffn__prompt_kernel_nzm
v_mov_b32 v27, 0
v_lshlrev_b32 v26, 7, v31
s_mov_b32 exec_lo, 0xfffff000
s_mov_b32 exec_hi, 0x100ffff0
buffer_store_dword v27, v26, s[88:91], s97 offen sc1
s_mov_b64 exec, -1
interleave_layers__ssm_conv_h3__geglu_ffn__prompt_kernel_nzm:
s_add_u32 s56, s24, 111149056
s_addc_u32 s57, s25, 0
s_mov_b32 s58, 4456448
s_mov_b32 s59, 0x20000
s_lshl_b32 s70, s27, 2
s_add_u32 s70, s70, s26
s_mul_i32 s70, s70, 69632
s_lshl_b32 s34, s28, 8
s_sub_u32 s34, 3840, s34
s_add_u32 s70, s70, s34
s_lshr_b32 s101, s28, 3
s_lshl_b32 s101, s101, 7
s_and_b32 s99, s28, 7
s_add_u32 s99, s99, s101
s_mul_i32 s98, s27, 165888
s_add_u32 s98, s98, s99
s_add_u32 s98, s98, 147456
s_lshl_b32 s27, s2, 2
s_add_u32 s27, s27, s26
s_lshl_b32 s28, s27, 12
s_add_u32 s32, s14, s28
s_addc_u32 s33, s15, 0
s_mov_b32 s34, 4096
s_mov_b32 s35, 0x20000
s_mov_b32 s48, s32
s_mov_b32 s49, s33
s_mov_b32 s50, 4096
s_mov_b32 s51, 0x20000
s_getpc_b64 s[36:37]
interleave_layers__ssm_conv_h3__geglu_ffn__prompt_kernel_pc0:
s_sub_u32 s36, s36, interleave_layers__ssm_conv_h3__geglu_ffn__prompt_kernel_pc0-interleave_layers__ssm_conv_h3__geglu_ffn__prompt_kernel
s_subb_u32 s37, s37, 0
s_mov_b32 s38, interleave_layers__ssm_conv_h3__geglu_ffn__prompt_kernel_codeend-interleave_layers__ssm_conv_h3__geglu_ffn__prompt_kernel
s_mov_b32 s39, 0x20000
s_lshr_b32 s29, s2, 3
s_lshl_b32 s29, s29, 2
s_add_u32 s29, s29, s26
s_lshl_b32 s29, s29, 9
v_lshlrev_b32 v26, 7, v31
s_mov_b64 exec, 15
buffer_load_dword a255, v26, s[36:39], s29 offen
s_mov_b64 exec, -1
v_lshrrev_b32 v19, 4, v31
v_and_b32 v20, 15, v31
s_lshl_b32 s29, s26, 1
v_xor_b32 v21, s29, v20
v_lshlrev_b32 v21, 4, v21
v_lshl_add_u32 v21, v19, 8, v21
s_lshl_b32 s29, s26, 12
s_add_u32 s29, s29, 137728
v_add_u32 v254, s29, v21
v_xor_b32 v255, 16, v254
v_mul_u32_u24 v19, 4352, v19
v_lshl_add_u32 v248, v20, 4, v19
s_mul_i32 s28, s27, 4352
s_add_u32 s28, s28, 111149056
s_add_u32 s40, s24, s28
s_addc_u32 s41, s25, 0
s_mov_b32 s42, 4096
s_mov_b32 s43, 0x20000
s_mul_i32 s29, s26, 4608
s_add_u32 s29, s29, 86016
s_mov_b32 s71, s29
s_mul_i32 s30, s26, 8320
s_add_u32 s30, s30, 104448
s_lshl_b32 s28, s2, 3
s_add_u32 s16, s16, s28
s_addc_u32 s17, s17, 0
s_load_dwordx2 s[44:45], s[16:17], 0
v_and_b32 v16, 15, v31
v_lshrrev_b32 v17, 4, v31
v_lshlrev_b32 v100, 4, v17
v_lshlrev_b32 v18, 5, v16
v_sub_u32 v100, v100, v18
v_add_u32 v100, 480, v100
v_add_u32 v100, s29, v100
v_add_u32 v101, s30, v3
v_and_b32 v18, 1, v16
v_mul_u32_u24 v18, 4162, v18
v_lshl_add_u32 v18, v16, 1, v18
v_lshl_add_u32 v18, v17, 4, v18
v_add_u32 v102, s30, v18
v_add_u32 v103, 1024, v102
v_add_u32 v104, 2048, v102
v_add_u32 v105, 3072, v102
v_mov_b32 v110, 0
v_mov_b32 v111, 0
v_lshlrev_b32 v18, 3, v31
v_add_u32 v19, s29, v18
ds_write_b64 v19, v[110:111] offset:4096
v_add_u32 v19, s30, v18
s_mov_b64 exec, 15
ds_write_b64 v19, v[110:111]
ds_write_b64 v19, v[110:111] offset:4160
s_mov_b64 exec, -1
s_lshl_b32 s28, s26, 12
s_add_u32 s28, s28, 137728
v_lshlrev_b32 v107, 5, v16
v_lshl_add_u32 v107, v17, 3, v107
v_add_u32 v107, s28, v107
s_lshl_b32 s28, s26, 8
s_add_u32 s28, s28, 137728
v_lshl_add_u32 v108, v31, 2, s28
s_lshl_b32 s28, s26, 10
v_add_u32 v109, s28, v3
v_lshlrev_b32 v18, 3, v17
v_add_u32 v18, v18, v16
v_sub_u32 v110, 15, v18
s_lshl_b32 s34, s26, 8
s_add_u32 s34, s34, s2
s_cmp_ge_u32 s34, 64
s_cbranch_scc1 interleave_layers__ssm_conv_h3__geglu_ffn__prompt_kernel_nz3
s_waitcnt vmcnt(16)
s_and_b32 s34, s2, 1
s_lshl_b32 s34, s34, 7
v_mov_b32 v26, 0
v_mov_b32 v27, 1
s_mov_b64 exec, 1
buffer_atomic_add v27, v26, s[72:75], s34 offen sc1
s_mov_b64 exec, -1
interleave_layers__ssm_conv_h3__geglu_ffn__prompt_kernel_nz3:
s_waitcnt vmcnt(12)
v_lshlrev_b32 v188, 16, v172
v_and_b32 v196, 0xffff0000, v172
v_lshlrev_b32 v204, 16, v173
v_and_b32 v212, 0xffff0000, v173
v_lshlrev_b32 v189, 16, v174
v_and_b32 v197, 0xffff0000, v174
v_lshlrev_b32 v205, 16, v175
v_and_b32 v213, 0xffff0000, v175
v_lshlrev_b32 v190, 16, v176
v_and_b32 v198, 0xffff0000, v176
v_lshlrev_b32 v206, 16, v177
v_and_b32 v214, 0xffff0000, v177
v_lshlrev_b32 v191, 16, v178
v_and_b32 v199, 0xffff0000, v178
v_lshlrev_b32 v207, 16, v179
v_and_b32 v215, 0xffff0000, v179
v_lshlrev_b32 v192, 16, v180
v_and_b32 v200, 0xffff0000, v180
v_lshlrev_b32 v208, 16, v181
v_and_b32 v216, 0xffff0000, v181
v_lshlrev_b32 v193, 16, v182
v_and_b32 v201, 0xffff0000, v182
v_lshlrev_b32 v209, 16, v183
v_and_b32 v217, 0xffff0000, v183
v_lshlrev_b32 v194, 16, v184
v_and_b32 v202, 0xffff0000, v184
v_lshlrev_b32 v210, 16, v185
v_and_b32 v218, 0xffff0000, v185
v_lshlrev_b32 v195, 16, v186
v_and_b32 v203, 0xffff0000, v186
v_lshlrev_b32 v211, 16, v187
v_and_b32 v219, 0xffff0000, v187
buffer_load_dwordx4 v[64:67], v3, s[48:51], 0 offen offset:0 nt
buffer_load_dwordx4 v[68:71], v3, s[48:51], 0 offen offset:1024 nt
buffer_load_dwordx4 v[72:75], v3, s[48:51], 0 offen offset:2048 nt
buffer_load_dwordx4 v[76:79], v3, s[48:51], 0 offen offset:3072 nt
s_waitcnt vmcnt(5)
v_lshlrev_b32 v220, 16, v128
v_and_b32 v221, 0xffff0000, v128
v_lshlrev_b32 v222, 16, v129
v_and_b32 v223, 0xffff0000, v129
v_lshlrev_b32 v224, 16, v132
v_and_b32 v225, 0xffff0000, v132
v_lshlrev_b32 v226, 16, v133
v_and_b32 v227, 0xffff0000, v133
v_lshlrev_b32 v228, 16, v136
v_and_b32 v229, 0xffff0000, v136
v_lshlrev_b32 v230, 16, v137
v_and_b32 v231, 0xffff0000, v137
v_lshlrev_b32 v232, 16, v140
v_and_b32 v233, 0xffff0000, v140
v_lshlrev_b32 v234, 16, v141
v_and_b32 v235, 0xffff0000, v141
v_lshlrev_b32 v236, 16, v144
v_and_b32 v237, 0xffff0000, v144
v_lshlrev_b32 v238, 16, v145
v_and_b32 v239, 0xffff0000, v145
v_lshlrev_b32 v240, 16, v148
v_and_b32 v241, 0xffff0000, v148
v_lshlrev_b32 v242, 16, v149
v_and_b32 v243, 0xffff0000, v149
v_lshlrev_b32 v244, 16, v152
v_and_b32 v245, 0xffff0000, v152
v_lshlrev_b32 v246, 16, v153
v_and_b32 v247, 0xffff0000, v153
v_pk_mul_f32 v[32:33], v[232:233], v[188:189]
v_pk_fma_f32 v[32:33], v[228:229], v[196:197], v[32:33]
v_pk_fma_f32 v[32:33], v[224:225], v[204:205], v[32:33]
v_pk_fma_f32 v[32:33], v[220:221], v[212:213], v[32:33]
v_lshlrev_b32 v26, 16, v156
v_and_b32 v27, 0xffff0000, v156
v_pk_mul_f32 v[32:33], v[32:33], v[26:27]
v_pk_mul_f32 v[34:35], v[234:235], v[190:191]
v_pk_fma_f32 v[34:35], v[230:231], v[198:199], v[34:35]
v_pk_fma_f32 v[34:35], v[226:227], v[206:207], v[34:35]
v_pk_fma_f32 v[34:35], v[222:223], v[214:215], v[34:35]
v_lshlrev_b32 v26, 16, v157
v_and_b32 v27, 0xffff0000, v157
v_pk_mul_f32 v[34:35], v[34:35], v[26:27]
v_pk_mul_f32 v[40:41], v[236:237], v[188:189]
v_pk_fma_f32 v[40:41], v[232:233], v[196:197], v[40:41]
v_pk_fma_f32 v[40:41], v[228:229], v[204:205], v[40:41]
v_pk_fma_f32 v[40:41], v[224:225], v[212:213], v[40:41]
v_lshlrev_b32 v26, 16, v160
v_and_b32 v27, 0xffff0000, v160
v_pk_mul_f32 v[40:41], v[40:41], v[26:27]
v_pk_mul_f32 v[42:43], v[238:239], v[190:191]
v_pk_fma_f32 v[42:43], v[234:235], v[198:199], v[42:43]
v_pk_fma_f32 v[42:43], v[230:231], v[206:207], v[42:43]
v_pk_fma_f32 v[42:43], v[226:227], v[214:215], v[42:43]
v_lshlrev_b32 v26, 16, v161
v_and_b32 v27, 0xffff0000, v161
v_pk_mul_f32 v[42:43], v[42:43], v[26:27]
v_pk_mul_f32 v[48:49], v[240:241], v[188:189]
v_pk_fma_f32 v[48:49], v[236:237], v[196:197], v[48:49]
v_pk_fma_f32 v[48:49], v[232:233], v[204:205], v[48:49]
v_pk_fma_f32 v[48:49], v[228:229], v[212:213], v[48:49]
v_lshlrev_b32 v26, 16, v164
v_and_b32 v27, 0xffff0000, v164
v_pk_mul_f32 v[48:49], v[48:49], v[26:27]
v_pk_mul_f32 v[50:51], v[242:243], v[190:191]
v_pk_fma_f32 v[50:51], v[238:239], v[198:199], v[50:51]
v_pk_fma_f32 v[50:51], v[234:235], v[206:207], v[50:51]
v_pk_fma_f32 v[50:51], v[230:231], v[214:215], v[50:51]
v_lshlrev_b32 v26, 16, v165
v_and_b32 v27, 0xffff0000, v165
v_pk_mul_f32 v[50:51], v[50:51], v[26:27]
v_pk_mul_f32 v[56:57], v[244:245], v[188:189]
v_pk_fma_f32 v[56:57], v[240:241], v[196:197], v[56:57]
v_pk_fma_f32 v[56:57], v[236:237], v[204:205], v[56:57]
v_pk_fma_f32 v[56:57], v[232:233], v[212:213], v[56:57]
v_lshlrev_b32 v26, 16, v168
v_and_b32 v27, 0xffff0000, v168
v_pk_mul_f32 v[56:57], v[56:57], v[26:27]
v_pk_mul_f32 v[58:59], v[246:247], v[190:191]
v_pk_fma_f32 v[58:59], v[242:243], v[198:199], v[58:59]
v_pk_fma_f32 v[58:59], v[238:239], v[206:207], v[58:59]
v_pk_fma_f32 v[58:59], v[234:235], v[214:215], v[58:59]
v_lshlrev_b32 v26, 16, v169
v_and_b32 v27, 0xffff0000, v169
v_pk_mul_f32 v[58:59], v[58:59], v[26:27]
v_cvt_pk_bf16_f32 v112, v56, v48
v_cvt_pk_bf16_f32 v113, v40, v32
ds_write_b64 v253, v[112:113] offset:0
v_cvt_pk_bf16_f32 v114, v57, v49
v_cvt_pk_bf16_f32 v115, v41, v33
ds_write_b64 v253, v[114:115] offset:256
v_cvt_pk_bf16_f32 v116, v58, v50
v_cvt_pk_bf16_f32 v117, v42, v34
ds_write_b64 v253, v[116:117] offset:512
v_cvt_pk_bf16_f32 v118, v59, v51
v_cvt_pk_bf16_f32 v119, v43, v35
ds_write_b64 v253, v[118:119] offset:768
v_lshlrev_b32 v220, 16, v130
v_and_b32 v221, 0xffff0000, v130
v_lshlrev_b32 v222, 16, v131
v_and_b32 v223, 0xffff0000, v131
v_lshlrev_b32 v224, 16, v134
v_and_b32 v225, 0xffff0000, v134
v_lshlrev_b32 v226, 16, v135
v_and_b32 v227, 0xffff0000, v135
v_lshlrev_b32 v228, 16, v138
v_and_b32 v229, 0xffff0000, v138
v_lshlrev_b32 v230, 16, v139
v_and_b32 v231, 0xffff0000, v139
v_lshlrev_b32 v232, 16, v142
v_and_b32 v233, 0xffff0000, v142
v_lshlrev_b32 v234, 16, v143
v_and_b32 v235, 0xffff0000, v143
v_lshlrev_b32 v236, 16, v146
v_and_b32 v237, 0xffff0000, v146
v_lshlrev_b32 v238, 16, v147
v_and_b32 v239, 0xffff0000, v147
v_lshlrev_b32 v240, 16, v150
v_and_b32 v241, 0xffff0000, v150
v_lshlrev_b32 v242, 16, v151
v_and_b32 v243, 0xffff0000, v151
v_lshlrev_b32 v244, 16, v154
v_and_b32 v245, 0xffff0000, v154
v_lshlrev_b32 v246, 16, v155
v_and_b32 v247, 0xffff0000, v155
v_pk_mul_f32 v[36:37], v[232:233], v[192:193]
v_pk_fma_f32 v[36:37], v[228:229], v[200:201], v[36:37]
v_pk_fma_f32 v[36:37], v[224:225], v[208:209], v[36:37]
v_pk_fma_f32 v[36:37], v[220:221], v[216:217], v[36:37]
v_lshlrev_b32 v26, 16, v158
v_and_b32 v27, 0xffff0000, v158
v_pk_mul_f32 v[36:37], v[36:37], v[26:27]
v_pk_mul_f32 v[38:39], v[234:235], v[194:195]
v_pk_fma_f32 v[38:39], v[230:231], v[202:203], v[38:39]
v_pk_fma_f32 v[38:39], v[226:227], v[210:211], v[38:39]
v_pk_fma_f32 v[38:39], v[222:223], v[218:219], v[38:39]
v_lshlrev_b32 v26, 16, v159
v_and_b32 v27, 0xffff0000, v159
v_pk_mul_f32 v[38:39], v[38:39], v[26:27]
v_pk_mul_f32 v[44:45], v[236:237], v[192:193]
v_pk_fma_f32 v[44:45], v[232:233], v[200:201], v[44:45]
v_pk_fma_f32 v[44:45], v[228:229], v[208:209], v[44:45]
v_pk_fma_f32 v[44:45], v[224:225], v[216:217], v[44:45]
v_lshlrev_b32 v26, 16, v162
v_and_b32 v27, 0xffff0000, v162
v_pk_mul_f32 v[44:45], v[44:45], v[26:27]
v_pk_mul_f32 v[46:47], v[238:239], v[194:195]
v_pk_fma_f32 v[46:47], v[234:235], v[202:203], v[46:47]
v_pk_fma_f32 v[46:47], v[230:231], v[210:211], v[46:47]
v_pk_fma_f32 v[46:47], v[226:227], v[218:219], v[46:47]
v_lshlrev_b32 v26, 16, v163
v_and_b32 v27, 0xffff0000, v163
v_pk_mul_f32 v[46:47], v[46:47], v[26:27]
v_pk_mul_f32 v[52:53], v[240:241], v[192:193]
v_pk_fma_f32 v[52:53], v[236:237], v[200:201], v[52:53]
v_pk_fma_f32 v[52:53], v[232:233], v[208:209], v[52:53]
v_pk_fma_f32 v[52:53], v[228:229], v[216:217], v[52:53]
v_lshlrev_b32 v26, 16, v166
v_and_b32 v27, 0xffff0000, v166
v_pk_mul_f32 v[52:53], v[52:53], v[26:27]
v_pk_mul_f32 v[54:55], v[242:243], v[194:195]
v_pk_fma_f32 v[54:55], v[238:239], v[202:203], v[54:55]
v_pk_fma_f32 v[54:55], v[234:235], v[210:211], v[54:55]
v_pk_fma_f32 v[54:55], v[230:231], v[218:219], v[54:55]
v_lshlrev_b32 v26, 16, v167
v_and_b32 v27, 0xffff0000, v167
v_pk_mul_f32 v[54:55], v[54:55], v[26:27]
v_pk_mul_f32 v[60:61], v[244:245], v[192:193]
v_pk_fma_f32 v[60:61], v[240:241], v[200:201], v[60:61]
v_pk_fma_f32 v[60:61], v[236:237], v[208:209], v[60:61]
v_pk_fma_f32 v[60:61], v[232:233], v[216:217], v[60:61]
v_lshlrev_b32 v26, 16, v170
v_and_b32 v27, 0xffff0000, v170
v_pk_mul_f32 v[60:61], v[60:61], v[26:27]
v_pk_mul_f32 v[62:63], v[246:247], v[194:195]
v_pk_fma_f32 v[62:63], v[242:243], v[202:203], v[62:63]
v_pk_fma_f32 v[62:63], v[238:239], v[210:211], v[62:63]
v_pk_fma_f32 v[62:63], v[234:235], v[218:219], v[62:63]
v_lshlrev_b32 v26, 16, v171
v_and_b32 v27, 0xffff0000, v171
v_pk_mul_f32 v[62:63], v[62:63], v[26:27]
v_cvt_pk_bf16_f32 v120, v60, v52
v_cvt_pk_bf16_f32 v121, v44, v36
ds_write_b64 v253, v[120:121] offset:1024
v_cvt_pk_bf16_f32 v122, v61, v53
v_cvt_pk_bf16_f32 v123, v45, v37
ds_write_b64 v253, v[122:123] offset:1280
v_cvt_pk_bf16_f32 v124, v62, v54
v_cvt_pk_bf16_f32 v125, v46, v38
ds_write_b64 v253, v[124:125] offset:1536
v_cvt_pk_bf16_f32 v126, v63, v55
v_cvt_pk_bf16_f32 v127, v47, v39
ds_write_b64 v253, v[126:127] offset:1792
s_waitcnt lgkmcnt(0)
s_barrier
ds_read_b128 v[128:131], v254 offset:0
ds_read_b128 v[132:135], v254 offset:1024
ds_read_b128 v[136:139], v255 offset:2048
ds_read_b128 v[140:143], v255 offset:3072
s_waitcnt lgkmcnt(3)
buffer_store_dwordx4 v[128:131], v248, s[56:59], s70 offen sc1
s_add_u32 s70, s70, 17408
s_waitcnt lgkmcnt(2)
buffer_store_dwordx4 v[132:135], v248, s[56:59], s70 offen sc1
s_add_u32 s70, s70, 17408
s_waitcnt lgkmcnt(1)
buffer_store_dwordx4 v[136:139], v248, s[56:59], s70 offen sc1
s_add_u32 s70, s70, 17408
s_waitcnt lgkmcnt(0)
buffer_store_dwordx4 v[140:143], v248, s[56:59], s70 offen sc1
v_mov_b32 v32, 0
v_mov_b32 v33, 0
v_mov_b32 v34, 0
v_mov_b32 v35, 0
v_mov_b32 v36, 0
v_mov_b32 v37, 0
v_mov_b32 v38, 0
v_mov_b32 v39, 0
v_mov_b32 v40, 0
v_mov_b32 v41, 0
v_mov_b32 v42, 0
v_mov_b32 v43, 0
v_mov_b32 v44, 0
v_mov_b32 v45, 0
v_mov_b32 v46, 0
v_mov_b32 v47, 0
v_mov_b32 v48, 0
v_mov_b32 v49, 0
v_mov_b32 v50, 0
v_mov_b32 v51, 0
v_mov_b32 v52, 0
v_mov_b32 v53, 0
v_mov_b32 v54, 0
v_mov_b32 v55, 0
v_mov_b32 v56, 0
v_mov_b32 v57, 0
v_mov_b32 v58, 0
v_mov_b32 v59, 0
v_mov_b32 v60, 0
v_mov_b32 v61, 0
v_mov_b32 v62, 0
v_mov_b32 v63, 0
s_waitcnt vmcnt(4)
ds_write_b128 v101, v[64:67] offset:4192
ds_write_b128 v101, v[68:71] offset:5216
ds_write_b128 v101, v[72:75] offset:6240
ds_write_b128 v101, v[76:79] offset:7264
v_readfirstlane_b32 s34, v68
s_nop 1
v_mov_b32 v84, s34
s_nop 1
v_mov_b32_dpp v84, v64 wave_shl:1 row_mask:0xf bank_mask:0xf
v_alignbyte_b32 v80, v65, v64, 2
v_alignbyte_b32 v81, v66, v65, 2
v_alignbyte_b32 v82, v67, v66, 2
v_alignbyte_b32 v83, v84, v67, 2
ds_write_b128 v101, v[80:83] offset:32
v_readfirstlane_b32 s34, v72
s_nop 1
v_mov_b32 v92, s34
s_nop 1
v_mov_b32_dpp v92, v68 wave_shl:1 row_mask:0xf bank_mask:0xf
v_alignbyte_b32 v88, v69, v68, 2
v_alignbyte_b32 v89, v70, v69, 2
v_alignbyte_b32 v90, v71, v70, 2
v_alignbyte_b32 v91, v92, v71, 2
ds_write_b128 v101, v[88:91] offset:1056
v_readfirstlane_b32 s34, v76
s_nop 1
v_mov_b32 v84, s34
s_nop 1
v_mov_b32_dpp v84, v72 wave_shl:1 row_mask:0xf bank_mask:0xf
v_alignbyte_b32 v80, v73, v72, 2
v_alignbyte_b32 v81, v74, v73, 2
v_alignbyte_b32 v82, v75, v74, 2
v_alignbyte_b32 v83, v84, v75, 2
ds_write_b128 v101, v[80:83] offset:2080
v_mov_b32 v92, 0
s_nop 1
v_mov_b32_dpp v92, v76 wave_shl:1 row_mask:0xf bank_mask:0xf
v_alignbyte_b32 v88, v77, v76, 2
v_alignbyte_b32 v89, v78, v77, 2
v_alignbyte_b32 v90, v79, v78, 2
v_alignbyte_b32 v91, v92, v79, 2
ds_write_b128 v101, v[88:91] offset:3104
v_lshlrev_b32 v87, 16, v64
s_mov_b64 exec, 1
ds_write_b32 v101, v87 offset:28
s_mov_b64 exec, -1
s_cmp_lg_u32 s26, 0
s_cbranch_scc1 interleave_layers__ssm_conv_h3__geglu_ffn__prompt_kernel_zok
s_mov_b32 s100, 0x200000
interleave_layers__ssm_conv_h3__geglu_ffn__prompt_kernel_zl:
s_load_dword s92, s[72:73], 0
s_load_dword s93, s[72:73], 128
s_waitcnt lgkmcnt(0)
s_min_u32 s92, s92, s93
s_cmp_ge_u32 s92, 32
s_cbranch_scc1 interleave_layers__ssm_conv_h3__geglu_ffn__prompt_kernel_zok
ZSLOWinterleave_layers__ssm_conv_h3__geglu_ffn__prompt_kernel:
v_lshlrev_b32 v26, 7, v31
s_mov_b64 exec, 3
interleave_layers__ssm_conv_h3__geglu_ffn__prompt_kernel_zm:
buffer_load_dword v27, v26, s[72:75], 0 offen sc1
s_waitcnt vmcnt(0)
v_cmp_le_u32 vcc, 32, v27
s_cmp_eq_u32 vcc_lo, 3
s_cbranch_scc1 interleave_layers__ssm_conv_h3__geglu_ffn__prompt_kernel_zd
s_sleep 2
s_sub_u32 s100, s100, 1
s_cmp_lg_u32 s100, 0
s_cbranch_scc1 interleave_layers__ssm_conv_h3__geglu_ffn__prompt_kernel_zm
interleave_layers__ssm_conv_h3__geglu_ffn__prompt_kernel_zd:
s_mov_b64 exec, -1
interleave_layers__ssm_conv_h3__geglu_ffn__prompt_kernel_zok:
s_add_u32 s74, s88, s97
s_addc_u32 s75, s89, 0
v_mul_u32_u24 v26, 10368, v31
v_mov_b32 v27, 1
s_waitcnt vmcnt(0)
s_barrier
s_cmp_lg_u32 s26, 0
s_cbranch_scc1 sig1
s_mov_b64 exec, 0xffff
buffer_store_byte v27, v26, s[88:91], s98 offen sc1
s_mov_b64 exec, -1
sig1:
s_lshr_b32 s3, s2, 4
s_lshl_b32 s3, s3, 3
s_and_b32 s29, s2, 7
s_add_u32 s3, s3, s29
s_lshl_b32 s3, s3, 1
s_bfe_u32 s29, s2, 0x10003
s_add_u32 s3, s3, s29
v_and_b32 v16, 7, v31
v_bfe_u32 v17, v31, 3, 2
v_lshrrev_b32 v18, 5, v31
v_mul_u32_u24 v12, 4096, v18
v_lshl_add_u32 v12, v17, 7, v12
v_lshl_add_u32 v12, v16, 4, v12
s_lshr_b32 s29, s3, 3
s_lshl_b32 s29, s29, 2
s_add_u32 s29, s29, s26
s_mul_i32 s29, s29, 32768
s_bfe_u32 s30, s3, 0x20001
s_lshl_b32 s30, s30, 10
s_add_u32 s29, s29, s30
s_and_b32 s30, s3, 1
s_lshl_b32 s30, s30, 9
s_add_u32 s29, s29, s30
s_add_u32 s30, s29, 8192
s_add_u32 s31, s29, 16384
s_add_u32 s32, s29, 24576
v_lshlrev_b32 v13, 11, v16
v_lshl_add_u32 v13, v18, 6, v13
v_lshl_add_u32 v13, v17, 4, v13
s_lshl_b32 s33, s3, 14
s_lshl_b32 s34, s26, 9
s_add_u32 s33, s33, s34
s_mov_b32 s16, s80
s_mov_b32 s17, s81
s_mov_b32 s18, 4194304
s_mov_b32 s19, 0x20000
s_and_b32 s27, s2, 1
s_lshl_b32 s27, s27, 2
s_lshr_b32 s28, s2, 3
s_and_b32 s34, s28, 3
s_add_u32 s27, s27, s34
s_bfe_u32 s34, s2, 0x20001
s_lshl_b32 s34, s34, 3
s_lshr_b32 s28, s28, 2
s_add_u32 s28, s28, s34
s_lshr_b32 s35, s26, 1
s_and_b32 s34, s26, 1
s_mul_i32 s21, s35, 229376
s_mul_i32 s22, s35, 14336
s_mul_i32 s36, s34, 7168
s_add_u32 s22, s22, s36
s_cmp_eq_u32 s34, 0
s_cselect_b32 s12, s4, s6
s_cselect_b32 s13, s5, s7
s_mul_i32 s35, s28, 224
s_add_u32 s12, s12, s35
s_addc_u32 s13, s13, 0
s_sub_u32 s14, 7340032, s35
s_mov_b32 s15, 0x20000
s_lshr_b32 s61, s2, 3
s_lshr_b32 s62, s61, 2
s_add_u32 s61, s61, s62
s_mul_i32 s61, s61, s60
s_add_u32 s62, s61, 0
s_and_b32 s62, s62, 3
s_mul_i32 s76, s62, 8192
s_mul_i32 s62, s62, 458752
s_add_u32 s64, s62, s21
s_add_u32 s62, s61, 1
s_and_b32 s62, s62, 3
s_mul_i32 s77, s62, 8192
s_mul_i32 s62, s62, 458752
s_add_u32 s65, s62, s21
s_add_u32 s62, s61, 2
s_and_b32 s62, s62, 3
s_mul_i32 s78, s62, 8192
s_mul_i32 s62, s62, 458752
s_add_u32 s66, s62, s21
s_add_u32 s62, s61, 3
s_and_b32 s62, s62, 3
s_mul_i32 s79, s62, 8192
s_mul_i32 s62, s62, 458752
s_add_u32 s67, s62, s21
s_mov_b32 s68, 0
s_mov_b32 s69, 0
s_mov_b32 s21, s64
s_mov_b32 s20, s76
s_waitcnt lgkmcnt(0)
s_cmp_lt_u32 s26, 2
s_cselect_b32 s44, s44, s45
s_and_b32 s45, s26, 1
s_lshl_b32 s45, s45, 4
s_lshr_b32 s44, s44, s45
s_and_b32 s44, s44, 0xffff
v_and_b32 v111, 1, v110
v_lshlrev_b32 v111, 4, v111
v_lshlrev_b32 v111, v111, s44
v_ashrrev_i32 v110, 1, v110
v_cmp_eq_u32 vcc, 0, v110
s_nop 1
v_cndmask_b32 v96, 0, v111, vcc
v_cmp_eq_u32 vcc, 1, v110
s_nop 1
v_cndmask_b32 v97, 0, v111, vcc
v_cmp_eq_u32 vcc, 2, v110
s_nop 1
v_cndmask_b32 v98, 0, v111, vcc
v_cmp_eq_u32 vcc, 3, v110
s_nop 1
v_cndmask_b32 v99, 0, v111, vcc
s_cmp_lg_u32 s26, 0
s_cbranch_scc1 wt2
s_mov_b32 s101, 0
s_add_u32 vcc_lo, s74, s101
s_addc_u32 vcc_hi, s75, 0
s_mov_b32 s100, 0x200000
wp2:
s_load_dwordx2 s[92:93], vcc, 0 glc
s_load_dwordx2 s[94:95], vcc, 128 glc
s_waitcnt lgkmcnt(0)
s_and_b32 s92, s92, s93
s_and_b32 s92, s92, s94
s_and_b32 s92, s92, s95
s_cmp_eq_u32 s92, 0x01010101
s_cbranch_scc1 wd2
s_sleep 2
s_sub_u32 s100, s100, 1
s_cmp_lg_u32 s100, 0
s_cbranch_scc1 wp2
wd2:
wt2:
s_barrier
s_mov_b32 m0, s71
s_nop 0
buffer_load_dwordx4 v3, s[40:43], 0 offen offset:0 lds
buffer_load_dwordx4 v3, s[40:43], 0 offen offset:1024 lds
buffer_load_dwordx4 v3, s[40:43], 0 offen offset:2048 lds
buffer_load_dwordx4 v3, s[40:43], 0 offen offset:3072 lds
s_and_b32 s27, s2, 1
s_lshl_b32 s27, s27, 2
s_lshr_b32 s28, s2, 3
s_and_b32 s34, s28, 3
s_add_u32 s27, s27, s34
s_bfe_u32 s34, s2, 0x20001
s_lshl_b32 s34, s34, 3
s_lshr_b32 s28, s28, 2
s_add_u32 s28, s28, s34
v_lshlrev_b32 v3, 4, v31
s_movk_i32 s34, 4682
s_movk_i32 s35, 7168
s_and_b32 s36, s28, 1
s_lshl_b32 s36, s36, 1
v_add_u32 v20, 0, v31
v_mul_u32_u24 v21, s34, v20
v_lshrrev_b32 v21, 16, v21
v_mul_u32_u24 v22, 14, v21
v_sub_u32 v22, v20, v22
v_add_u32 v22, s36, v22
v_subrev_u32 v26, 14, v22
v_min_u32 v22, v22, v26
v_bfe_u32 v19, v21, 2, 2
v_lshlrev_b32 v19, 3, v19
v_lshrrev_b32 v26, 4, v21
v_lshl_add_u32 v19, v26, 2, v19
v_and_b32 v26, 3, v21
v_add_u32 v19, v19, v26
v_mul_u32_u24 v19, s35, v19
v_lshl_add_u32 v4, v22, 4, v19
v_add_u32 v20, 64, v31
v_mul_u32_u24 v21, s34, v20
v_lshrrev_b32 v21, 16, v21
v_mul_u32_u24 v22, 14, v21
v_sub_u32 v22, v20, v22
v_add_u32 v22, s36, v22
v_subrev_u32 v26, 14, v22
v_min_u32 v22, v22, v26
v_bfe_u32 v19, v21, 2, 2
v_lshlrev_b32 v19, 3, v19
v_lshrrev_b32 v26, 4, v21
v_lshl_add_u32 v19, v26, 2, v19
v_and_b32 v26, 3, v21
v_add_u32 v19, v19, v26
v_mul_u32_u24 v19, s35, v19
v_lshl_add_u32 v5, v22, 4, v19
v_subrev_u32 v5, 1024, v5
v_add_u32 v20, 128, v31
v_mul_u32_u24 v21, s34, v20
v_lshrrev_b32 v21, 16, v21
v_mul_u32_u24 v22, 14, v21
v_sub_u32 v22, v20, v22
v_add_u32 v22, s36, v22
v_subrev_u32 v26, 14, v22
v_min_u32 v22, v22, v26
v_bfe_u32 v19, v21, 2, 2
v_lshlrev_b32 v19, 3, v19
v_lshrrev_b32 v26, 4, v21
v_lshl_add_u32 v19, v26, 2, v19
v_and_b32 v26, 3, v21
v_add_u32 v19, v19, v26
v_mul_u32_u24 v19, s35, v19
v_lshl_add_u32 v6, v22, 4, v19
v_subrev_u32 v6, 2048, v6
v_add_u32 v20, 192, v31
v_mul_u32_u24 v21, s34, v20
v_lshrrev_b32 v21, 16, v21
v_mul_u32_u24 v22, 14, v21
v_sub_u32 v22, v20, v22
v_add_u32 v22, s36, v22
v_subrev_u32 v26, 14, v22
v_min_u32 v22, v22, v26
v_bfe_u32 v19, v21, 2, 2
v_lshlrev_b32 v19, 3, v19
v_lshrrev_b32 v26, 4, v21
v_lshl_add_u32 v19, v26, 2, v19
v_and_b32 v26, 3, v21
v_add_u32 v19, v19, v26
v_mul_u32_u24 v19, s35, v19
v_lshl_add_u32 v7, v22, 4, v19
v_subrev_u32 v7, 3072, v7
v_add_u32 v20, 256, v31
v_mul_u32_u24 v21, s34, v20
v_lshrrev_b32 v21, 16, v21
v_mul_u32_u24 v22, 14, v21
v_sub_u32 v22, v20, v22
v_add_u32 v22, s36, v22
v_subrev_u32 v26, 14, v22
v_min_u32 v22, v22, v26
v_bfe_u32 v19, v21, 2, 2
v_lshlrev_b32 v19, 3, v19
v_lshrrev_b32 v26, 4, v21
v_lshl_add_u32 v19, v26, 2, v19
v_and_b32 v26, 3, v21
v_add_u32 v19, v19, v26
v_mul_u32_u24 v19, s35, v19
v_lshl_add_u32 v8, v22, 4, v19
v_add_u32 v20, 320, v31
v_mul_u32_u24 v21, s34, v20
v_lshrrev_b32 v21, 16, v21
v_mul_u32_u24 v22, 14, v21
v_sub_u32 v22, v20, v22
v_add_u32 v22, s36, v22
v_subrev_u32 v26, 14, v22
v_min_u32 v22, v22, v26
v_bfe_u32 v19, v21, 2, 2
v_lshlrev_b32 v19, 3, v19
v_lshrrev_b32 v26, 4, v21
v_lshl_add_u32 v19, v26, 2, v19
v_and_b32 v26, 3, v21
v_add_u32 v19, v19, v26
v_mul_u32_u24 v19, s35, v19
v_lshl_add_u32 v9, v22, 4, v19
v_subrev_u32 v9, 1024, v9
v_add_u32 v20, 384, v31
v_mul_u32_u24 v21, s34, v20
v_lshrrev_b32 v21, 16, v21
v_mul_u32_u24 v22, 14, v21
v_sub_u32 v22, v20, v22
v_add_u32 v22, s36, v22
v_subrev_u32 v26, 14, v22
v_min_u32 v22, v22, v26
v_bfe_u32 v19, v21, 2, 2
v_lshlrev_b32 v19, 3, v19
v_lshrrev_b32 v26, 4, v21
v_lshl_add_u32 v19, v26, 2, v19
v_and_b32 v26, 3, v21
v_add_u32 v19, v19, v26
v_mul_u32_u24 v19, s35, v19
v_lshl_add_u32 v10, v22, 4, v19
v_subrev_u32 v10, 2048, v10
v_lshrrev_b32 v20, 2, v31
v_mul_u32_u24 v20, 224, v20
v_and_b32 v21, 3, v31
v_lshl_add_u32 v1, v21, 3, v20
v_add_u32 v2, 57344, v1
v_lshrrev_b32 v20, 3, v31
v_bfe_u32 v21, v31, 1, 2
v_bfe_u32 v22, v31, 4, 2
v_xor_b32 v21, v21, v22
v_and_b32 v22, 1, v31
v_lshl_add_u32 v21, v21, 1, v22
v_lshlrev_b32 v21, 4, v21
v_lshl_add_u32 v11, v20, 11, v21
v_mov_b32 v28, 3222493025
v_mov_b32 v29, 3222493025
v_and_b32 v30, 15, v31
v_lshlrev_b32 v30, 4, v30
v_lshrrev_b32 v20, 5, v31
v_lshl_add_u32 v30, v20, 8, v30
v_lshrrev_b32 v20, 2, v31
v_lshlrev_b32 v20, 7, v20
v_and_b32 v21, 3, v31
v_lshl_add_u32 v20, v21, 3, v20
v_add_u32 v20, 114688, v20
v_bfe_u32 v22, v31, 3, 2
v_xor_b32 v22, s26, v22
v_lshl_add_u32 v23, v22, 5, v20
v_lshrrev_b32 v20, 4, v31
v_lshlrev_b32 v20, 3, v20
v_bfe_u32 v22, v31, 2, 2
v_add_u32 v20, v20, v22
v_add_u32 v19, 0, v20
v_bfe_u32 v22, v19, 1, 2
v_xor_b32 v22, s26, v22
v_lshlrev_b32 v19, 7, v19
v_lshl_add_u32 v19, v22, 5, v19
v_lshl_add_u32 v19, v21, 3, v19
v_add_u32 v24, 126976, v19
v_add_u32 v19, 4, v20
v_bfe_u32 v22, v19, 1, 2
v_xor_b32 v22, s26, v22
v_lshlrev_b32 v19, 7, v19
v_lshl_add_u32 v19, v22, 5, v19
v_lshl_add_u32 v19, v21, 3, v19
v_add_u32 v25, 126976, v19
v_mul_u32_u24 v20, 43, v31
v_lshrrev_b32 v20, 7, v20
v_mul_u32_u24 v19, 3, v20
v_sub_u32 v19, v31, v19
v_mul_u32_u24 v20, s35, v20
v_lshl_add_u32 v21, v19, 7, v20
v_accvgpr_write_b32 a254, v21
v_bfe_u32 v20, v31, 3, 1
v_lshlrev_b32 v20, 9, v20
v_lshrrev_b32 v21, 4, v31
v_lshl_add_u32 v20, v21, 7, v20
v_and_b32 v21, 7, v31
v_lshl_add_u32 v22, v21, 4, v20
s_waitcnt lgkmcnt(0)
ds_read2_b32 a[0:1], v102 offset0:0 offset1:1
ds_read2_b32 a[2:3], v102 offset0:2 offset1:3
ds_read2_b32 a[4:5], v102 offset0:128 offset1:129
ds_read2_b32 a[6:7], v102 offset0:130 offset1:131
ds_read2_b32 a[8:9], v103 offset0:0 offset1:1
ds_read2_b32 a[10:11], v103 offset0:2 offset1:3
ds_read2_b32 a[12:13], v103 offset0:128 offset1:129
ds_read2_b32 a[14:15], v103 offset0:130 offset1:131
ds_read2_b32 a[16:17], v104 offset0:0 offset1:1
ds_read2_b32 a[18:19], v104 offset0:2 offset1:3
ds_read2_b32 a[20:21], v104 offset0:128 offset1:129
ds_read2_b32 a[22:23], v104 offset0:130 offset1:131
ds_read2_b32 a[24:25], v105 offset0:0 offset1:1
ds_read2_b32 a[26:27], v105 offset0:2 offset1:3
ds_read2_b32 a[28:29], v105 offset0:128 offset1:129
ds_read2_b32 a[30:31], v105 offset0:130 offset1:131
s_waitcnt vmcnt(0)
ds_read_b128 a[32:35], v100 offset:3584
ds_read_b128 a[36:39], v100 offset:3072
ds_read_b128 a[40:43], v100 offset:2560
ds_read_b128 a[44:47], v100 offset:2048
ds_read_b128 a[48:51], v100 offset:1536
ds_read_b128 a[52:55], v100 offset:1024
ds_read_b128 a[56:59], v100 offset:512
ds_read_b128 a[60:63], v100 offset:0
s_waitcnt lgkmcnt(0)
v_mfma_f32_16x16x32_bf16 v[32:35], a[0:3], a[32:35], v[32:35]
ds_read_b128 a[96:99], v100 offset:3648
v_mfma_f32_16x16x32_bf16 v[36:39], a[4:7], a[32:35], v[36:39]
ds_read2_b32 a[64:65], v102 offset0:16 offset1:17
v_mfma_f32_16x16x32_bf16 v[40:43], a[8:11], a[32:35], v[40:43]
ds_read2_b32 a[66:67], v102 offset0:18 offset1:19
v_mfma_f32_16x16x32_bf16 v[44:47], a[12:15], a[32:35], v[44:47]
ds_read_b128 a[100:103], v100 offset:3136
v_mfma_f32_16x16x32_bf16 v[48:51], a[16:19], a[32:35], v[48:51]
ds_read2_b32 a[68:69], v102 offset0:144 offset1:145
v_mfma_f32_16x16x32_bf16 v[52:55], a[20:23], a[32:35], v[52:55]
ds_read2_b32 a[70:71], v102 offset0:146 offset1:147
v_mfma_f32_16x16x32_bf16 v[56:59], a[24:27], a[32:35], v[56:59]
ds_read_b128 a[104:107], v100 offset:2624
v_mfma_f32_16x16x32_bf16 v[60:63], a[28:31], a[32:35], v[60:63]
ds_read2_b32 a[72:73], v103 offset0:16 offset1:17
v_mfma_f32_16x16x32_bf16 v[36:39], a[0:3], a[36:39], v[36:39]
ds_read2_b32 a[74:75], v103 offset0:18 offset1:19
v_mfma_f32_16x16x32_bf16 v[40:43], a[4:7], a[36:39], v[40:43]
ds_read_b128 a[108:111], v100 offset:2112
v_mfma_f32_16x16x32_bf16 v[44:47], a[8:11], a[36:39], v[44:47]
ds_read2_b32 a[76:77], v103 offset0:144 offset1:145
v_mfma_f32_16x16x32_bf16 v[48:51], a[12:15], a[36:39], v[48:51]
ds_read2_b32 a[78:79], v103 offset0:146 offset1:147
v_mfma_f32_16x16x32_bf16 v[52:55], a[16:19], a[36:39], v[52:55]
ds_read_b128 a[112:115], v100 offset:1600
v_mfma_f32_16x16x32_bf16 v[56:59], a[20:23], a[36:39], v[56:59]
ds_read2_b32 a[80:81], v104 offset0:16 offset1:17
v_mfma_f32_16x16x32_bf16 v[60:63], a[24:27], a[36:39], v[60:63]
ds_read2_b32 a[82:83], v104 offset0:18 offset1:19
v_mfma_f32_16x16x32_bf16 v[40:43], a[0:3], a[40:43], v[40:43]
ds_read_b128 a[116:119], v100 offset:1088
buffer_load_dwordx4 v[112:115], v13, s[16:19], s33 offen offset:0 nt
v_mfma_f32_16x16x32_bf16 v[44:47], a[4:7], a[40:43], v[44:47]
ds_read2_b32 a[84:85], v104 offset0:144 offset1:145
v_mfma_f32_16x16x32_bf16 v[48:51], a[8:11], a[40:43], v[48:51]
ds_read2_b32 a[86:87], v104 offset0:146 offset1:147
v_mfma_f32_16x16x32_bf16 v[52:55], a[12:15], a[40:43], v[52:55]
ds_read_b128 a[120:123], v100 offset:576
v_mfma_f32_16x16x32_bf16 v[56:59], a[16:19], a[40:43], v[56:59]
ds_read2_b32 a[88:89], v105 offset0:16 offset1:17
v_mfma_f32_16x16x32_bf16 v[60:63], a[20:23], a[40:43], v[60:63]
ds_read2_b32 a[90:91], v105 offset0:18 offset1:19
v_mfma_f32_16x16x32_bf16 v[44:47], a[0:3], a[44:47], v[44:47]
ds_read_b128 a[124:127], v100 offset:64
v_mfma_f32_16x16x32_bf16 v[48:51], a[4:7], a[44:47], v[48:51]
ds_read2_b32 a[92:93], v105 offset0:144 offset1:145
v_mfma_f32_16x16x32_bf16 v[52:55], a[8:11], a[44:47], v[52:55]
ds_read2_b32 a[94:95], v105 offset0:146 offset1:147
v_mfma_f32_16x16x32_bf16 v[56:59], a[12:15], a[44:47], v[56:59]
v_mfma_f32_16x16x32_bf16 v[60:63], a[16:19], a[44:47], v[60:63]
v_mfma_f32_16x16x32_bf16 v[48:51], a[0:3], a[48:51], v[48:51]
v_mfma_f32_16x16x32_bf16 v[52:55], a[4:7], a[48:51], v[52:55]
v_mfma_f32_16x16x32_bf16 v[56:59], a[8:11], a[48:51], v[56:59]
v_mfma_f32_16x16x32_bf16 v[60:63], a[12:15], a[48:51], v[60:63]
v_mfma_f32_16x16x32_bf16 v[52:55], a[0:3], a[52:55], v[52:55]
v_mfma_f32_16x16x32_bf16 v[56:59], a[4:7], a[52:55], v[56:59]
buffer_load_dwordx4 v[116:119], v13, s[16:19], s33 offen offset:128 nt
v_mfma_f32_16x16x32_bf16 v[60:63], a[8:11], a[52:55], v[60:63]
v_mfma_f32_16x16x32_bf16 v[56:59], a[0:3], a[56:59], v[56:59]
v_mfma_f32_16x16x32_bf16 v[60:63], a[4:7], a[56:59], v[60:63]
v_mfma_f32_16x16x32_bf16 v[60:63], a[0:3], a[60:63], v[60:63]
v_mfma_f32_16x16x32_bf16 v[32:35], v[96:99], a[32:35], v[32:35]
v_mfma_f32_16x16x32_bf16 v[36:39], v[96:99], a[36:39], v[36:39]
v_mfma_f32_16x16x32_bf16 v[40:43], v[96:99], a[40:43], v[40:43]
v_mfma_f32_16x16x32_bf16 v[44:47], v[96:99], a[44:47], v[44:47]
v_mfma_f32_16x16x32_bf16 v[48:51], v[96:99], a[48:51], v[48:51]
v_mfma_f32_16x16x32_bf16 v[52:55], v[96:99], a[52:55], v[52:55]
v_mfma_f32_16x16x32_bf16 v[56:59], v[96:99], a[56:59], v[56:59]
v_mfma_f32_16x16x32_bf16 v[60:63], v[96:99], a[60:63], v[60:63]
s_waitcnt lgkmcnt(0)
v_mfma_f32_16x16x32_bf16 v[32:35], a[64:67], a[96:99], v[32:35]
ds_read_b128 a[32:35], v100 offset:3712
v_mfma_f32_16x16x32_bf16 v[36:39], a[68:71], a[96:99], v[36:39]
ds_read2_b32 a[0:1], v102 offset0:32 offset1:33
v_mfma_f32_16x16x32_bf16 v[40:43], a[72:75], a[96:99], v[40:43]
ds_read2_b32 a[2:3], v102 offset0:34 offset1:35
v_mfma_f32_16x16x32_bf16 v[44:47], a[76:79], a[96:99], v[44:47]
ds_read_b128 a[36:39], v100 offset:3200
buffer_load_dwordx4 v[120:123], v13, s[16:19], s33 offen offset:256 nt
v_mfma_f32_16x16x32_bf16 v[48:51], a[80:83], a[96:99], v[48:51]
ds_read2_b32 a[4:5], v102 offset0:160 offset1:161
v_mfma_f32_16x16x32_bf16 v[52:55], a[84:87], a[96:99], v[52:55]
ds_read2_b32 a[6:7], v102 offset0:162 offset1:163
v_mfma_f32_16x16x32_bf16 v[56:59], a[88:91], a[96:99], v[56:59]
ds_read_b128 a[40:43], v100 offset:2688
v_mfma_f32_16x16x32_bf16 v[60:63], a[92:95], a[96:99], v[60:63]
ds_read2_b32 a[8:9], v103 offset0:32 offset1:33
v_mfma_f32_16x16x32_bf16 v[36:39], a[64:67], a[100:103], v[36:39]
ds_read2_b32 a[10:11], v103 offset0:34 offset1:35
v_mfma_f32_16x16x32_bf16 v[40:43], a[68:71], a[100:103], v[40:43]
ds_read_b128 a[44:47], v100 offset:2176
v_mfma_f32_16x16x32_bf16 v[44:47], a[72:75], a[100:103], v[44:47]
ds_read2_b32 a[12:13], v103 offset0:160 offset1:161
v_mfma_f32_16x16x32_bf16 v[48:51], a[76:79], a[100:103], v[48:51]
ds_read2_b32 a[14:15], v103 offset0:162 offset1:163
v_mfma_f32_16x16x32_bf16 v[52:55], a[80:83], a[100:103], v[52:55]
ds_read_b128 a[48:51], v100 offset:1664
v_mfma_f32_16x16x32_bf16 v[56:59], a[84:87], a[100:103], v[56:59]
ds_read2_b32 a[16:17], v104 offset0:32 offset1:33
v_mfma_f32_16x16x32_bf16 v[60:63], a[88:91], a[100:103], v[60:63]
ds_read2_b32 a[18:19], v104 offset0:34 offset1:35
v_mfma_f32_16x16x32_bf16 v[40:43], a[64:67], a[104:107], v[40:43]
ds_read_b128 a[52:55], v100 offset:1152
v_mfma_f32_16x16x32_bf16 v[44:47], a[68:71], a[104:107], v[44:47]
ds_read2_b32 a[20:21], v104 offset0:160 offset1:161
v_mfma_f32_16x16x32_bf16 v[48:51], a[72:75], a[104:107], v[48:51]
ds_read2_b32 a[22:23], v104 offset0:162 offset1:163
v_mfma_f32_16x16x32_bf16 v[52:55], a[76:79], a[104:107], v[52:55]
ds_read_b128 a[56:59], v100 offset:640
v_mfma_f32_16x16x32_bf16 v[56:59], a[80:83], a[104:107], v[56:59]
ds_read2_b32 a[24:25], v105 offset0:32 offset1:33
buffer_load_dwordx4 v[124:127], v13, s[16:19], s33 offen offset:384 nt
v_mfma_f32_16x16x32_bf16 v[60:63], a[84:87], a[104:107], v[60:63]
ds_read2_b32 a[26:27], v105 offset0:34 offset1:35
v_mfma_f32_16x16x32_bf16 v[44:47], a[64:67], a[108:111], v[44:47]
ds_read_b128 a[60:63], v100 offset:128
v_mfma_f32_16x16x32_bf16 v[48:51], a[68:71], a[108:111], v[48:51]
ds_read2_b32 a[28:29], v105 offset0:160 offset1:161
v_mfma_f32_16x16x32_bf16 v[52:55], a[72:75], a[108:111], v[52:55]
ds_read2_b32 a[30:31], v105 offset0:162 offset1:163
v_mfma_f32_16x16x32_bf16 v[56:59], a[76:79], a[108:111], v[56:59]
v_mfma_f32_16x16x32_bf16 v[60:63], a[80:83], a[108:111], v[60:63]
v_mfma_f32_16x16x32_bf16 v[48:51], a[64:67], a[112:115], v[48:51]
v_mfma_f32_16x16x32_bf16 v[52:55], a[68:71], a[112:115], v[52:55]
v_mfma_f32_16x16x32_bf16 v[56:59], a[72:75], a[112:115], v[56:59]
v_mfma_f32_16x16x32_bf16 v[60:63], a[76:79], a[112:115], v[60:63]
v_mfma_f32_16x16x32_bf16 v[52:55], a[64:67], a[116:119], v[52:55]
v_mfma_f32_16x16x32_bf16 v[56:59], a[68:71], a[116:119], v[56:59]
v_mfma_f32_16x16x32_bf16 v[60:63], a[72:75], a[116:119], v[60:63]
v_mfma_f32_16x16x32_bf16 v[56:59], a[64:67], a[120:123], v[56:59]
v_mfma_f32_16x16x32_bf16 v[60:63], a[68:71], a[120:123], v[60:63]
v_mfma_f32_16x16x32_bf16 v[60:63], a[64:67], a[124:127], v[60:63]
s_add_u32 m0, s22, 0
s_nop 0
buffer_load_dwordx4 v4, s[12:15], s21 offen offset:0  lds
s_waitcnt lgkmcnt(0)
v_mfma_f32_16x16x32_bf16 v[32:35], a[0:3], a[32:35], v[32:35]
ds_read_b128 a[96:99], v100 offset:3776
v_mfma_f32_16x16x32_bf16 v[36:39], a[4:7], a[32:35], v[36:39]
ds_read2_b32 a[64:65], v102 offset0:48 offset1:49
v_mfma_f32_16x16x32_bf16 v[40:43], a[8:11], a[32:35], v[40:43]
ds_read2_b32 a[66:67], v102 offset0:50 offset1:51
v_mfma_f32_16x16x32_bf16 v[44:47], a[12:15], a[32:35], v[44:47]
ds_read_b128 a[100:103], v100 offset:3264
v_mfma_f32_16x16x32_bf16 v[48:51], a[16:19], a[32:35], v[48:51]
ds_read2_b32 a[68:69], v102 offset0:176 offset1:177
v_mfma_f32_16x16x32_bf16 v[52:55], a[20:23], a[32:35], v[52:55]
ds_read2_b32 a[70:71], v102 offset0:178 offset1:179
v_mfma_f32_16x16x32_bf16 v[56:59], a[24:27], a[32:35], v[56:59]
ds_read_b128 a[104:107], v100 offset:2752
v_mfma_f32_16x16x32_bf16 v[60:63], a[28:31], a[32:35], v[60:63]
ds_read2_b32 a[72:73], v103 offset0:48 offset1:49
v_mfma_f32_16x16x32_bf16 v[36:39], a[0:3], a[36:39], v[36:39]
ds_read2_b32 a[74:75], v103 offset0:50 offset1:51
v_mfma_f32_16x16x32_bf16 v[40:43], a[4:7], a[36:39], v[40:43]
ds_read_b128 a[108:111], v100 offset:2240
v_mfma_f32_16x16x32_bf16 v[44:47], a[8:11], a[36:39], v[44:47]
ds_read2_b32 a[76:77], v103 offset0:176 offset1:177
v_mfma_f32_16x16x32_bf16 v[48:51], a[12:15], a[36:39], v[48:51]
ds_read2_b32 a[78:79], v103 offset0:178 offset1:179
v_mfma_f32_16x16x32_bf16 v[52:55], a[16:19], a[36:39], v[52:55]
ds_read_b128 a[112:115], v100 offset:1728
v_mfma_f32_16x16x32_bf16 v[56:59], a[20:23], a[36:39], v[56:59]
ds_read2_b32 a[80:81], v104 offset0:48 offset1:49
v_mfma_f32_16x16x32_bf16 v[60:63], a[24:27], a[36:39], v[60:63]
ds_read2_b32 a[82:83], v104 offset0:50 offset1:51
v_mfma_f32_16x16x32_bf16 v[40:43], a[0:3], a[40:43], v[40:43]
ds_read_b128 a[116:119], v100 offset:1216
buffer_load_dwordx4 v5, s[12:15], s21 offen offset:1024  lds
v_mfma_f32_16x16x32_bf16 v[44:47], a[4:7], a[40:43], v[44:47]
ds_read2_b32 a[84:85], v104 offset0:176 offset1:177
v_mfma_f32_16x16x32_bf16 v[48:51], a[8:11], a[40:43], v[48:51]
ds_read2_b32 a[86:87], v104 offset0:178 offset1:179
v_mfma_f32_16x16x32_bf16 v[52:55], a[12:15], a[40:43], v[52:55]
ds_read_b128 a[120:123], v100 offset:704
v_mfma_f32_16x16x32_bf16 v[56:59], a[16:19], a[40:43], v[56:59]
ds_read2_b32 a[88:89], v105 offset0:48 offset1:49
v_mfma_f32_16x16x32_bf16 v[60:63], a[20:23], a[40:43], v[60:63]
ds_read2_b32 a[90:91], v105 offset0:50 offset1:51
v_mfma_f32_16x16x32_bf16 v[44:47], a[0:3], a[44:47], v[44:47]
ds_read_b128 a[124:127], v100 offset:192
v_mfma_f32_16x16x32_bf16 v[48:51], a[4:7], a[44:47], v[48:51]
ds_read2_b32 a[92:93], v105 offset0:176 offset1:177
v_mfma_f32_16x16x32_bf16 v[52:55], a[8:11], a[44:47], v[52:55]
ds_read2_b32 a[94:95], v105 offset0:178 offset1:179
v_mfma_f32_16x16x32_bf16 v[56:59], a[12:15], a[44:47], v[56:59]
v_mfma_f32_16x16x32_bf16 v[60:63], a[16:19], a[44:47], v[60:63]
v_mfma_f32_16x16x32_bf16 v[48:51], a[0:3], a[48:51], v[48:51]
v_mfma_f32_16x16x32_bf16 v[52:55], a[4:7], a[48:51], v[52:55]
v_mfma_f32_16x16x32_bf16 v[56:59], a[8:11], a[48:51], v[56:59]
v_mfma_f32_16x16x32_bf16 v[60:63], a[12:15], a[48:51], v[60:63]
v_mfma_f32_16x16x32_bf16 v[52:55], a[0:3], a[52:55], v[52:55]
v_mfma_f32_16x16x32_bf16 v[56:59], a[4:7], a[52:55], v[56:59]
buffer_load_dwordx4 v6, s[12:15], s21 offen offset:2048  lds
v_mfma_f32_16x16x32_bf16 v[60:63], a[8:11], a[52:55], v[60:63]
v_mfma_f32_16x16x32_bf16 v[56:59], a[0:3], a[56:59], v[56:59]
v_mfma_f32_16x16x32_bf16 v[60:63], a[4:7], a[56:59], v[60:63]
v_mfma_f32_16x16x32_bf16 v[60:63], a[0:3], a[60:63], v[60:63]
s_waitcnt lgkmcnt(0)
v_mfma_f32_16x16x32_bf16 v[32:35], a[64:67], a[96:99], v[32:35]
ds_read_b128 a[32:35], v100 offset:3840
v_mfma_f32_16x16x32_bf16 v[36:39], a[68:71], a[96:99], v[36:39]
ds_read2_b32 a[0:1], v102 offset0:64 offset1:65
v_mfma_f32_16x16x32_bf16 v[40:43], a[72:75], a[96:99], v[40:43]
ds_read2_b32 a[2:3], v102 offset0:66 offset1:67
v_mfma_f32_16x16x32_bf16 v[44:47], a[76:79], a[96:99], v[44:47]
ds_read_b128 a[36:39], v100 offset:3328
v_mfma_f32_16x16x32_bf16 v[48:51], a[80:83], a[96:99], v[48:51]
ds_read2_b32 a[4:5], v102 offset0:192 offset1:193
v_mfma_f32_16x16x32_bf16 v[52:55], a[84:87], a[96:99], v[52:55]
ds_read2_b32 a[6:7], v102 offset0:194 offset1:195
v_mfma_f32_16x16x32_bf16 v[56:59], a[88:91], a[96:99], v[56:59]
ds_read_b128 a[40:43], v100 offset:2816
v_mfma_f32_16x16x32_bf16 v[60:63], a[92:95], a[96:99], v[60:63]
ds_read2_b32 a[8:9], v103 offset0:64 offset1:65
v_mfma_f32_16x16x32_bf16 v[36:39], a[64:67], a[100:103], v[36:39]
ds_read2_b32 a[10:11], v103 offset0:66 offset1:67
v_mfma_f32_16x16x32_bf16 v[40:43], a[68:71], a[100:103], v[40:43]
ds_read_b128 a[44:47], v100 offset:2304
v_mfma_f32_16x16x32_bf16 v[44:47], a[72:75], a[100:103], v[44:47]
ds_read2_b32 a[12:13], v103 offset0:192 offset1:193
v_mfma_f32_16x16x32_bf16 v[48:51], a[76:79], a[100:103], v[48:51]
ds_read2_b32 a[14:15], v103 offset0:194 offset1:195
buffer_load_dwordx4 v7, s[12:15], s21 offen offset:3072  lds
v_mfma_f32_16x16x32_bf16 v[52:55], a[80:83], a[100:103], v[52:55]
ds_read_b128 a[48:51], v100 offset:1792
v_mfma_f32_16x16x32_bf16 v[56:59], a[84:87], a[100:103], v[56:59]
ds_read2_b32 a[16:17], v104 offset0:64 offset1:65
v_mfma_f32_16x16x32_bf16 v[60:63], a[88:91], a[100:103], v[60:63]
ds_read2_b32 a[18:19], v104 offset0:66 offset1:67
v_mfma_f32_16x16x32_bf16 v[40:43], a[64:67], a[104:107], v[40:43]
ds_read_b128 a[52:55], v100 offset:1280
v_mfma_f32_16x16x32_bf16 v[44:47], a[68:71], a[104:107], v[44:47]
ds_read2_b32 a[20:21], v104 offset0:192 offset1:193
v_mfma_f32_16x16x32_bf16 v[48:51], a[72:75], a[104:107], v[48:51]
ds_read2_b32 a[22:23], v104 offset0:194 offset1:195
v_mfma_f32_16x16x32_bf16 v[52:55], a[76:79], a[104:107], v[52:55]
ds_read_b128 a[56:59], v100 offset:768
v_mfma_f32_16x16x32_bf16 v[56:59], a[80:83], a[104:107], v[56:59]
ds_read2_b32 a[24:25], v105 offset0:64 offset1:65
v_mfma_f32_16x16x32_bf16 v[60:63], a[84:87], a[104:107], v[60:63]
ds_read2_b32 a[26:27], v105 offset0:66 offset1:67
v_mfma_f32_16x16x32_bf16 v[44:47], a[64:67], a[108:111], v[44:47]
ds_read_b128 a[60:63], v100 offset:256
v_mfma_f32_16x16x32_bf16 v[48:51], a[68:71], a[108:111], v[48:51]
ds_read2_b32 a[28:29], v105 offset0:192 offset1:193
v_mfma_f32_16x16x32_bf16 v[52:55], a[72:75], a[108:111], v[52:55]
ds_read2_b32 a[30:31], v105 offset0:194 offset1:195
v_mfma_f32_16x16x32_bf16 v[56:59], a[76:79], a[108:111], v[56:59]
v_mfma_f32_16x16x32_bf16 v[60:63], a[80:83], a[108:111], v[60:63]
v_mfma_f32_16x16x32_bf16 v[48:51], a[64:67], a[112:115], v[48:51]
v_mfma_f32_16x16x32_bf16 v[52:55], a[68:71], a[112:115], v[52:55]
s_add_u32 m0, s22, 4096
s_nop 0
buffer_load_dwordx4 v8, s[12:15], s21 offen offset:0  lds
v_mfma_f32_16x16x32_bf16 v[56:59], a[72:75], a[112:115], v[56:59]
v_mfma_f32_16x16x32_bf16 v[60:63], a[76:79], a[112:115], v[60:63]
v_mfma_f32_16x16x32_bf16 v[52:55], a[64:67], a[116:119], v[52:55]
v_mfma_f32_16x16x32_bf16 v[56:59], a[68:71], a[116:119], v[56:59]
v_mfma_f32_16x16x32_bf16 v[60:63], a[72:75], a[116:119], v[60:63]
v_mfma_f32_16x16x32_bf16 v[56:59], a[64:67], a[120:123], v[56:59]
v_mfma_f32_16x16x32_bf16 v[60:63], a[68:71], a[120:123], v[60:63]
v_mfma_f32_16x16x32_bf16 v[60:63], a[64:67], a[124:127], v[60:63]
s_waitcnt lgkmcnt(0)
v_mfma_f32_16x16x32_bf16 v[32:35], a[0:3], a[32:35], v[32:35]
ds_read_b128 a[96:99], v100 offset:3904
v_mfma_f32_16x16x32_bf16 v[36:39], a[4:7], a[32:35], v[36:39]
ds_read2_b32 a[64:65], v102 offset0:80 offset1:81
v_mfma_f32_16x16x32_bf16 v[40:43], a[8:11], a[32:35], v[40:43]
ds_read2_b32 a[66:67], v102 offset0:82 offset1:83
v_mfma_f32_16x16x32_bf16 v[44:47], a[12:15], a[32:35], v[44:47]
ds_read_b128 a[100:103], v100 offset:3392
v_mfma_f32_16x16x32_bf16 v[48:51], a[16:19], a[32:35], v[48:51]
ds_read2_b32 a[68:69], v102 offset0:208 offset1:209
v_mfma_f32_16x16x32_bf16 v[52:55], a[20:23], a[32:35], v[52:55]
ds_read2_b32 a[70:71], v102 offset0:210 offset1:211
v_mfma_f32_16x16x32_bf16 v[56:59], a[24:27], a[32:35], v[56:59]
ds_read_b128 a[104:107], v100 offset:2880
v_mfma_f32_16x16x32_bf16 v[60:63], a[28:31], a[32:35], v[60:63]
ds_read2_b32 a[72:73], v103 offset0:80 offset1:81
buffer_load_dwordx4 v9, s[12:15], s21 offen offset:1024  lds
v_mfma_f32_16x16x32_bf16 v[36:39], a[0:3], a[36:39], v[36:39]
ds_read2_b32 a[74:75], v103 offset0:82 offset1:83
v_mfma_f32_16x16x32_bf16 v[40:43], a[4:7], a[36:39], v[40:43]
ds_read_b128 a[108:111], v100 offset:2368
v_mfma_f32_16x16x32_bf16 v[44:47], a[8:11], a[36:39], v[44:47]
ds_read2_b32 a[76:77], v103 offset0:208 offset1:209
v_mfma_f32_16x16x32_bf16 v[48:51], a[12:15], a[36:39], v[48:51]
ds_read2_b32 a[78:79], v103 offset0:210 offset1:211
v_mfma_f32_16x16x32_bf16 v[52:55], a[16:19], a[36:39], v[52:55]
ds_read_b128 a[112:115], v100 offset:1856
v_mfma_f32_16x16x32_bf16 v[56:59], a[20:23], a[36:39], v[56:59]
ds_read2_b32 a[80:81], v104 offset0:80 offset1:81
v_mfma_f32_16x16x32_bf16 v[60:63], a[24:27], a[36:39], v[60:63]
ds_read2_b32 a[82:83], v104 offset0:82 offset1:83
v_mfma_f32_16x16x32_bf16 v[40:43], a[0:3], a[40:43], v[40:43]
ds_read_b128 a[116:119], v100 offset:1344
v_mfma_f32_16x16x32_bf16 v[44:47], a[4:7], a[40:43], v[44:47]
ds_read2_b32 a[84:85], v104 offset0:208 offset1:209
v_mfma_f32_16x16x32_bf16 v[48:51], a[8:11], a[40:43], v[48:51]
ds_read2_b32 a[86:87], v104 offset0:210 offset1:211
v_mfma_f32_16x16x32_bf16 v[52:55], a[12:15], a[40:43], v[52:55]
ds_read_b128 a[120:123], v100 offset:832
v_mfma_f32_16x16x32_bf16 v[56:59], a[16:19], a[40:43], v[56:59]
ds_read2_b32 a[88:89], v105 offset0:80 offset1:81
v_mfma_f32_16x16x32_bf16 v[60:63], a[20:23], a[40:43], v[60:63]
ds_read2_b32 a[90:91], v105 offset0:82 offset1:83
v_mfma_f32_16x16x32_bf16 v[44:47], a[0:3], a[44:47], v[44:47]
ds_read_b128 a[124:127], v100 offset:320
v_mfma_f32_16x16x32_bf16 v[48:51], a[4:7], a[44:47], v[48:51]
ds_read2_b32 a[92:93], v105 offset0:208 offset1:209
v_mfma_f32_16x16x32_bf16 v[52:55], a[8:11], a[44:47], v[52:55]
ds_read2_b32 a[94:95], v105 offset0:210 offset1:211
buffer_load_dwordx4 v10, s[12:15], s21 offen offset:2048  lds
s_add_u32 s21, s68, s65
v_mfma_f32_16x16x32_bf16 v[56:59], a[12:15], a[44:47], v[56:59]
v_mfma_f32_16x16x32_bf16 v[60:63], a[16:19], a[44:47], v[60:63]
v_mfma_f32_16x16x32_bf16 v[48:51], a[0:3], a[48:51], v[48:51]
v_mfma_f32_16x16x32_bf16 v[52:55], a[4:7], a[48:51], v[52:55]
v_mfma_f32_16x16x32_bf16 v[56:59], a[8:11], a[48:51], v[56:59]
v_mfma_f32_16x16x32_bf16 v[60:63], a[12:15], a[48:51], v[60:63]
v_mfma_f32_16x16x32_bf16 v[52:55], a[0:3], a[52:55], v[52:55]
v_mfma_f32_16x16x32_bf16 v[56:59], a[4:7], a[52:55], v[56:59]
v_mfma_f32_16x16x32_bf16 v[60:63], a[8:11], a[52:55], v[60:63]
v_mfma_f32_16x16x32_bf16 v[56:59], a[0:3], a[56:59], v[56:59]
v_mfma_f32_16x16x32_bf16 v[60:63], a[4:7], a[56:59], v[60:63]
v_mfma_f32_16x16x32_bf16 v[60:63], a[0:3], a[60:63], v[60:63]
s_waitcnt lgkmcnt(0)
v_mfma_f32_16x16x32_bf16 v[32:35], a[64:67], a[96:99], v[32:35]
ds_read_b128 a[32:35], v100 offset:3968
v_mfma_f32_16x16x32_bf16 v[36:39], a[68:71], a[96:99], v[36:39]
ds_read2_b32 a[0:1], v102 offset0:96 offset1:97
v_mfma_f32_16x16x32_bf16 v[40:43], a[72:75], a[96:99], v[40:43]
ds_read2_b32 a[2:3], v102 offset0:98 offset1:99
v_mfma_f32_16x16x32_bf16 v[44:47], a[76:79], a[96:99], v[44:47]
ds_read_b128 a[36:39], v100 offset:3456
s_add_u32 m0, s22, 28672
s_nop 0
buffer_load_dwordx4 v4, s[12:15], s21 offen offset:0  lds
v_mfma_f32_16x16x32_bf16 v[48:51], a[80:83], a[96:99], v[48:51]
ds_read2_b32 a[4:5], v102 offset0:224 offset1:225
v_mfma_f32_16x16x32_bf16 v[52:55], a[84:87], a[96:99], v[52:55]
ds_read2_b32 a[6:7], v102 offset0:226 offset1:227
v_mfma_f32_16x16x32_bf16 v[56:59], a[88:91], a[96:99], v[56:59]
ds_read_b128 a[40:43], v100 offset:2944
v_mfma_f32_16x16x32_bf16 v[60:63], a[92:95], a[96:99], v[60:63]
ds_read2_b32 a[8:9], v103 offset0:96 offset1:97
v_mfma_f32_16x16x32_bf16 v[36:39], a[64:67], a[100:103], v[36:39]
ds_read2_b32 a[10:11], v103 offset0:98 offset1:99
v_mfma_f32_16x16x32_bf16 v[40:43], a[68:71], a[100:103], v[40:43]
ds_read_b128 a[44:47], v100 offset:2432
v_mfma_f32_16x16x32_bf16 v[44:47], a[72:75], a[100:103], v[44:47]
ds_read2_b32 a[12:13], v103 offset0:224 offset1:225
v_mfma_f32_16x16x32_bf16 v[48:51], a[76:79], a[100:103], v[48:51]
ds_read2_b32 a[14:15], v103 offset0:226 offset1:227
v_mfma_f32_16x16x32_bf16 v[52:55], a[80:83], a[100:103], v[52:55]
ds_read_b128 a[48:51], v100 offset:1920
v_mfma_f32_16x16x32_bf16 v[56:59], a[84:87], a[100:103], v[56:59]
ds_read2_b32 a[16:17], v104 offset0:96 offset1:97
v_mfma_f32_16x16x32_bf16 v[60:63], a[88:91], a[100:103], v[60:63]
ds_read2_b32 a[18:19], v104 offset0:98 offset1:99
v_mfma_f32_16x16x32_bf16 v[40:43], a[64:67], a[104:107], v[40:43]
ds_read_b128 a[52:55], v100 offset:1408
v_mfma_f32_16x16x32_bf16 v[44:47], a[68:71], a[104:107], v[44:47]
ds_read2_b32 a[20:21], v104 offset0:224 offset1:225
v_mfma_f32_16x16x32_bf16 v[48:51], a[72:75], a[104:107], v[48:51]
ds_read2_b32 a[22:23], v104 offset0:226 offset1:227
v_mfma_f32_16x16x32_bf16 v[52:55], a[76:79], a[104:107], v[52:55]
ds_read_b128 a[56:59], v100 offset:896
v_mfma_f32_16x16x32_bf16 v[56:59], a[80:83], a[104:107], v[56:59]
ds_read2_b32 a[24:25], v105 offset0:96 offset1:97
buffer_load_dwordx4 v5, s[12:15], s21 offen offset:1024  lds
v_mfma_f32_16x16x32_bf16 v[60:63], a[84:87], a[104:107], v[60:63]
ds_read2_b32 a[26:27], v105 offset0:98 offset1:99
v_mfma_f32_16x16x32_bf16 v[44:47], a[64:67], a[108:111], v[44:47]
ds_read_b128 a[60:63], v100 offset:384
v_mfma_f32_16x16x32_bf16 v[48:51], a[68:71], a[108:111], v[48:51]
ds_read2_b32 a[28:29], v105 offset0:224 offset1:225
v_mfma_f32_16x16x32_bf16 v[52:55], a[72:75], a[108:111], v[52:55]
ds_read2_b32 a[30:31], v105 offset0:226 offset1:227
v_mfma_f32_16x16x32_bf16 v[56:59], a[76:79], a[108:111], v[56:59]
v_mfma_f32_16x16x32_bf16 v[60:63], a[80:83], a[108:111], v[60:63]
v_mfma_f32_16x16x32_bf16 v[48:51], a[64:67], a[112:115], v[48:51]
v_mfma_f32_16x16x32_bf16 v[52:55], a[68:71], a[112:115], v[52:55]
v_mfma_f32_16x16x32_bf16 v[56:59], a[72:75], a[112:115], v[56:59]
v_mfma_f32_16x16x32_bf16 v[60:63], a[76:79], a[112:115], v[60:63]
v_mfma_f32_16x16x32_bf16 v[52:55], a[64:67], a[116:119], v[52:55]
v_mfma_f32_16x16x32_bf16 v[56:59], a[68:71], a[116:119], v[56:59]
v_mfma_f32_16x16x32_bf16 v[60:63], a[72:75], a[116:119], v[60:63]
v_mfma_f32_16x16x32_bf16 v[56:59], a[64:67], a[120:123], v[56:59]
v_mfma_f32_16x16x32_bf16 v[60:63], a[68:71], a[120:123], v[60:63]
v_mfma_f32_16x16x32_bf16 v[60:63], a[64:67], a[124:127], v[60:63]
buffer_load_dwordx4 v6, s[12:15], s21 offen offset:2048  lds
s_waitcnt lgkmcnt(0)
v_mfma_f32_16x16x32_bf16 v[32:35], a[0:3], a[32:35], v[32:35]
ds_read_b128 a[96:99], v100 offset:4032
v_mfma_f32_16x16x32_bf16 v[36:39], a[4:7], a[32:35], v[36:39]
ds_read2_b32 a[64:65], v102 offset0:112 offset1:113
v_mfma_f32_16x16x32_bf16 v[40:43], a[8:11], a[32:35], v[40:43]
ds_read2_b32 a[66:67], v102 offset0:114 offset1:115
v_mfma_f32_16x16x32_bf16 v[44:47], a[12:15], a[32:35], v[44:47]
ds_read_b128 a[100:103], v100 offset:3520
v_mfma_f32_16x16x32_bf16 v[48:51], a[16:19], a[32:35], v[48:51]
ds_read2_b32 a[68:69], v102 offset0:240 offset1:241
v_mfma_f32_16x16x32_bf16 v[52:55], a[20:23], a[32:35], v[52:55]
ds_read2_b32 a[70:71], v102 offset0:242 offset1:243
v_mfma_f32_16x16x32_bf16 v[56:59], a[24:27], a[32:35], v[56:59]
ds_read_b128 a[104:107], v100 offset:3008
v_mfma_f32_16x16x32_bf16 v[60:63], a[28:31], a[32:35], v[60:63]
ds_read2_b32 a[72:73], v103 offset0:112 offset1:113
v_mfma_f32_16x16x32_bf16 v[36:39], a[0:3], a[36:39], v[36:39]
ds_read2_b32 a[74:75], v103 offset0:114 offset1:115
v_mfma_f32_16x16x32_bf16 v[40:43], a[4:7], a[36:39], v[40:43]
ds_read_b128 a[108:111], v100 offset:2496
v_mfma_f32_16x16x32_bf16 v[44:47], a[8:11], a[36:39], v[44:47]
ds_read2_b32 a[76:77], v103 offset0:240 offset1:241
v_mfma_f32_16x16x32_bf16 v[48:51], a[12:15], a[36:39], v[48:51]
ds_read2_b32 a[78:79], v103 offset0:242 offset1:243
v_mfma_f32_16x16x32_bf16 v[52:55], a[16:19], a[36:39], v[52:55]
ds_read_b128 a[112:115], v100 offset:1984
v_mfma_f32_16x16x32_bf16 v[56:59], a[20:23], a[36:39], v[56:59]
ds_read2_b32 a[80:81], v104 offset0:112 offset1:113
v_mfma_f32_16x16x32_bf16 v[60:63], a[24:27], a[36:39], v[60:63]
ds_read2_b32 a[82:83], v104 offset0:114 offset1:115
v_mfma_f32_16x16x32_bf16 v[40:43], a[0:3], a[40:43], v[40:43]
ds_read_b128 a[116:119], v100 offset:1472
buffer_load_dwordx4 v7, s[12:15], s21 offen offset:3072  lds
v_mfma_f32_16x16x32_bf16 v[44:47], a[4:7], a[40:43], v[44:47]
ds_read2_b32 a[84:85], v104 offset0:240 offset1:241
v_mfma_f32_16x16x32_bf16 v[48:51], a[8:11], a[40:43], v[48:51]
ds_read2_b32 a[86:87], v104 offset0:242 offset1:243
v_mfma_f32_16x16x32_bf16 v[52:55], a[12:15], a[40:43], v[52:55]
ds_read_b128 a[120:123], v100 offset:960
v_mfma_f32_16x16x32_bf16 v[56:59], a[16:19], a[40:43], v[56:59]
ds_read2_b32 a[88:89], v105 offset0:112 offset1:113
v_mfma_f32_16x16x32_bf16 v[60:63], a[20:23], a[40:43], v[60:63]
ds_read2_b32 a[90:91], v105 offset0:114 offset1:115
v_mfma_f32_16x16x32_bf16 v[44:47], a[0:3], a[44:47], v[44:47]
ds_read_b128 a[124:127], v100 offset:448
v_mfma_f32_16x16x32_bf16 v[48:51], a[4:7], a[44:47], v[48:51]
ds_read2_b32 a[92:93], v105 offset0:240 offset1:241
v_mfma_f32_16x16x32_bf16 v[52:55], a[8:11], a[44:47], v[52:55]
ds_read2_b32 a[94:95], v105 offset0:242 offset1:243
v_mfma_f32_16x16x32_bf16 v[56:59], a[12:15], a[44:47], v[56:59]
v_mfma_f32_16x16x32_bf16 v[60:63], a[16:19], a[44:47], v[60:63]
v_mfma_f32_16x16x32_bf16 v[48:51], a[0:3], a[48:51], v[48:51]
v_mfma_f32_16x16x32_bf16 v[52:55], a[4:7], a[48:51], v[52:55]
v_mfma_f32_16x16x32_bf16 v[56:59], a[8:11], a[48:51], v[56:59]
v_mfma_f32_16x16x32_bf16 v[60:63], a[12:15], a[48:51], v[60:63]
v_mfma_f32_16x16x32_bf16 v[52:55], a[0:3], a[52:55], v[52:55]
v_mfma_f32_16x16x32_bf16 v[56:59], a[4:7], a[52:55], v[56:59]
s_add_u32 m0, s22, 32768
s_nop 0
buffer_load_dwordx4 v8, s[12:15], s21 offen offset:0  lds
v_mfma_f32_16x16x32_bf16 v[60:63], a[8:11], a[52:55], v[60:63]
v_mfma_f32_16x16x32_bf16 v[56:59], a[0:3], a[56:59], v[56:59]
v_mfma_f32_16x16x32_bf16 v[60:63], a[4:7], a[56:59], v[60:63]
v_mfma_f32_16x16x32_bf16 v[60:63], a[0:3], a[60:63], v[60:63]
s_waitcnt lgkmcnt(0)
v_mfma_f32_16x16x32_bf16 v[32:35], a[64:67], a[96:99], v[32:35]
v_mfma_f32_16x16x32_bf16 v[36:39], a[68:71], a[96:99], v[36:39]
v_mfma_f32_16x16x32_bf16 v[40:43], a[72:75], a[96:99], v[40:43]
v_mfma_f32_16x16x32_bf16 v[44:47], a[76:79], a[96:99], v[44:47]
v_mfma_f32_16x16x32_bf16 v[48:51], a[80:83], a[96:99], v[48:51]
v_mfma_f32_16x16x32_bf16 v[52:55], a[84:87], a[96:99], v[52:55]
v_mfma_f32_16x16x32_bf16 v[56:59], a[88:91], a[96:99], v[56:59]
v_mfma_f32_16x16x32_bf16 v[60:63], a[92:95], a[96:99], v[60:63]
v_mfma_f32_16x16x32_bf16 v[36:39], a[64:67], a[100:103], v[36:39]
v_mfma_f32_16x16x32_bf16 v[40:43], a[68:71], a[100:103], v[40:43]
v_mfma_f32_16x16x32_bf16 v[44:47], a[72:75], a[100:103], v[44:47]
v_mfma_f32_16x16x32_bf16 v[48:51], a[76:79], a[100:103], v[48:51]
buffer_load_dwordx4 v9, s[12:15], s21 offen offset:1024  lds
v_mfma_f32_16x16x32_bf16 v[52:55], a[80:83], a[100:103], v[52:55]
v_mfma_f32_16x16x32_bf16 v[56:59], a[84:87], a[100:103], v[56:59]
v_mfma_f32_16x16x32_bf16 v[60:63], a[88:91], a[100:103], v[60:63]
v_mfma_f32_16x16x32_bf16 v[40:43], a[64:67], a[104:107], v[40:43]
v_mfma_f32_16x16x32_bf16 v[44:47], a[68:71], a[104:107], v[44:47]
v_mfma_f32_16x16x32_bf16 v[48:51], a[72:75], a[104:107], v[48:51]
v_mfma_f32_16x16x32_bf16 v[52:55], a[76:79], a[104:107], v[52:55]
v_mfma_f32_16x16x32_bf16 v[56:59], a[80:83], a[104:107], v[56:59]
v_mfma_f32_16x16x32_bf16 v[60:63], a[84:87], a[104:107], v[60:63]
v_mfma_f32_16x16x32_bf16 v[44:47], a[64:67], a[108:111], v[44:47]
v_mfma_f32_16x16x32_bf16 v[48:51], a[68:71], a[108:111], v[48:51]
v_mfma_f32_16x16x32_bf16 v[52:55], a[72:75], a[108:111], v[52:55]
v_mfma_f32_16x16x32_bf16 v[56:59], a[76:79], a[108:111], v[56:59]
v_mfma_f32_16x16x32_bf16 v[60:63], a[80:83], a[108:111], v[60:63]
v_mfma_f32_16x16x32_bf16 v[48:51], a[64:67], a[112:115], v[48:51]
v_mfma_f32_16x16x32_bf16 v[52:55], a[68:71], a[112:115], v[52:55]
buffer_load_dwordx4 v10, s[12:15], s21 offen offset:2048  lds
s_add_u32 s21, s68, s66
v_mfma_f32_16x16x32_bf16 v[56:59], a[72:75], a[112:115], v[56:59]
v_mfma_f32_16x16x32_bf16 v[60:63], a[76:79], a[112:115], v[60:63]
v_mfma_f32_16x16x32_bf16 v[52:55], a[64:67], a[116:119], v[52:55]
v_mfma_f32_16x16x32_bf16 v[56:59], a[68:71], a[116:119], v[56:59]
v_mfma_f32_16x16x32_bf16 v[60:63], a[72:75], a[116:119], v[60:63]
v_mfma_f32_16x16x32_bf16 v[56:59], a[64:67], a[120:123], v[56:59]
v_mfma_f32_16x16x32_bf16 v[60:63], a[68:71], a[120:123], v[60:63]
v_mfma_f32_16x16x32_bf16 v[60:63], a[64:67], a[124:127], v[60:63]
interleave_layers__ssm_conv_h3__geglu_ffn__prompt_kernel_cvend:
s_mul_i32 s34, s2, 16512
s_add_u32 s34, s34, 104857600
s_add_u32 s40, s24, s34
s_addc_u32 s41, s25, 0
s_mov_b32 s42, 16384
s_mov_b32 s43, 0x20000
s_mov_b32 s34, 0x05040100
s_mov_b32 s35, 0x07060302
s_nop 4
v_cvt_pk_bf16_f32 v80, v32, v33
v_cvt_pk_bf16_f32 v81, v34, v35
ds_write_b64 v107, v[80:81] offset:0
v_cvt_pk_bf16_f32 v82, v36, v37
v_cvt_pk_bf16_f32 v83, v38, v39
ds_write_b64 v107, v[82:83] offset:512
v_cvt_pk_bf16_f32 v84, v40, v41
v_cvt_pk_bf16_f32 v85, v42, v43
ds_write_b64 v107, v[84:85] offset:1024
v_cvt_pk_bf16_f32 v86, v44, v45
v_cvt_pk_bf16_f32 v87, v46, v47
ds_write_b64 v107, v[86:87] offset:1536
v_cvt_pk_bf16_f32 v88, v48, v49
v_cvt_pk_bf16_f32 v89, v50, v51
ds_write_b64 v107, v[88:89] offset:2048
v_cvt_pk_bf16_f32 v90, v52, v53
v_cvt_pk_bf16_f32 v91, v54, v55
ds_write_b64 v107, v[90:91] offset:2560
v_cvt_pk_bf16_f32 v92, v56, v57
v_cvt_pk_bf16_f32 v93, v58, v59
ds_write_b64 v107, v[92:93] offset:3072
v_cvt_pk_bf16_f32 v94, v60, v61
v_cvt_pk_bf16_f32 v95, v62, v63
ds_write_b64 v107, v[94:95] offset:3584
s_waitcnt lgkmcnt(0)
s_barrier
ds_read_b32 v64, v108 offset:0
ds_read_b32 v65, v108 offset:4096
ds_read_b32 v66, v108 offset:8192
ds_read_b32 v67, v108 offset:12288
ds_read_b32 v68, v108 offset:1024
ds_read_b32 v69, v108 offset:5120
ds_read_b32 v70, v108 offset:9216
ds_read_b32 v71, v108 offset:13312
ds_read_b32 v72, v108 offset:2048
ds_read_b32 v73, v108 offset:6144
ds_read_b32 v74, v108 offset:10240
ds_read_b32 v75, v108 offset:14336
ds_read_b32 v76, v108 offset:3072
ds_read_b32 v77, v108 offset:7168
ds_read_b32 v78, v108 offset:11264
ds_read_b32 v79, v108 offset:15360
s_waitcnt lgkmcnt(12)
v_perm_b32 v32, v65, v64, s34
v_perm_b32 v33, v67, v66, s34
v_perm_b32 v34, v65, v64, s35
v_perm_b32 v35, v67, v66, s35
s_mov_b32 s36, 0
buffer_store_dwordx4 v[32:35], v109, s[40:43], s36 offen sc1
s_waitcnt lgkmcnt(8)
v_perm_b32 v36, v69, v68, s34
v_perm_b32 v37, v71, v70, s34
v_perm_b32 v38, v69, v68, s35
v_perm_b32 v39, v71, v70, s35
s_mov_b32 s36, 4096
buffer_store_dwordx4 v[36:39], v109, s[40:43], s36 offen sc1
s_waitcnt lgkmcnt(4)
v_perm_b32 v40, v73, v72, s34
v_perm_b32 v41, v75, v74, s34
v_perm_b32 v42, v73, v72, s35
v_perm_b32 v43, v75, v74, s35
s_mov_b32 s36, 8192
buffer_store_dwordx4 v[40:43], v109, s[40:43], s36 offen sc1
s_waitcnt lgkmcnt(0)
v_perm_b32 v44, v77, v76, s34
v_perm_b32 v45, v79, v78, s34
v_perm_b32 v46, v77, v76, s35
v_perm_b32 v47, v79, v78, s35
s_mov_b32 s36, 12288
buffer_store_dwordx4 v[44:47], v109, s[40:43], s36 offen sc1
s_waitcnt vmcnt(18)
v_mov_b32 v64, v112
v_mov_b32 v65, v113
v_mov_b32 v66, v114
v_mov_b32 v67, v115
v_mov_b32 v68, v116
v_mov_b32 v69, v117
v_mov_b32 v70, v118
v_mov_b32 v71, v119
v_mov_b32 v72, v120
v_mov_b32 v73, v121
v_mov_b32 v74, v122
v_mov_b32 v75, v123
v_mov_b32 v76, v124
v_mov_b32 v77, v125
v_mov_b32 v78, v126
v_mov_b32 v79, v127
s_getpc_b64 s[50:51]
interleave_layers__ssm_conv_h3__geglu_ffn__prompt_kernel_pc:
s_add_u32 s50, s50, interleave_layers__ssm_conv_h3__geglu_ffn__prompt_kernel_stats-interleave_layers__ssm_conv_h3__geglu_ffn__prompt_kernel_pc
s_addc_u32 s51, s51, 0
v_lshlrev_b32 v15, 5, v16
v_add_u32 v15, 154112, v15
s_lshl_b32 s34, s26, 3
v_add_u32 v14, s34, v15
s_mov_b32 s38, 0x3f803f80
s_mov_b32 s39, 925353388
s_mov_b32 s48, 981467136
s_mov_b32 s44, s86
s_mov_b32 s45, s87
s_mov_b32 s46, 4194304
s_mov_b32 s47, 0x20000
v_mov_b32 v160, 0
v_mov_b32 v161, 0
v_mov_b32 v162, 0
v_mov_b32 v163, 0
v_dot2c_f32_bf16 v160, s38, v64
v_dot2c_f32_bf16 v161, v64, v64
v_dot2c_f32_bf16 v162, s38, v65
v_dot2c_f32_bf16 v163, v65, v65
v_dot2c_f32_bf16 v160, s38, v66
v_dot2c_f32_bf16 v161, v66, v66
v_dot2c_f32_bf16 v162, s38, v67
v_dot2c_f32_bf16 v163, v67, v67
v_dot2c_f32_bf16 v160, s38, v68
v_dot2c_f32_bf16 v161, v68, v68
v_dot2c_f32_bf16 v162, s38, v69
v_dot2c_f32_bf16 v163, v69, v69
v_dot2c_f32_bf16 v160, s38, v70
v_dot2c_f32_bf16 v161, v70, v70
v_dot2c_f32_bf16 v162, s38, v71
v_dot2c_f32_bf16 v163, v71, v71
v_dot2c_f32_bf16 v160, s38, v72
v_dot2c_f32_bf16 v161, v72, v72
v_dot2c_f32_bf16 v162, s38, v73
v_dot2c_f32_bf16 v163, v73, v73
v_dot2c_f32_bf16 v160, s38, v74
v_dot2c_f32_bf16 v161, v74, v74
v_dot2c_f32_bf16 v162, s38, v75
v_dot2c_f32_bf16 v163, v75, v75
v_dot2c_f32_bf16 v160, s38, v76
v_dot2c_f32_bf16 v161, v76, v76
v_dot2c_f32_bf16 v162, s38, v77
v_dot2c_f32_bf16 v163, v77, v77
v_dot2c_f32_bf16 v160, s38, v78
v_dot2c_f32_bf16 v161, v78, v78
v_dot2c_f32_bf16 v162, s38, v79
v_dot2c_f32_bf16 v163, v79, v79
s_swappc_b64 s[54:55], s[50:51]
v_lshlrev_b32 v19, 2, v18
v_add_u32 v19, v19, v17
v_mul_u32_u24 v19, 33024, v19
v_lshl_add_u32 v19, v16, 3, v19
v_add_u32 v20, 16512, v19
s_mul_i32 s34, s26, 1056768
s_lshl_b32 s35, s3, 6
s_add_u32 s34, s34, s35
s_add_u32 s35, s34, 264192
s_add_u32 s36, s34, 528384
s_add_u32 s37, s34, 792576
s_add_u32 s40, s24, 104857600
s_addc_u32 s41, s25, 0
s_mov_b32 s42, 4227072
s_mov_b32 s43, 0x20000
s_waitcnt vmcnt(0)
s_barrier
s_cmp_lg_u32 s26, 0
s_cbranch_scc1 interleave_layers__ssm_conv_h3__geglu_ffn__prompt_kernel_yw
s_and_b32 s98, s2, 15
s_lshl_b32 s98, s98, 7
s_add_u32 s98, s98, 57344
s_mov_b32 s99, 61440
v_mov_b32 v26, 0
v_mov_b32 v27, 1
s_mov_b64 exec, 1
buffer_atomic_add v27, v26, s[88:91], s98 offen sc0 sc1
s_waitcnt vmcnt(0)
v_readfirstlane_b32 s101, v27
s_cmp_lg_u32 s101, 15
s_cbranch_scc1 interleave_layers__ssm_conv_h3__geglu_ffn__prompt_kernel_yp
s_mov_b64 exec, -1
v_mov_b32 v27, 1
v_mul_u32_u24 v26, 10368, v31
s_and_b32 s99, s2, 15
s_lshr_b32 s101, s99, 3
s_lshl_b32 s101, s101, 7
s_and_b32 s99, s99, 7
s_add_u32 s99, s99, s101
s_add_u32 s99, s99, 147712
buffer_store_byte v27, v26, s[88:91], s99 offen sc1
s_add_u32 s99, s99, 663552
buffer_store_byte v27, v26, s[88:91], s99 offen sc1
s_add_u32 s99, s99, 663552
buffer_store_byte v27, v26, s[88:91], s99 offen sc1
s_add_u32 s99, s99, 663552
buffer_store_byte v27, v26, s[88:91], s99 offen sc1
interleave_layers__ssm_conv_h3__geglu_ffn__prompt_kernel_yp:
s_mov_b32 s101, 256
s_add_u32 vcc_lo, s74, s101
s_addc_u32 vcc_hi, s75, 0
s_mov_b32 s100, 0x200000
wpy:
s_load_dwordx2 s[92:93], vcc, 0 glc
s_load_dwordx2 s[94:95], vcc, 128 glc
s_waitcnt lgkmcnt(0)
s_and_b32 s92, s92, s93
s_and_b32 s92, s92, s94
s_and_b32 s92, s92, s95
s_cmp_eq_u32 s92, 0x01010101
s_cbranch_scc1 wdy
s_sleep 2
s_sub_u32 s100, s100, 1
s_cmp_lg_u32 s100, 0
s_cbranch_scc1 wpy
wdy:
interleave_layers__ssm_conv_h3__geglu_ffn__prompt_kernel_yd:
s_mov_b64 exec, -1
interleave_layers__ssm_conv_h3__geglu_ffn__prompt_kernel_yw:
v_lshlrev_b32 v32, 16, v64
v_and_b32 v33, 0xffff0000, v64
v_lshlrev_b32 v34, 16, v65
v_and_b32 v35, 0xffff0000, v65
v_lshlrev_b32 v36, 16, v66
v_and_b32 v37, 0xffff0000, v66
v_lshlrev_b32 v38, 16, v67
v_and_b32 v39, 0xffff0000, v67
v_lshlrev_b32 v40, 16, v68
v_and_b32 v41, 0xffff0000, v68
v_lshlrev_b32 v42, 16, v69
v_and_b32 v43, 0xffff0000, v69
v_lshlrev_b32 v44, 16, v70
v_and_b32 v45, 0xffff0000, v70
v_lshlrev_b32 v46, 16, v71
v_and_b32 v47, 0xffff0000, v71
v_lshlrev_b32 v48, 16, v72
v_and_b32 v49, 0xffff0000, v72
v_lshlrev_b32 v50, 16, v73
v_and_b32 v51, 0xffff0000, v73
v_lshlrev_b32 v52, 16, v74
v_and_b32 v53, 0xffff0000, v74
v_lshlrev_b32 v54, 16, v75
v_and_b32 v55, 0xffff0000, v75
v_lshlrev_b32 v56, 16, v76
v_and_b32 v57, 0xffff0000, v76
v_lshlrev_b32 v58, 16, v77
v_and_b32 v59, 0xffff0000, v77
v_lshlrev_b32 v60, 16, v78
v_and_b32 v61, 0xffff0000, v78
v_lshlrev_b32 v62, 16, v79
v_and_b32 v63, 0xffff0000, v79
s_barrier
buffer_load_dwordx2 v[80:81], v19, s[40:43], s34 offen
buffer_load_dwordx2 v[82:83], v20, s[40:43], s34 offen
buffer_load_dwordx2 v[84:85], v19, s[40:43], s35 offen
buffer_load_dwordx2 v[86:87], v20, s[40:43], s35 offen
buffer_load_dwordx2 v[88:89], v19, s[40:43], s36 offen
buffer_load_dwordx2 v[90:91], v20, s[40:43], s36 offen
buffer_load_dwordx2 v[92:93], v19, s[40:43], s37 offen
buffer_load_dwordx2 v[94:95], v20, s[40:43], s37 offen
s_waitcnt vmcnt(6)
v_lshlrev_b32 v176, 16, v80
v_and_b32 v177, 0xffff0000, v80
v_lshlrev_b32 v178, 16, v81
v_and_b32 v179, 0xffff0000, v81
v_lshlrev_b32 v180, 16, v82
v_and_b32 v181, 0xffff0000, v82
v_lshlrev_b32 v182, 16, v83
v_and_b32 v183, 0xffff0000, v83
s_waitcnt vmcnt(4)
v_lshlrev_b32 v184, 16, v84
v_and_b32 v185, 0xffff0000, v84
v_lshlrev_b32 v186, 16, v85
v_and_b32 v187, 0xffff0000, v85
v_lshlrev_b32 v188, 16, v86
v_and_b32 v189, 0xffff0000, v86
v_lshlrev_b32 v190, 16, v87
v_and_b32 v191, 0xffff0000, v87
s_waitcnt vmcnt(2)
v_lshlrev_b32 v192, 16, v88
v_and_b32 v193, 0xffff0000, v88
v_lshlrev_b32 v194, 16, v89
v_and_b32 v195, 0xffff0000, v89
v_lshlrev_b32 v196, 16, v90
v_and_b32 v197, 0xffff0000, v90
v_lshlrev_b32 v198, 16, v91
v_and_b32 v199, 0xffff0000, v91
s_waitcnt vmcnt(0)
v_lshlrev_b32 v200, 16, v92
v_and_b32 v201, 0xffff0000, v92
v_lshlrev_b32 v202, 16, v93
v_and_b32 v203, 0xffff0000, v93
v_lshlrev_b32 v204, 16, v94
v_and_b32 v205, 0xffff0000, v94
v_lshlrev_b32 v206, 16, v95
v_and_b32 v207, 0xffff0000, v95
s_branch interleave_layers__ssm_conv_h3__geglu_ffn__prompt_kernel_lngo2
interleave_layers__ssm_conv_h3__geglu_ffn__prompt_kernel_layer:
s_lshr_b32 s3, s2, 4
s_lshl_b32 s3, s3, 3
s_and_b32 s29, s2, 7
s_add_u32 s3, s3, s29
s_lshl_b32 s3, s3, 1
s_bfe_u32 s29, s2, 0x10003
s_add_u32 s3, s3, s29
v_and_b32 v16, 7, v31
v_bfe_u32 v17, v31, 3, 2
v_lshrrev_b32 v18, 5, v31
v_mul_u32_u24 v12, 4096, v18
v_lshl_add_u32 v12, v17, 7, v12
v_lshl_add_u32 v12, v16, 4, v12
s_lshr_b32 s29, s3, 3
s_lshl_b32 s29, s29, 2
s_add_u32 s29, s29, s26
s_mul_i32 s29, s29, 32768
s_bfe_u32 s30, s3, 0x20001
s_lshl_b32 s30, s30, 10
s_add_u32 s29, s29, s30
s_and_b32 s30, s3, 1
s_lshl_b32 s30, s30, 9
s_add_u32 s29, s29, s30
s_add_u32 s30, s29, 8192
s_add_u32 s31, s29, 16384
s_add_u32 s32, s29, 24576
v_lshlrev_b32 v13, 11, v16
v_lshl_add_u32 v13, v18, 6, v13
v_lshl_add_u32 v13, v17, 4, v13
s_lshl_b32 s33, s3, 14
s_lshl_b32 s34, s26, 9
s_add_u32 s33, s33, s34
s_lshr_b32 s34, s3, 4
s_add_u32 s34, s34, 24
s_lshl_b32 s34, s34, 10
s_add_u32 s8, s24, 20971520
s_addc_u32 s9, s25, 0
s_mov_b32 s10, 4194304
s_mov_b32 s11, 0x20000
s_add_u32 s40, s24, 27262976
s_addc_u32 s41, s25, 0
s_mov_b32 s42, 4194304
s_mov_b32 s43, 0x20000
s_and_b32 s27, s2, 1
s_lshl_b32 s27, s27, 2
s_lshr_b32 s28, s2, 3
s_and_b32 s34, s28, 3
s_add_u32 s27, s27, s34
s_bfe_u32 s34, s2, 0x20001
s_lshl_b32 s34, s34, 3
s_lshr_b32 s28, s28, 2
s_add_u32 s28, s28, s34
s_lshr_b32 s35, s26, 1
s_and_b32 s34, s26, 1
s_mul_i32 s21, s35, 229376
s_mul_i32 s22, s35, 14336
s_mul_i32 s36, s34, 7168
s_add_u32 s22, s22, s36
s_cmp_eq_u32 s34, 0
s_cselect_b32 s12, s4, s6
s_cselect_b32 s13, s5, s7
s_mul_i32 s35, s28, 224
s_add_u32 s12, s12, s35
s_addc_u32 s13, s13, 0
s_sub_u32 s14, 7340032, s35
s_mov_b32 s15, 0x20000
s_lshr_b32 s61, s2, 3
s_lshr_b32 s62, s61, 2
s_add_u32 s61, s61, s62
s_mul_i32 s61, s61, s60
s_add_u32 s62, s61, 0
s_and_b32 s62, s62, 3
s_mul_i32 s76, s62, 8192
s_mul_i32 s62, s62, 458752
s_add_u32 s64, s62, s21
s_add_u32 s62, s61, 1
s_and_b32 s62, s62, 3
s_mul_i32 s77, s62, 8192
s_mul_i32 s62, s62, 458752
s_add_u32 s65, s62, s21
s_add_u32 s62, s61, 2
s_and_b32 s62, s62, 3
s_mul_i32 s78, s62, 8192
s_mul_i32 s62, s62, 458752
s_add_u32 s66, s62, s21
s_add_u32 s62, s61, 3
s_and_b32 s62, s62, 3
s_mul_i32 s79, s62, 8192
s_mul_i32 s62, s62, 458752
s_add_u32 s67, s62, s21
s_mov_b32 s68, 0
s_mov_b32 s69, 0
s_mov_b32 s21, s64
s_mov_b32 s20, s76
s_cmp_eq_u32 s26, 0
s_cbranch_scc1 interleave_layers__ssm_conv_h3__geglu_ffn__prompt_kernel_nw0
s_add_u32 m0, s22, 0
s_nop 0
buffer_load_dwordx4 v4, s[12:15], s21 offen offset:0  lds
buffer_load_dwordx4 v5, s[12:15], s21 offen offset:1024  lds
buffer_load_dwordx4 v6, s[12:15], s21 offen offset:2048  lds
buffer_load_dwordx4 v7, s[12:15], s21 offen offset:3072  lds
s_add_u32 m0, s22, 4096
s_nop 0
buffer_load_dwordx4 v8, s[12:15], s21 offen offset:0  lds
buffer_load_dwordx4 v9, s[12:15], s21 offen offset:1024  lds
buffer_load_dwordx4 v10, s[12:15], s21 offen offset:2048  lds
s_add_u32 s21, s68, s65
s_add_u32 m0, s22, 28672
s_nop 0
buffer_load_dwordx4 v4, s[12:15], s21 offen offset:0  lds
buffer_load_dwordx4 v5, s[12:15], s21 offen offset:1024  lds
buffer_load_dwordx4 v6, s[12:15], s21 offen offset:2048  lds
buffer_load_dwordx4 v7, s[12:15], s21 offen offset:3072  lds
s_add_u32 m0, s22, 32768
s_nop 0
buffer_load_dwordx4 v8, s[12:15], s21 offen offset:0  lds
buffer_load_dwordx4 v9, s[12:15], s21 offen offset:1024  lds
buffer_load_dwordx4 v10, s[12:15], s21 offen offset:2048  lds
s_add_u32 s21, s68, s66
interleave_layers__ssm_conv_h3__geglu_ffn__prompt_kernel_nw0:
s_cmp_lg_u32 s26, 0
s_cbranch_scc1 wt3
s_mov_b32 s101, 3584
s_add_u32 vcc_lo, s74, s101
s_addc_u32 vcc_hi, s75, 0
s_mov_b32 s100, 0x200000
wp3:
s_load_dword s92, vcc, 0 glc
s_load_dword s93, vcc, 128 glc
s_load_dword s94, vcc, 256 glc
s_load_dword s95, vcc, 384 glc
s_waitcnt lgkmcnt(0)
s_and_b32 s92, s92, s93
s_and_b32 s92, s92, s94
s_and_b32 s92, s92, s95
s_cmp_eq_u32 s92, 0x01010101
s_cbranch_scc1 wd3
s_sleep 2
s_sub_u32 s100, s100, 1
s_cmp_lg_u32 s100, 0
s_cbranch_scc1 wp3
wd3:
wt3:
s_barrier
buffer_load_dwordx4 v[128:131], v12, s[8:11], s29 offen
buffer_load_dwordx4 v[144:147], v12, s[40:43], s29 offen
buffer_load_dwordx4 v[132:135], v12, s[8:11], s30 offen
buffer_load_dwordx4 v[148:151], v12, s[40:43], s30 offen
buffer_load_dwordx4 v[136:139], v12, s[8:11], s31 offen
buffer_load_dwordx4 v[152:155], v12, s[40:43], s31 offen
buffer_load_dwordx4 v[140:143], v12, s[8:11], s32 offen
buffer_load_dwordx4 v[156:159], v12, s[40:43], s32 offen
v_lshlrev_b32 v15, 5, v16
v_add_u32 v15, 154112, v15
s_lshl_b32 s34, s26, 3
v_add_u32 v14, s34, v15
s_mov_b32 s38, 0x3f803f80
s_mov_b32 s39, 925353388
s_mov_b32 s48, 981467136
s_mov_b32 s44, s86
s_mov_b32 s45, s87
s_mov_b32 s46, 4194304
s_mov_b32 s47, 0x20000
v_accvgpr_read_b32 v64, a192
v_accvgpr_read_b32 v65, a193
v_accvgpr_read_b32 v66, a194
v_accvgpr_read_b32 v67, a195
v_accvgpr_read_b32 v68, a196
v_accvgpr_read_b32 v69, a197
v_accvgpr_read_b32 v70, a198
v_accvgpr_read_b32 v71, a199
v_accvgpr_read_b32 v72, a200
v_accvgpr_read_b32 v73, a201
v_accvgpr_read_b32 v74, a202
v_accvgpr_read_b32 v75, a203
v_accvgpr_read_b32 v76, a204
v_accvgpr_read_b32 v77, a205
v_accvgpr_read_b32 v78, a206
v_accvgpr_read_b32 v79, a207
v_lshlrev_b32 v32, 16, v64
v_and_b32 v33, 0xffff0000, v64
v_lshlrev_b32 v34, 16, v65
v_and_b32 v35, 0xffff0000, v65
v_lshlrev_b32 v36, 16, v66
v_and_b32 v37, 0xffff0000, v66
v_lshlrev_b32 v38, 16, v67
v_and_b32 v39, 0xffff0000, v67
v_lshlrev_b32 v40, 16, v68
v_and_b32 v41, 0xffff0000, v68
v_lshlrev_b32 v42, 16, v69
v_and_b32 v43, 0xffff0000, v69
v_lshlrev_b32 v44, 16, v70
v_and_b32 v45, 0xffff0000, v70
v_lshlrev_b32 v46, 16, v71
v_and_b32 v47, 0xffff0000, v71
v_lshlrev_b32 v48, 16, v72
v_and_b32 v49, 0xffff0000, v72
v_lshlrev_b32 v50, 16, v73
v_and_b32 v51, 0xffff0000, v73
v_lshlrev_b32 v52, 16, v74
v_and_b32 v53, 0xffff0000, v74
v_lshlrev_b32 v54, 16, v75
v_and_b32 v55, 0xffff0000, v75
v_lshlrev_b32 v56, 16, v76
v_and_b32 v57, 0xffff0000, v76
v_lshlrev_b32 v58, 16, v77
v_and_b32 v59, 0xffff0000, v77
v_lshlrev_b32 v60, 16, v78
v_and_b32 v61, 0xffff0000, v78
v_lshlrev_b32 v62, 16, v79
v_and_b32 v63, 0xffff0000, v79
v_accvgpr_read_b32 v80, a208
v_accvgpr_read_b32 v81, a209
v_accvgpr_read_b32 v82, a210
v_accvgpr_read_b32 v83, a211
v_accvgpr_read_b32 v84, a212
v_accvgpr_read_b32 v85, a213
v_accvgpr_read_b32 v86, a214
v_accvgpr_read_b32 v87, a215
v_accvgpr_read_b32 v88, a216
v_accvgpr_read_b32 v89, a217
v_accvgpr_read_b32 v90, a218
v_accvgpr_read_b32 v91, a219
v_accvgpr_read_b32 v92, a220
v_accvgpr_read_b32 v93, a221
v_accvgpr_read_b32 v94, a222
v_accvgpr_read_b32 v95, a223
v_lshlrev_b32 v176, 16, v80
v_and_b32 v177, 0xffff0000, v80
v_lshlrev_b32 v178, 16, v81
v_and_b32 v179, 0xffff0000, v81
v_lshlrev_b32 v180, 16, v82
v_and_b32 v181, 0xffff0000, v82
v_lshlrev_b32 v182, 16, v83
v_and_b32 v183, 0xffff0000, v83
v_lshlrev_b32 v184, 16, v84
v_and_b32 v185, 0xffff0000, v84
v_lshlrev_b32 v186, 16, v85
v_and_b32 v187, 0xffff0000, v85
v_lshlrev_b32 v188, 16, v86
v_and_b32 v189, 0xffff0000, v86
v_lshlrev_b32 v190, 16, v87
v_and_b32 v191, 0xffff0000, v87
v_lshlrev_b32 v192, 16, v88
v_and_b32 v193, 0xffff0000, v88
v_lshlrev_b32 v194, 16, v89
v_and_b32 v195, 0xffff0000, v89
v_lshlrev_b32 v196, 16, v90
v_and_b32 v197, 0xffff0000, v90
v_lshlrev_b32 v198, 16, v91
v_and_b32 v199, 0xffff0000, v91
v_lshlrev_b32 v200, 16, v92
v_and_b32 v201, 0xffff0000, v92
v_lshlrev_b32 v202, 16, v93
v_and_b32 v203, 0xffff0000, v93
v_lshlrev_b32 v204, 16, v94
v_and_b32 v205, 0xffff0000, v94
v_lshlrev_b32 v206, 16, v95
v_and_b32 v207, 0xffff0000, v95
v_mov_b32 v160, 0
v_mov_b32 v161, 0
v_mov_b32 v162, 0
v_mov_b32 v163, 0
s_waitcnt vmcnt(6)
v_lshlrev_b32 v208, 16, v128
v_and_b32 v209, 0xffff0000, v128
v_lshlrev_b32 v216, 16, v144
v_and_b32 v217, 0xffff0000, v144
v_lshlrev_b32 v210, 16, v129
v_and_b32 v211, 0xffff0000, v129
v_lshlrev_b32 v218, 16, v145
v_and_b32 v219, 0xffff0000, v145
v_lshlrev_b32 v212, 16, v130
v_and_b32 v213, 0xffff0000, v130
v_lshlrev_b32 v220, 16, v146
v_and_b32 v221, 0xffff0000, v146
v_lshlrev_b32 v214, 16, v131
v_and_b32 v215, 0xffff0000, v131
v_lshlrev_b32 v222, 16, v147
v_and_b32 v223, 0xffff0000, v147
v_pk_add_f32 v[208:209], v[208:209], v[216:217]
v_pk_add_f32 v[210:211], v[210:211], v[218:219]
v_pk_add_f32 v[212:213], v[212:213], v[220:221]
v_pk_add_f32 v[214:215], v[214:215], v[222:223]
v_pk_add_f32 v[32:33], v[32:33], v[208:209]
v_pk_add_f32 v[34:35], v[34:35], v[210:211]
v_pk_add_f32 v[36:37], v[36:37], v[212:213]
v_pk_add_f32 v[38:39], v[38:39], v[214:215]
v_cvt_pk_bf16_f32 v64, v32, v33
v_cvt_pk_bf16_f32 v65, v34, v35
v_cvt_pk_bf16_f32 v66, v36, v37
v_cvt_pk_bf16_f32 v67, v38, v39
v_dot2c_f32_bf16 v160, s38, v64
v_dot2c_f32_bf16 v161, v64, v64
v_dot2c_f32_bf16 v162, s38, v65
v_dot2c_f32_bf16 v163, v65, v65
v_dot2c_f32_bf16 v160, s38, v66
v_dot2c_f32_bf16 v161, v66, v66
v_dot2c_f32_bf16 v162, s38, v67
v_dot2c_f32_bf16 v163, v67, v67
s_waitcnt vmcnt(4)
v_lshlrev_b32 v208, 16, v132
v_and_b32 v209, 0xffff0000, v132
v_lshlrev_b32 v216, 16, v148
v_and_b32 v217, 0xffff0000, v148
v_lshlrev_b32 v210, 16, v133
v_and_b32 v211, 0xffff0000, v133
v_lshlrev_b32 v218, 16, v149
v_and_b32 v219, 0xffff0000, v149
v_lshlrev_b32 v212, 16, v134
v_and_b32 v213, 0xffff0000, v134
v_lshlrev_b32 v220, 16, v150
v_and_b32 v221, 0xffff0000, v150
v_lshlrev_b32 v214, 16, v135
v_and_b32 v215, 0xffff0000, v135
v_lshlrev_b32 v222, 16, v151
v_and_b32 v223, 0xffff0000, v151
v_pk_add_f32 v[208:209], v[208:209], v[216:217]
v_pk_add_f32 v[210:211], v[210:211], v[218:219]
v_pk_add_f32 v[212:213], v[212:213], v[220:221]
v_pk_add_f32 v[214:215], v[214:215], v[222:223]
v_pk_add_f32 v[40:41], v[40:41], v[208:209]
v_pk_add_f32 v[42:43], v[42:43], v[210:211]
v_pk_add_f32 v[44:45], v[44:45], v[212:213]
v_pk_add_f32 v[46:47], v[46:47], v[214:215]
v_cvt_pk_bf16_f32 v68, v40, v41
v_cvt_pk_bf16_f32 v69, v42, v43
v_cvt_pk_bf16_f32 v70, v44, v45
v_cvt_pk_bf16_f32 v71, v46, v47
v_dot2c_f32_bf16 v160, s38, v68
v_dot2c_f32_bf16 v161, v68, v68
v_dot2c_f32_bf16 v162, s38, v69
v_dot2c_f32_bf16 v163, v69, v69
v_dot2c_f32_bf16 v160, s38, v70
v_dot2c_f32_bf16 v161, v70, v70
v_dot2c_f32_bf16 v162, s38, v71
v_dot2c_f32_bf16 v163, v71, v71
s_waitcnt vmcnt(2)
v_lshlrev_b32 v208, 16, v136
v_and_b32 v209, 0xffff0000, v136
v_lshlrev_b32 v216, 16, v152
v_and_b32 v217, 0xffff0000, v152
v_lshlrev_b32 v210, 16, v137
v_and_b32 v211, 0xffff0000, v137
v_lshlrev_b32 v218, 16, v153
v_and_b32 v219, 0xffff0000, v153
v_lshlrev_b32 v212, 16, v138
v_and_b32 v213, 0xffff0000, v138
v_lshlrev_b32 v220, 16, v154
v_and_b32 v221, 0xffff0000, v154
v_lshlrev_b32 v214, 16, v139
v_and_b32 v215, 0xffff0000, v139
v_lshlrev_b32 v222, 16, v155
v_and_b32 v223, 0xffff0000, v155
v_pk_add_f32 v[208:209], v[208:209], v[216:217]
v_pk_add_f32 v[210:211], v[210:211], v[218:219]
v_pk_add_f32 v[212:213], v[212:213], v[220:221]
v_pk_add_f32 v[214:215], v[214:215], v[222:223]
v_pk_add_f32 v[48:49], v[48:49], v[208:209]
v_pk_add_f32 v[50:51], v[50:51], v[210:211]
v_pk_add_f32 v[52:53], v[52:53], v[212:213]
v_pk_add_f32 v[54:55], v[54:55], v[214:215]
v_cvt_pk_bf16_f32 v72, v48, v49
v_cvt_pk_bf16_f32 v73, v50, v51
v_cvt_pk_bf16_f32 v74, v52, v53
v_cvt_pk_bf16_f32 v75, v54, v55
v_dot2c_f32_bf16 v160, s38, v72
v_dot2c_f32_bf16 v161, v72, v72
v_dot2c_f32_bf16 v162, s38, v73
v_dot2c_f32_bf16 v163, v73, v73
v_dot2c_f32_bf16 v160, s38, v74
v_dot2c_f32_bf16 v161, v74, v74
v_dot2c_f32_bf16 v162, s38, v75
v_dot2c_f32_bf16 v163, v75, v75
s_waitcnt vmcnt(0)
v_lshlrev_b32 v208, 16, v140
v_and_b32 v209, 0xffff0000, v140
v_lshlrev_b32 v216, 16, v156
v_and_b32 v217, 0xffff0000, v156
v_lshlrev_b32 v210, 16, v141
v_and_b32 v211, 0xffff0000, v141
v_lshlrev_b32 v218, 16, v157
v_and_b32 v219, 0xffff0000, v157
v_lshlrev_b32 v212, 16, v142
v_and_b32 v213, 0xffff0000, v142
v_lshlrev_b32 v220, 16, v158
v_and_b32 v221, 0xffff0000, v158
v_lshlrev_b32 v214, 16, v143
v_and_b32 v215, 0xffff0000, v143
v_lshlrev_b32 v222, 16, v159
v_and_b32 v223, 0xffff0000, v159
v_pk_add_f32 v[208:209], v[208:209], v[216:217]
v_pk_add_f32 v[210:211], v[210:211], v[218:219]
v_pk_add_f32 v[212:213], v[212:213], v[220:221]
v_pk_add_f32 v[214:215], v[214:215], v[222:223]
v_pk_add_f32 v[56:57], v[56:57], v[208:209]
v_pk_add_f32 v[58:59], v[58:59], v[210:211]
v_pk_add_f32 v[60:61], v[60:61], v[212:213]
v_pk_add_f32 v[62:63], v[62:63], v[214:215]
v_cvt_pk_bf16_f32 v76, v56, v57
v_cvt_pk_bf16_f32 v77, v58, v59
v_cvt_pk_bf16_f32 v78, v60, v61
v_cvt_pk_bf16_f32 v79, v62, v63
v_dot2c_f32_bf16 v160, s38, v76
v_dot2c_f32_bf16 v161, v76, v76
v_dot2c_f32_bf16 v162, s38, v77
v_dot2c_f32_bf16 v163, v77, v77
v_dot2c_f32_bf16 v160, s38, v78
v_dot2c_f32_bf16 v161, v78, v78
v_dot2c_f32_bf16 v162, s38, v79
v_dot2c_f32_bf16 v163, v79, v79
s_cmp_lg_u32 s26, 0
s_cbranch_scc1 interleave_layers__ssm_conv_h3__geglu_ffn__prompt_kernel_nw1
s_add_u32 m0, s22, 0
s_nop 0
buffer_load_dwordx4 v4, s[12:15], s21 offen offset:0  lds
buffer_load_dwordx4 v5, s[12:15], s21 offen offset:1024  lds
buffer_load_dwordx4 v6, s[12:15], s21 offen offset:2048  lds
buffer_load_dwordx4 v7, s[12:15], s21 offen offset:3072  lds
s_add_u32 m0, s22, 4096
s_nop 0
buffer_load_dwordx4 v8, s[12:15], s21 offen offset:0  lds
buffer_load_dwordx4 v9, s[12:15], s21 offen offset:1024  lds
buffer_load_dwordx4 v10, s[12:15], s21 offen offset:2048  lds
s_add_u32 s21, s68, s65
s_add_u32 m0, s22, 28672
s_nop 0
buffer_load_dwordx4 v4, s[12:15], s21 offen offset:0  lds
buffer_load_dwordx4 v5, s[12:15], s21 offen offset:1024  lds
buffer_load_dwordx4 v6, s[12:15], s21 offen offset:2048  lds
buffer_load_dwordx4 v7, s[12:15], s21 offen offset:3072  lds
s_add_u32 m0, s22, 32768
s_nop 0
buffer_load_dwordx4 v8, s[12:15], s21 offen offset:0  lds
buffer_load_dwordx4 v9, s[12:15], s21 offen offset:1024  lds
buffer_load_dwordx4 v10, s[12:15], s21 offen offset:2048  lds
s_add_u32 s21, s68, s66
interleave_layers__ssm_conv_h3__geglu_ffn__prompt_kernel_nw1:
interleave_layers__ssm_conv_h3__geglu_ffn__prompt_kernel_lngo:
s_swappc_b64 s[54:55], s[50:51]
interleave_layers__ssm_conv_h3__geglu_ffn__prompt_kernel_lngo2:
v_pk_fma_f32 v[208:209], v[32:33], v[162:163], v[160:161] op_sel_hi:[1,0,0]
v_pk_fma_f32 v[210:211], v[34:35], v[162:163], v[160:161] op_sel_hi:[1,0,0]
v_pk_fma_f32 v[212:213], v[36:37], v[162:163], v[160:161] op_sel_hi:[1,0,0]
v_pk_fma_f32 v[214:215], v[38:39], v[162:163], v[160:161] op_sel_hi:[1,0,0]
v_pk_fma_f32 v[216:217], v[40:41], v[162:163], v[160:161] op_sel_hi:[1,0,0]
v_pk_fma_f32 v[218:219], v[42:43], v[162:163], v[160:161] op_sel_hi:[1,0,0]
v_pk_fma_f32 v[220:221], v[44:45], v[162:163], v[160:161] op_sel_hi:[1,0,0]
v_pk_fma_f32 v[222:223], v[46:47], v[162:163], v[160:161] op_sel_hi:[1,0,0]
v_pk_fma_f32 v[224:225], v[48:49], v[162:163], v[160:161] op_sel_hi:[1,0,0]
v_pk_fma_f32 v[226:227], v[50:51], v[162:163], v[160:161] op_sel_hi:[1,0,0]
v_pk_fma_f32 v[228:229], v[52:53], v[162:163], v[160:161] op_sel_hi:[1,0,0]
v_pk_fma_f32 v[230:231], v[54:55], v[162:163], v[160:161] op_sel_hi:[1,0,0]
v_pk_fma_f32 v[232:233], v[56:57], v[162:163], v[160:161] op_sel_hi:[1,0,0]
v_pk_fma_f32 v[234:235], v[58:59], v[162:163], v[160:161] op_sel_hi:[1,0,0]
v_pk_fma_f32 v[236:237], v[60:61], v[162:163], v[160:161] op_sel_hi:[1,0,0]
v_pk_fma_f32 v[238:239], v[62:63], v[162:163], v[160:161] op_sel_hi:[1,0,0]
v_pk_fma_f32 v[32:33], v[208:209], v[176:177], v[32:33]
v_pk_fma_f32 v[34:35], v[210:211], v[178:179], v[34:35]
v_pk_fma_f32 v[36:37], v[212:213], v[180:181], v[36:37]
v_pk_fma_f32 v[38:39], v[214:215], v[182:183], v[38:39]
v_pk_fma_f32 v[40:41], v[216:217], v[184:185], v[40:41]
v_pk_fma_f32 v[42:43], v[218:219], v[186:187], v[42:43]
v_pk_fma_f32 v[44:45], v[220:221], v[188:189], v[44:45]
v_pk_fma_f32 v[46:47], v[222:223], v[190:191], v[46:47]
v_pk_fma_f32 v[48:49], v[224:225], v[192:193], v[48:49]
v_pk_fma_f32 v[50:51], v[226:227], v[194:195], v[50:51]
v_pk_fma_f32 v[52:53], v[228:229], v[196:197], v[52:53]
v_pk_fma_f32 v[54:55], v[230:231], v[198:199], v[54:55]
v_pk_fma_f32 v[56:57], v[232:233], v[200:201], v[56:57]
v_pk_fma_f32 v[58:59], v[234:235], v[202:203], v[58:59]
v_pk_fma_f32 v[60:61], v[236:237], v[204:205], v[60:61]
v_pk_fma_f32 v[62:63], v[238:239], v[206:207], v[62:63]
v_mov_b32 v160, 0
v_mov_b32 v161, 0
v_mov_b32 v162, 0
v_mov_b32 v163, 0
v_cvt_pk_bf16_f32 v64, v32, v33
v_cvt_pk_bf16_f32 v65, v34, v35
v_cvt_pk_bf16_f32 v66, v36, v37
v_cvt_pk_bf16_f32 v67, v38, v39
v_cvt_pk_bf16_f32 v68, v40, v41
v_cvt_pk_bf16_f32 v69, v42, v43
v_cvt_pk_bf16_f32 v70, v44, v45
v_cvt_pk_bf16_f32 v71, v46, v47
v_cvt_pk_bf16_f32 v72, v48, v49
v_cvt_pk_bf16_f32 v73, v50, v51
v_cvt_pk_bf16_f32 v74, v52, v53
v_cvt_pk_bf16_f32 v75, v54, v55
v_cvt_pk_bf16_f32 v76, v56, v57
v_cvt_pk_bf16_f32 v77, v58, v59
v_cvt_pk_bf16_f32 v78, v60, v61
v_cvt_pk_bf16_f32 v79, v62, v63
s_add_u32 s16, s86, 33554432
s_addc_u32 s17, s87, 0
s_sub_u32 s18, 1, s60
s_mul_i32 s18, s18, 4194304
s_mov_b32 s19, 0x20000
buffer_store_dwordx4 v[64:67], v12, s[16:19], s29 offen sc1
buffer_store_dwordx4 v[68:71], v12, s[16:19], s30 offen sc1
buffer_store_dwordx4 v[72:75], v12, s[16:19], s31 offen sc1
buffer_store_dwordx4 v[76:79], v12, s[16:19], s32 offen sc1
v_dot2c_f32_bf16 v160, s38, v64
v_dot2c_f32_bf16 v161, v64, v64
v_dot2c_f32_bf16 v162, s38, v65
v_dot2c_f32_bf16 v163, v65, v65
v_dot2c_f32_bf16 v160, s38, v66
v_dot2c_f32_bf16 v161, v66, v66
v_dot2c_f32_bf16 v162, s38, v67
v_dot2c_f32_bf16 v163, v67, v67
v_dot2c_f32_bf16 v160, s38, v68
v_dot2c_f32_bf16 v161, v68, v68
v_dot2c_f32_bf16 v162, s38, v69
v_dot2c_f32_bf16 v163, v69, v69
v_dot2c_f32_bf16 v160, s38, v70
v_dot2c_f32_bf16 v161, v70, v70
v_dot2c_f32_bf16 v162, s38, v71
v_dot2c_f32_bf16 v163, v71, v71
v_dot2c_f32_bf16 v160, s38, v72
v_dot2c_f32_bf16 v161, v72, v72
v_dot2c_f32_bf16 v162, s38, v73
v_dot2c_f32_bf16 v163, v73, v73
v_dot2c_f32_bf16 v160, s38, v74
v_dot2c_f32_bf16 v161, v74, v74
v_dot2c_f32_bf16 v162, s38, v75
v_dot2c_f32_bf16 v163, v75, v75
v_dot2c_f32_bf16 v160, s38, v76
v_dot2c_f32_bf16 v161, v76, v76
v_dot2c_f32_bf16 v162, s38, v77
v_dot2c_f32_bf16 v163, v77, v77
v_dot2c_f32_bf16 v160, s38, v78
v_dot2c_f32_bf16 v161, v78, v78
v_dot2c_f32_bf16 v162, s38, v79
v_dot2c_f32_bf16 v163, v79, v79
v_add_u32 v14, 256, v14
v_add_u32 v15, 256, v15
s_swappc_b64 s[54:55], s[50:51]
v_pk_fma_f32 v[208:209], v[32:33], v[162:163], v[160:161] op_sel_hi:[1,0,0]
v_pk_fma_f32 v[210:211], v[34:35], v[162:163], v[160:161] op_sel_hi:[1,0,0]
v_pk_fma_f32 v[212:213], v[36:37], v[162:163], v[160:161] op_sel_hi:[1,0,0]
v_pk_fma_f32 v[214:215], v[38:39], v[162:163], v[160:161] op_sel_hi:[1,0,0]
v_cvt_pk_bf16_f32 v128, v208, v209
v_cvt_pk_bf16_f32 v129, v210, v211
v_cvt_pk_bf16_f32 v130, v212, v213
v_cvt_pk_bf16_f32 v131, v214, v215
buffer_store_dwordx4 v[128:131], v12, s[44:47], s29 offen sc1
v_pk_fma_f32 v[216:217], v[40:41], v[162:163], v[160:161] op_sel_hi:[1,0,0]
v_pk_fma_f32 v[218:219], v[42:43], v[162:163], v[160:161] op_sel_hi:[1,0,0]
v_pk_fma_f32 v[220:221], v[44:45], v[162:163], v[160:161] op_sel_hi:[1,0,0]
v_pk_fma_f32 v[222:223], v[46:47], v[162:163], v[160:161] op_sel_hi:[1,0,0]
v_cvt_pk_bf16_f32 v132, v216, v217
v_cvt_pk_bf16_f32 v133, v218, v219
v_cvt_pk_bf16_f32 v134, v220, v221
v_cvt_pk_bf16_f32 v135, v222, v223
buffer_store_dwordx4 v[132:135], v12, s[44:47], s30 offen sc1
v_pk_fma_f32 v[224:225], v[48:49], v[162:163], v[160:161] op_sel_hi:[1,0,0]
v_pk_fma_f32 v[226:227], v[50:51], v[162:163], v[160:161] op_sel_hi:[1,0,0]
v_pk_fma_f32 v[228:229], v[52:53], v[162:163], v[160:161] op_sel_hi:[1,0,0]
v_pk_fma_f32 v[230:231], v[54:55], v[162:163], v[160:161] op_sel_hi:[1,0,0]
v_cvt_pk_bf16_f32 v136, v224, v225
v_cvt_pk_bf16_f32 v137, v226, v227
v_cvt_pk_bf16_f32 v138, v228, v229
v_cvt_pk_bf16_f32 v139, v230, v231
buffer_store_dwordx4 v[136:139], v12, s[44:47], s31 offen sc1
v_pk_fma_f32 v[232:233], v[56:57], v[162:163], v[160:161] op_sel_hi:[1,0,0]
v_pk_fma_f32 v[234:235], v[58:59], v[162:163], v[160:161] op_sel_hi:[1,0,0]
v_pk_fma_f32 v[236:237], v[60:61], v[162:163], v[160:161] op_sel_hi:[1,0,0]
v_pk_fma_f32 v[238:239], v[62:63], v[162:163], v[160:161] op_sel_hi:[1,0,0]
v_cvt_pk_bf16_f32 v140, v232, v233
v_cvt_pk_bf16_f32 v141, v234, v235
v_cvt_pk_bf16_f32 v142, v236, v237
v_cvt_pk_bf16_f32 v143, v238, v239
buffer_store_dwordx4 v[140:143], v12, s[44:47], s32 offen sc1
v_accvgpr_write_b32 a192, v64
v_accvgpr_write_b32 a208, v80
v_accvgpr_write_b32 a193, v65
v_accvgpr_write_b32 a209, v81
v_accvgpr_write_b32 a194, v66
v_accvgpr_write_b32 a210, v82
v_accvgpr_write_b32 a195, v67
v_accvgpr_write_b32 a211, v83
v_accvgpr_write_b32 a196, v68
v_accvgpr_write_b32 a212, v84
v_accvgpr_write_b32 a197, v69
v_accvgpr_write_b32 a213, v85
v_accvgpr_write_b32 a198, v70
v_accvgpr_write_b32 a214, v86
v_accvgpr_write_b32 a199, v71
v_accvgpr_write_b32 a215, v87
v_accvgpr_write_b32 a200, v72
v_accvgpr_write_b32 a216, v88
v_accvgpr_write_b32 a201, v73
v_accvgpr_write_b32 a217, v89
v_accvgpr_write_b32 a202, v74
v_accvgpr_write_b32 a218, v90
v_accvgpr_write_b32 a203, v75
v_accvgpr_write_b32 a219, v91
v_accvgpr_write_b32 a204, v76
v_accvgpr_write_b32 a220, v92
v_accvgpr_write_b32 a205, v77
v_accvgpr_write_b32 a221, v93
v_accvgpr_write_b32 a206, v78
v_accvgpr_write_b32 a222, v94
v_accvgpr_write_b32 a207, v79
v_accvgpr_write_b32 a223, v95
s_lshr_b32 s49, s3, 5
s_add_u32 s49, s49, 0
s_lshl_b32 s49, s49, 10
s_add_u32 s49, s49, s85
s_lshl_b32 s34, s27, 2
s_add_u32 s34, s34, s26
s_mul_i32 s34, s34, 131072
s_add_u32 s34, s34, 0
s_add_u32 s8, s86, s34
s_addc_u32 s9, s87, 0
s_mov_b32 s10, 131072
s_mov_b32 s11, 0x20000
s_add_u32 s16, s86, 5242880
s_addc_u32 s17, s87, 0
s_mov_b32 s18, 14680064
s_mov_b32 s19, 0x20000
s_mov_b32 s36, 3184710632
s_mov_b32 s37, 3184710632
s_lshl_b32 s29, s27, 1
s_lshr_b32 s30, s26, 1
s_add_u32 s29, s29, s30
s_mul_i32 s29, s29, 917504
s_and_b32 s30, s26, 1
s_lshl_b32 s30, s30, 12
s_add_u32 s29, s29, s30
s_mul_i32 s30, s28, 7
s_and_b32 s31, s28, 1
s_add_u32 s30, s30, s31
s_lshl_b32 s30, s30, 12
s_add_u32 s38, s29, s30
s_lshr_b32 s30, s28, 1
s_mul_i32 s30, s30, 7
s_add_u32 s30, s30, 3
s_lshl_b32 s30, s30, 13
s_lshl_b32 s31, s31, 9
s_add_u32 s39, s29, s30
s_add_u32 s39, s39, s31
s_add_u32 s61, s38, 8192
s_add_u32 s62, s38, 16384
s_lshr_b32 s30, s2, 4
s_mul_i32 s30, s30, 458752
s_and_b32 s31, s2, 15
s_lshl_b32 s31, s31, 7
s_add_u32 s30, s30, s31
s_lshl_b32 s31, s26, 14
s_add_u32 s30, s30, s31
s_add_u32 s56, s52, s30
s_addc_u32 s57, s53, 0
s_mul_i32 s58, s60, 407680
s_mov_b32 s59, 0x20000
s_mov_b32 s70, 0
s_lshl_b32 s71, s26, 10
s_add_u32 s71, s71, 114688
s_add_u32 s72, s71, 28672
s_add_u32 s40, s24, 33554432
s_addc_u32 s41, s25, 0
s_mov_b32 s42, 7340032
s_mov_b32 s43, 0x20000
s_and_b32 s30, s2, 15
s_mul_i32 s30, s30, 112
s_lshr_b32 s31, s2, 4
s_mul_i32 s31, s31, 7
s_add_u32 s30, s30, s31
s_lshl_b32 s30, s30, 2
s_add_u32 s30, s30, s26
s_lshl_b32 s44, s30, 10
s_bfe_u32 s45, s2, 0x30001
s_lshl_b32 s45, s45, 1
s_lshr_b32 s30, s2, 7
s_add_u32 s45, s45, s30
s_add_u32 s45, s45, 40
s_lshl_b32 s45, s45, 10
s_lshl_b32 s46, s27, 1
s_lshr_b32 s30, s28, 4
s_add_u32 s46, s46, s30
s_add_u32 s46, s46, 8
s_lshl_b32 s46, s46, 10
s_add_u32 s46, s46, s85
s_add_u32 s47, s27, 0
s_lshl_b32 s47, s47, 10
s_add_u32 s47, s47, s85
s_lshr_b32 s30, s3, 5
s_lshr_b32 s31, s30, 2
s_and_b32 s30, s30, 3
s_lshl_b32 s30, s30, 3
s_add_u32 s30, s30, s31
s_mul_i32 s49, s30, 10368
s_and_b32 s30, s3, 31
s_lshr_b32 s101, s30, 2
s_lshl_b32 s101, s101, 7
s_and_b32 s30, s30, 3
s_add_u32 s30, s30, s101
s_add_u32 s49, s49, s30
s_add_u32 s49, s49, 149504
s_add_u32 s49, s49, s85
s_lshr_b32 s30, s28, 4
s_and_b32 s31, s27, 6
s_add_u32 s30, s30, s31
s_and_b32 s31, s27, 1
s_lshl_b32 s31, s31, 4
s_add_u32 s30, s30, s31
s_mul_i32 s46, s30, 10368
s_and_b32 s30, s28, 15
s_lshr_b32 s101, s30, 2
s_lshl_b32 s101, s101, 7
s_and_b32 s30, s30, 3
s_add_u32 s30, s30, s101
s_add_u32 s46, s46, s30
s_add_u32 s46, s46, 150528
s_add_u32 s46, s46, s85
s_lshr_b32 s30, s2, 7
s_bfe_u32 s31, s2, 0x30001
s_lshl_b32 s31, s31, 5
s_add_u32 s30, s30, s31
s_mul_i32 s45, s30, 10368
s_bfe_u32 s30, s2, 0x30004
s_lshl_b32 s30, s30, 1
s_and_b32 s31, s2, 1
s_add_u32 s30, s30, s31
s_lshr_b32 s101, s30, 2
s_lshl_b32 s101, s101, 7
s_and_b32 s30, s30, 3
s_add_u32 s30, s30, s101
s_add_u32 s45, s45, s30
s_add_u32 s45, s45, 148992
v_lshrrev_b32 v26, 3, v31
v_lshlrev_b32 v26, 1, v26
v_and_b32 v27, 7, v31
v_lshl_add_u32 v26, v27, 5, v26
v_mul_u32_u24 v26, 10368, v26
v_mov_b32 v27, 1
s_waitcnt vmcnt(0)
s_barrier
s_cmp_lg_u32 s26, 0
s_cbranch_scc1 sig4
s_mov_b64 exec, 0xffffffff
buffer_store_byte v27, v26, s[88:91], s49 offen sc1
s_mov_b64 exec, -1
sig4:
ds_read_b64_tr_b16 a[128:129], v1 offset:0
ds_read_b64_tr_b16 a[130:131], v1 offset:3584
ds_read_b64_tr_b16 a[132:133], v1 offset:7168
ds_read_b64_tr_b16 a[134:135], v1 offset:10752
ds_read_b64_tr_b16 a[136:137], v1 offset:32
ds_read_b64_tr_b16 a[138:139], v1 offset:3616
ds_read_b64_tr_b16 a[140:141], v1 offset:7200
ds_read_b64_tr_b16 a[142:143], v1 offset:10784
s_cmp_lg_u32 s26, 0
s_cbranch_scc1 wt5
s_add_u32 s101, s85, 2048
s_add_u32 vcc_lo, s74, s101
s_addc_u32 vcc_hi, s75, 0
s_mov_b32 s100, 0x200000
wp5:
s_load_dword s92, vcc, 0 glc
s_load_dword s93, vcc, 128 glc
s_load_dword s94, vcc, 256 glc
s_load_dword s95, vcc, 384 glc
s_load_dword s96, vcc, 512 glc
s_load_dword s97, vcc, 640 glc
s_load_dword s98, vcc, 768 glc
s_load_dword s99, vcc, 896 glc
s_waitcnt lgkmcnt(0)
s_and_b32 s92, s92, s93
s_and_b32 s92, s92, s94
s_and_b32 s92, s92, s95
s_and_b32 s92, s92, s96
s_and_b32 s92, s92, s97
s_and_b32 s92, s92, s98
s_and_b32 s92, s92, s99
s_cmp_eq_u32 s92, 0x01010101
s_cbranch_scc1 wd5
s_sleep 2
s_sub_u32 s100, s100, 1
s_cmp_lg_u32 s100, 0
s_cbranch_scc1 wp5
wd5:
wt5:
s_barrier
buffer_load_dwordx4 a[0:3], v22, s[8:11], s20 offen offset:0
buffer_load_dwordx4 a[4:7], v22, s[8:11], s20 offen offset:1024
buffer_load_dwordx4 a[8:11], v22, s[8:11], s20 offen offset:2048
buffer_load_dwordx4 a[12:15], v22, s[8:11], s20 offen offset:3072
s_add_u32 s20, s20, 4096
buffer_load_dwordx4 a[16:19], v22, s[8:11], s20 offen offset:0
buffer_load_dwordx4 a[20:23], v22, s[8:11], s20 offen offset:1024
buffer_load_dwordx4 a[24:27], v22, s[8:11], s20 offen offset:2048
buffer_load_dwordx4 a[28:31], v22, s[8:11], s20 offen offset:3072
s_add_u32 s20, s69, s77
s_waitcnt vmcnt(4) lgkmcnt(4)
v_mfma_f32_16x16x32_bf16 v[32:35], a[128:131], a[0:3], 0
ds_read_b64_tr_b16 a[144:145], v1 offset:64
v_mfma_f32_16x16x32_bf16 v[48:51], a[132:135], a[0:3], 0
ds_read_b64_tr_b16 a[146:147], v1 offset:3648
v_mfma_f32_16x16x32_bf16 v[52:55], a[132:135], a[4:7], 0
buffer_load_dwordx4 a[32:35], v22, s[8:11], s20 offen offset:0
v_mfma_f32_16x16x32_bf16 v[36:39], a[128:131], a[4:7], 0
v_mfma_f32_16x16x32_bf16 v[40:43], a[128:131], a[8:11], 0
ds_read_b64_tr_b16 a[148:149], v1 offset:7232
v_mfma_f32_16x16x32_bf16 v[56:59], a[132:135], a[8:11], 0
ds_read_b64_tr_b16 a[150:151], v1 offset:10816
v_mfma_f32_16x16x32_bf16 v[60:63], a[132:135], a[12:15], 0
buffer_load_dwordx4 a[36:39], v22, s[8:11], s20 offen offset:1024
v_mfma_f32_16x16x32_bf16 v[44:47], a[128:131], a[12:15], 0
s_waitcnt lgkmcnt(4)
v_mfma_f32_16x16x32_bf16 v[76:79], a[136:139], a[12:15], 0
ds_read_b64_tr_b16 a[152:153], v1 offset:96
v_mfma_f32_16x16x32_bf16 v[92:95], a[140:143], a[12:15], 0
ds_read_b64_tr_b16 a[154:155], v1 offset:3680
v_mfma_f32_16x16x32_bf16 v[88:91], a[140:143], a[8:11], 0
buffer_load_dwordx4 a[40:43], v22, s[8:11], s20 offen offset:2048
v_mfma_f32_16x16x32_bf16 v[72:75], a[136:139], a[8:11], 0
v_mfma_f32_16x16x32_bf16 v[68:71], a[136:139], a[4:7], 0
ds_read_b64_tr_b16 a[156:157], v1 offset:7264
v_mfma_f32_16x16x32_bf16 v[84:87], a[140:143], a[4:7], 0
ds_read_b64_tr_b16 a[158:159], v1 offset:10848
v_mfma_f32_16x16x32_bf16 v[80:83], a[140:143], a[0:3], 0
buffer_load_dwordx4 a[44:47], v22, s[8:11], s20 offen offset:3072
s_add_u32 s20, s20, 4096
v_mfma_f32_16x16x32_bf16 v[64:67], a[136:139], a[0:3], 0
s_waitcnt lgkmcnt(4)
v_mfma_f32_16x16x32_bf16 v[96:99], a[144:147], a[0:3], 0
ds_read_b64_tr_b16 a[128:129], v1 offset:128
v_mfma_f32_16x16x32_bf16 v[112:115], a[148:151], a[0:3], 0
ds_read_b64_tr_b16 a[130:131], v1 offset:3712
v_mfma_f32_16x16x32_bf16 v[116:119], a[148:151], a[4:7], 0
s_add_u32 m0, s22, 57344
s_nop 0
buffer_load_dwordx4 v4, s[12:15], s21 offen offset:0  lds
v_mfma_f32_16x16x32_bf16 v[100:103], a[144:147], a[4:7], 0
v_mfma_f32_16x16x32_bf16 v[104:107], a[144:147], a[8:11], 0
ds_read_b64_tr_b16 a[132:133], v1 offset:7296
v_mfma_f32_16x16x32_bf16 v[120:123], a[148:151], a[8:11], 0
ds_read_b64_tr_b16 a[134:135], v1 offset:10880
v_mfma_f32_16x16x32_bf16 v[124:127], a[148:151], a[12:15], 0
buffer_load_dwordx4 v5, s[12:15], s21 offen offset:1024  lds
v_mfma_f32_16x16x32_bf16 v[108:111], a[144:147], a[12:15], 0
s_waitcnt lgkmcnt(4)
v_mfma_f32_16x16x32_bf16 v[140:143], a[152:155], a[12:15], 0
ds_read_b64_tr_b16 a[136:137], v1 offset:160
v_mfma_f32_16x16x32_bf16 v[156:159], a[156:159], a[12:15], 0
ds_read_b64_tr_b16 a[138:139], v1 offset:3744
v_mfma_f32_16x16x32_bf16 v[152:155], a[156:159], a[8:11], 0
buffer_load_dwordx4 v6, s[12:15], s21 offen offset:2048  lds
v_mfma_f32_16x16x32_bf16 v[136:139], a[152:155], a[8:11], 0
v_mfma_f32_16x16x32_bf16 v[132:135], a[152:155], a[4:7], 0
ds_read_b64_tr_b16 a[140:141], v1 offset:7328
v_mfma_f32_16x16x32_bf16 v[148:151], a[156:159], a[4:7], 0
ds_read_b64_tr_b16 a[142:143], v1 offset:10912
v_mfma_f32_16x16x32_bf16 v[144:147], a[156:159], a[0:3], 0
buffer_load_dwordx4 v7, s[12:15], s21 offen offset:3072  lds
v_mfma_f32_16x16x32_bf16 v[128:131], a[152:155], a[0:3], 0
s_waitcnt lgkmcnt(4)
v_mfma_f32_16x16x32_bf16 v[160:163], a[128:131], a[0:3], 0
ds_read_b64_tr_b16 a[144:145], v1 offset:192
v_mfma_f32_16x16x32_bf16 v[176:179], a[132:135], a[0:3], 0
ds_read_b64_tr_b16 a[146:147], v1 offset:3776
v_mfma_f32_16x16x32_bf16 v[180:183], a[132:135], a[4:7], 0
v_mfma_f32_16x16x32_bf16 v[164:167], a[128:131], a[4:7], 0
v_mfma_f32_16x16x32_bf16 v[168:171], a[128:131], a[8:11], 0
ds_read_b64_tr_b16 a[148:149], v1 offset:7360
v_mfma_f32_16x16x32_bf16 v[184:187], a[132:135], a[8:11], 0
ds_read_b64_tr_b16 a[150:151], v1 offset:10944
v_mfma_f32_16x16x32_bf16 v[188:191], a[132:135], a[12:15], 0
s_add_u32 m0, s22, 61440
s_nop 0
buffer_load_dwordx4 v8, s[12:15], s21 offen offset:0  lds
v_mfma_f32_16x16x32_bf16 v[172:175], a[128:131], a[12:15], 0
s_waitcnt lgkmcnt(4)
v_mfma_f32_16x16x32_bf16 v[204:207], a[136:139], a[12:15], 0
ds_read_b64_tr_b16 a[152:153], v1 offset:14336
v_mfma_f32_16x16x32_bf16 v[220:223], a[140:143], a[12:15], 0
ds_read_b64_tr_b16 a[154:155], v1 offset:17920
v_mfma_f32_16x16x32_bf16 v[216:219], a[140:143], a[8:11], 0
buffer_load_dwordx4 v9, s[12:15], s21 offen offset:1024  lds
v_mfma_f32_16x16x32_bf16 v[200:203], a[136:139], a[8:11], 0
v_mfma_f32_16x16x32_bf16 v[196:199], a[136:139], a[4:7], 0
ds_read_b64_tr_b16 a[156:157], v1 offset:21504
v_mfma_f32_16x16x32_bf16 v[212:215], a[140:143], a[4:7], 0
ds_read_b64_tr_b16 a[158:159], v1 offset:25088
v_mfma_f32_16x16x32_bf16 v[208:211], a[140:143], a[0:3], 0
buffer_load_dwordx4 v10, s[12:15], s21 offen offset:2048  lds
s_add_u32 s21, s68, s67
v_mfma_f32_16x16x32_bf16 v[192:195], a[136:139], a[0:3], 0
s_waitcnt lgkmcnt(4)
v_mfma_f32_16x16x32_bf16 v[224:227], a[144:147], a[0:3], 0
ds_read_b64_tr_b16 a[128:129], v1 offset:14368
v_mfma_f32_16x16x32_bf16 v[240:243], a[148:151], a[0:3], 0
ds_read_b64_tr_b16 a[130:131], v1 offset:17952
v_mfma_f32_16x16x32_bf16 v[244:247], a[148:151], a[4:7], 0
buffer_load_dwordx4 a[48:51], v22, s[8:11], s20 offen offset:0
v_mfma_f32_16x16x32_bf16 v[228:231], a[144:147], a[4:7], 0
v_mfma_f32_16x16x32_bf16 v[232:235], a[144:147], a[8:11], 0
ds_read_b64_tr_b16 a[132:133], v1 offset:21536
v_mfma_f32_16x16x32_bf16 v[248:251], a[148:151], a[8:11], 0
ds_read_b64_tr_b16 a[134:135], v1 offset:25120
v_mfma_f32_16x16x32_bf16 v[252:255], a[148:151], a[12:15], 0
buffer_load_dwordx4 a[52:55], v22, s[8:11], s20 offen offset:1024
v_mfma_f32_16x16x32_bf16 v[236:239], a[144:147], a[12:15], 0
s_waitcnt vmcnt(13) lgkmcnt(4)
v_mfma_f32_16x16x32_bf16 v[44:47], a[152:155], a[28:31], v[44:47]
ds_read_b64_tr_b16 a[136:137], v1 offset:14400
v_mfma_f32_16x16x32_bf16 v[60:63], a[156:159], a[28:31], v[60:63]
ds_read_b64_tr_b16 a[138:139], v1 offset:17984
v_mfma_f32_16x16x32_bf16 v[56:59], a[156:159], a[24:27], v[56:59]
buffer_load_dwordx4 a[56:59], v22, s[8:11], s20 offen offset:2048
v_mfma_f32_16x16x32_bf16 v[40:43], a[152:155], a[24:27], v[40:43]
v_mfma_f32_16x16x32_bf16 v[36:39], a[152:155], a[20:23], v[36:39]
ds_read_b64_tr_b16 a[140:141], v1 offset:21568
v_mfma_f32_16x16x32_bf16 v[52:55], a[156:159], a[20:23], v[52:55]
ds_read_b64_tr_b16 a[142:143], v1 offset:25152
v_mfma_f32_16x16x32_bf16 v[48:51], a[156:159], a[16:19], v[48:51]
buffer_load_dwordx4 a[60:63], v22, s[8:11], s20 offen offset:3072
s_add_u32 s20, s69, s78
v_mfma_f32_16x16x32_bf16 v[32:35], a[152:155], a[16:19], v[32:35]
s_waitcnt lgkmcnt(4)
v_mfma_f32_16x16x32_bf16 v[64:67], a[128:131], a[16:19], v[64:67]
ds_read_b64_tr_b16 a[144:145], v1 offset:14432
v_mfma_f32_16x16x32_bf16 v[80:83], a[132:135], a[16:19], v[80:83]
ds_read_b64_tr_b16 a[146:147], v1 offset:18016
v_mfma_f32_16x16x32_bf16 v[84:87], a[132:135], a[20:23], v[84:87]
buffer_load_dwordx4 a[64:67], v22, s[8:11], s20 offen offset:0
v_mfma_f32_16x16x32_bf16 v[68:71], a[128:131], a[20:23], v[68:71]
v_mfma_f32_16x16x32_bf16 v[72:75], a[128:131], a[24:27], v[72:75]
ds_read_b64_tr_b16 a[148:149], v1 offset:21600
v_mfma_f32_16x16x32_bf16 v[88:91], a[132:135], a[24:27], v[88:91]
ds_read_b64_tr_b16 a[150:151], v1 offset:25184
v_mfma_f32_16x16x32_bf16 v[92:95], a[132:135], a[28:31], v[92:95]
v_mfma_f32_16x16x32_bf16 v[76:79], a[128:131], a[28:31], v[76:79]
s_waitcnt lgkmcnt(4)
v_mfma_f32_16x16x32_bf16 v[108:111], a[136:139], a[28:31], v[108:111]
ds_read_b64_tr_b16 a[152:153], v1 offset:14464
v_mfma_f32_16x16x32_bf16 v[124:127], a[140:143], a[28:31], v[124:127]
ds_read_b64_tr_b16 a[154:155], v1 offset:18048
v_mfma_f32_16x16x32_bf16 v[120:123], a[140:143], a[24:27], v[120:123]
buffer_load_dwordx4 a[68:71], v22, s[8:11], s20 offen offset:1024
v_mfma_f32_16x16x32_bf16 v[104:107], a[136:139], a[24:27], v[104:107]
v_mfma_f32_16x16x32_bf16 v[100:103], a[136:139], a[20:23], v[100:103]
ds_read_b64_tr_b16 a[156:157], v1 offset:21632
v_mfma_f32_16x16x32_bf16 v[116:119], a[140:143], a[20:23], v[116:119]
ds_read_b64_tr_b16 a[158:159], v1 offset:25216
v_mfma_f32_16x16x32_bf16 v[112:115], a[140:143], a[16:19], v[112:115]
buffer_load_dwordx4 a[72:75], v22, s[8:11], s20 offen offset:2048
v_mfma_f32_16x16x32_bf16 v[96:99], a[136:139], a[16:19], v[96:99]
s_waitcnt lgkmcnt(4)
v_mfma_f32_16x16x32_bf16 v[128:131], a[144:147], a[16:19], v[128:131]
ds_read_b64_tr_b16 a[128:129], v1 offset:14496
v_mfma_f32_16x16x32_bf16 v[144:147], a[148:151], a[16:19], v[144:147]
ds_read_b64_tr_b16 a[130:131], v1 offset:18080
v_mfma_f32_16x16x32_bf16 v[148:151], a[148:151], a[20:23], v[148:151]
buffer_load_dwordx4 a[76:79], v22, s[8:11], s20 offen offset:3072
s_add_u32 s20, s20, 4096
v_mfma_f32_16x16x32_bf16 v[132:135], a[144:147], a[20:23], v[132:135]
v_mfma_f32_16x16x32_bf16 v[136:139], a[144:147], a[24:27], v[136:139]
ds_read_b64_tr_b16 a[132:133], v1 offset:21664
v_mfma_f32_16x16x32_bf16 v[152:155], a[148:151], a[24:27], v[152:155]
ds_read_b64_tr_b16 a[134:135], v1 offset:25248
v_mfma_f32_16x16x32_bf16 v[156:159], a[148:151], a[28:31], v[156:159]
buffer_load_dwordx4 a[80:83], v22, s[8:11], s20 offen offset:0
v_mfma_f32_16x16x32_bf16 v[140:143], a[144:147], a[28:31], v[140:143]
s_waitcnt lgkmcnt(4)
v_mfma_f32_16x16x32_bf16 v[172:175], a[152:155], a[28:31], v[172:175]
ds_read_b64_tr_b16 a[136:137], v1 offset:14528
v_mfma_f32_16x16x32_bf16 v[188:191], a[156:159], a[28:31], v[188:191]
ds_read_b64_tr_b16 a[138:139], v1 offset:18112
v_mfma_f32_16x16x32_bf16 v[184:187], a[156:159], a[24:27], v[184:187]
buffer_load_dwordx4 a[84:87], v22, s[8:11], s20 offen offset:1024
v_mfma_f32_16x16x32_bf16 v[168:171], a[152:155], a[24:27], v[168:171]
v_mfma_f32_16x16x32_bf16 v[164:167], a[152:155], a[20:23], v[164:167]
ds_read_b64_tr_b16 a[140:141], v1 offset:21696
v_mfma_f32_16x16x32_bf16 v[180:183], a[156:159], a[20:23], v[180:183]
ds_read_b64_tr_b16 a[142:143], v1 offset:25280
v_mfma_f32_16x16x32_bf16 v[176:179], a[156:159], a[16:19], v[176:179]
buffer_load_dwordx4 a[88:91], v22, s[8:11], s20 offen offset:2048
v_mfma_f32_16x16x32_bf16 v[160:163], a[152:155], a[16:19], v[160:163]
s_waitcnt lgkmcnt(4)
v_mfma_f32_16x16x32_bf16 v[192:195], a[128:131], a[16:19], v[192:195]
ds_read_b64_tr_b16 a[144:145], v1 offset:28672
v_mfma_f32_16x16x32_bf16 v[208:211], a[132:135], a[16:19], v[208:211]
ds_read_b64_tr_b16 a[146:147], v1 offset:32256
v_mfma_f32_16x16x32_bf16 v[212:215], a[132:135], a[20:23], v[212:215]
buffer_load_dwordx4 a[92:95], v22, s[8:11], s20 offen offset:3072
s_add_u32 s20, s69, s79
v_mfma_f32_16x16x32_bf16 v[196:199], a[128:131], a[20:23], v[196:199]
v_mfma_f32_16x16x32_bf16 v[200:203], a[128:131], a[24:27], v[200:203]
ds_read_b64_tr_b16 a[148:149], v1 offset:35840
v_mfma_f32_16x16x32_bf16 v[216:219], a[132:135], a[24:27], v[216:219]
ds_read_b64_tr_b16 a[150:151], v1 offset:39424
v_mfma_f32_16x16x32_bf16 v[220:223], a[132:135], a[28:31], v[220:223]
v_mfma_f32_16x16x32_bf16 v[204:207], a[128:131], a[28:31], v[204:207]
s_waitcnt lgkmcnt(4)
v_mfma_f32_16x16x32_bf16 v[236:239], a[136:139], a[28:31], v[236:239]
ds_read_b64_tr_b16 a[152:153], v1 offset:28704
v_mfma_f32_16x16x32_bf16 v[252:255], a[140:143], a[28:31], v[252:255]
ds_read_b64_tr_b16 a[154:155], v1 offset:32288
v_mfma_f32_16x16x32_bf16 v[248:251], a[140:143], a[24:27], v[248:251]
v_mfma_f32_16x16x32_bf16 v[232:235], a[136:139], a[24:27], v[232:235]
v_mfma_f32_16x16x32_bf16 v[228:231], a[136:139], a[20:23], v[228:231]
ds_read_b64_tr_b16 a[156:157], v1 offset:35872
v_mfma_f32_16x16x32_bf16 v[244:247], a[140:143], a[20:23], v[244:247]
ds_read_b64_tr_b16 a[158:159], v1 offset:39456
v_mfma_f32_16x16x32_bf16 v[240:243], a[140:143], a[16:19], v[240:243]
v_mfma_f32_16x16x32_bf16 v[224:227], a[136:139], a[16:19], v[224:227]
s_mov_b32 s35, 3
.p2align 6
interleave_layers__ssm_conv_h3__geglu_ffn__prompt_kernel_g1loop:
s_waitcnt vmcnt(19) lgkmcnt(4)
v_mfma_f32_16x16x32_bf16 v[32:35], a[144:147], a[32:35], v[32:35]
ds_read_b64_tr_b16 a[128:129], v1 offset:28736
v_mfma_f32_16x16x32_bf16 v[48:51], a[148:151], a[32:35], v[48:51]
ds_read_b64_tr_b16 a[130:131], v1 offset:32320
s_add_u32 m0, s22, 86016
v_mfma_f32_16x16x32_bf16 v[52:55], a[148:151], a[36:39], v[52:55]
buffer_load_dwordx4 v4, s[12:15], s21 offen offset:0  lds
v_mfma_f32_16x16x32_bf16 v[36:39], a[144:147], a[36:39], v[36:39]
v_mfma_f32_16x16x32_bf16 v[40:43], a[144:147], a[40:43], v[40:43]
ds_read_b64_tr_b16 a[132:133], v1 offset:35904
v_mfma_f32_16x16x32_bf16 v[56:59], a[148:151], a[40:43], v[56:59]
ds_read_b64_tr_b16 a[134:135], v1 offset:39488
v_mfma_f32_16x16x32_bf16 v[60:63], a[148:151], a[44:47], v[60:63]
v_mfma_f32_16x16x32_bf16 v[44:47], a[144:147], a[44:47], v[44:47]
s_waitcnt lgkmcnt(4)
v_mfma_f32_16x16x32_bf16 v[76:79], a[152:155], a[44:47], v[76:79]
ds_read_b64_tr_b16 a[136:137], v1 offset:28768
v_mfma_f32_16x16x32_bf16 v[92:95], a[156:159], a[44:47], v[92:95]
ds_read_b64_tr_b16 a[138:139], v1 offset:32352
v_mfma_f32_16x16x32_bf16 v[88:91], a[156:159], a[40:43], v[88:91]
buffer_load_dwordx4 v5, s[12:15], s21 offen offset:1024  lds
v_mfma_f32_16x16x32_bf16 v[72:75], a[152:155], a[40:43], v[72:75]
v_mfma_f32_16x16x32_bf16 v[68:71], a[152:155], a[36:39], v[68:71]
ds_read_b64_tr_b16 a[140:141], v1 offset:35936
v_mfma_f32_16x16x32_bf16 v[84:87], a[156:159], a[36:39], v[84:87]
ds_read_b64_tr_b16 a[142:143], v1 offset:39520
v_mfma_f32_16x16x32_bf16 v[80:83], a[156:159], a[32:35], v[80:83]
v_mfma_f32_16x16x32_bf16 v[64:67], a[152:155], a[32:35], v[64:67]
s_waitcnt lgkmcnt(4)
v_mfma_f32_16x16x32_bf16 v[96:99], a[128:131], a[32:35], v[96:99]
ds_read_b64_tr_b16 a[144:145], v1 offset:28800
v_mfma_f32_16x16x32_bf16 v[112:115], a[132:135], a[32:35], v[112:115]
ds_read_b64_tr_b16 a[146:147], v1 offset:32384
v_mfma_f32_16x16x32_bf16 v[116:119], a[132:135], a[36:39], v[116:119]
buffer_load_dwordx4 v6, s[12:15], s21 offen offset:2048  lds
v_mfma_f32_16x16x32_bf16 v[100:103], a[128:131], a[36:39], v[100:103]
v_mfma_f32_16x16x32_bf16 v[104:107], a[128:131], a[40:43], v[104:107]
ds_read_b64_tr_b16 a[148:149], v1 offset:35968
v_mfma_f32_16x16x32_bf16 v[120:123], a[132:135], a[40:43], v[120:123]
ds_read_b64_tr_b16 a[150:151], v1 offset:39552
v_mfma_f32_16x16x32_bf16 v[124:127], a[132:135], a[44:47], v[124:127]
v_mfma_f32_16x16x32_bf16 v[108:111], a[128:131], a[44:47], v[108:111]
s_waitcnt lgkmcnt(4)
v_mfma_f32_16x16x32_bf16 v[140:143], a[136:139], a[44:47], v[140:143]
ds_read_b64_tr_b16 a[152:153], v1 offset:28832
v_mfma_f32_16x16x32_bf16 v[156:159], a[140:143], a[44:47], v[156:159]
ds_read_b64_tr_b16 a[154:155], v1 offset:32416
v_mfma_f32_16x16x32_bf16 v[152:155], a[140:143], a[40:43], v[152:155]
buffer_load_dwordx4 v7, s[12:15], s21 offen offset:3072  lds
v_mfma_f32_16x16x32_bf16 v[136:139], a[136:139], a[40:43], v[136:139]
v_mfma_f32_16x16x32_bf16 v[132:135], a[136:139], a[36:39], v[132:135]
ds_read_b64_tr_b16 a[156:157], v1 offset:36000
v_mfma_f32_16x16x32_bf16 v[148:151], a[140:143], a[36:39], v[148:151]
ds_read_b64_tr_b16 a[158:159], v1 offset:39584
v_mfma_f32_16x16x32_bf16 v[144:147], a[140:143], a[32:35], v[144:147]
v_mfma_f32_16x16x32_bf16 v[128:131], a[136:139], a[32:35], v[128:131]
s_waitcnt lgkmcnt(4)
v_mfma_f32_16x16x32_bf16 v[160:163], a[144:147], a[32:35], v[160:163]
ds_read_b64_tr_b16 a[128:129], v1 offset:28864
v_mfma_f32_16x16x32_bf16 v[176:179], a[148:151], a[32:35], v[176:179]
ds_read_b64_tr_b16 a[130:131], v1 offset:32448
s_add_u32 m0, s22, 90112
v_mfma_f32_16x16x32_bf16 v[180:183], a[148:151], a[36:39], v[180:183]
buffer_load_dwordx4 v8, s[12:15], s21 offen offset:0  lds
v_mfma_f32_16x16x32_bf16 v[164:167], a[144:147], a[36:39], v[164:167]
v_mfma_f32_16x16x32_bf16 v[168:171], a[144:147], a[40:43], v[168:171]
ds_read_b64_tr_b16 a[132:133], v1 offset:36032
v_mfma_f32_16x16x32_bf16 v[184:187], a[148:151], a[40:43], v[184:187]
ds_read_b64_tr_b16 a[134:135], v1 offset:39616
v_mfma_f32_16x16x32_bf16 v[188:191], a[148:151], a[44:47], v[188:191]
v_mfma_f32_16x16x32_bf16 v[172:175], a[144:147], a[44:47], v[172:175]
s_waitcnt lgkmcnt(4)
v_mfma_f32_16x16x32_bf16 v[204:207], a[152:155], a[44:47], v[204:207]
ds_read_b64_tr_b16 a[136:137], v1 offset:43008
v_mfma_f32_16x16x32_bf16 v[220:223], a[156:159], a[44:47], v[220:223]
ds_read_b64_tr_b16 a[138:139], v1 offset:46592
v_mfma_f32_16x16x32_bf16 v[216:219], a[156:159], a[40:43], v[216:219]
buffer_load_dwordx4 v9, s[12:15], s21 offen offset:1024  lds
v_mfma_f32_16x16x32_bf16 v[200:203], a[152:155], a[40:43], v[200:203]
v_mfma_f32_16x16x32_bf16 v[196:199], a[152:155], a[36:39], v[196:199]
ds_read_b64_tr_b16 a[140:141], v1 offset:50176
v_mfma_f32_16x16x32_bf16 v[212:215], a[156:159], a[36:39], v[212:215]
ds_read_b64_tr_b16 a[142:143], v1 offset:53760
v_mfma_f32_16x16x32_bf16 v[208:211], a[156:159], a[32:35], v[208:211]
v_mfma_f32_16x16x32_bf16 v[192:195], a[152:155], a[32:35], v[192:195]
s_waitcnt lgkmcnt(4)
v_mfma_f32_16x16x32_bf16 v[224:227], a[128:131], a[32:35], v[224:227]
ds_read_b64_tr_b16 a[144:145], v1 offset:43040
v_mfma_f32_16x16x32_bf16 v[240:243], a[132:135], a[32:35], v[240:243]
ds_read_b64_tr_b16 a[146:147], v1 offset:46624
s_add_u32 s68, s68, 1835008
v_mfma_f32_16x16x32_bf16 v[244:247], a[132:135], a[36:39], v[244:247]
buffer_load_dwordx4 v10, s[12:15], s21 offen offset:2048  lds
v_mfma_f32_16x16x32_bf16 v[228:231], a[128:131], a[36:39], v[228:231]
s_add_u32 s21, s68, s64
v_mfma_f32_16x16x32_bf16 v[232:235], a[128:131], a[40:43], v[232:235]
ds_read_b64_tr_b16 a[148:149], v1 offset:50208
v_mfma_f32_16x16x32_bf16 v[248:251], a[132:135], a[40:43], v[248:251]
ds_read_b64_tr_b16 a[150:151], v1 offset:53792
s_min_u32 m0, s71, s72
v_mfma_f32_16x16x32_bf16 v[252:255], a[132:135], a[44:47], v[252:255]
buffer_load_dwordx4 v11, s[56:59], s70 offen nt lds
v_mfma_f32_16x16x32_bf16 v[236:239], a[128:131], a[44:47], v[236:239]
s_add_u32 s71, s71, 4096
s_waitcnt vmcnt(16) lgkmcnt(4)
s_barrier
v_mfma_f32_16x16x32_bf16 v[44:47], a[136:139], a[60:63], v[44:47]
ds_read_b64_tr_b16 a[152:153], v1 offset:43072
s_add_u32 s70, s70, 65536
v_mfma_f32_16x16x32_bf16 v[60:63], a[140:143], a[60:63], v[60:63]
ds_read_b64_tr_b16 a[154:155], v1 offset:46656
v_mfma_f32_16x16x32_bf16 v[56:59], a[140:143], a[56:59], v[56:59]
v_mfma_f32_16x16x32_bf16 v[40:43], a[136:139], a[56:59], v[40:43]
v_mfma_f32_16x16x32_bf16 v[36:39], a[136:139], a[52:55], v[36:39]
ds_read_b64_tr_b16 a[156:157], v1 offset:50240
v_mfma_f32_16x16x32_bf16 v[52:55], a[140:143], a[52:55], v[52:55]
ds_read_b64_tr_b16 a[158:159], v1 offset:53824
v_mfma_f32_16x16x32_bf16 v[48:51], a[140:143], a[48:51], v[48:51]
buffer_load_dwordx4 a[96:99], v22, s[8:11], s20 offen offset:0
v_mfma_f32_16x16x32_bf16 v[32:35], a[136:139], a[48:51], v[32:35]
s_waitcnt lgkmcnt(4)
v_mfma_f32_16x16x32_bf16 v[64:67], a[144:147], a[48:51], v[64:67]
ds_read_b64_tr_b16 a[128:129], v1 offset:43104
v_mfma_f32_16x16x32_bf16 v[80:83], a[148:151], a[48:51], v[80:83]
ds_read_b64_tr_b16 a[130:131], v1 offset:46688
v_mfma_f32_16x16x32_bf16 v[84:87], a[148:151], a[52:55], v[84:87]
v_mfma_f32_16x16x32_bf16 v[68:71], a[144:147], a[52:55], v[68:71]
v_mfma_f32_16x16x32_bf16 v[72:75], a[144:147], a[56:59], v[72:75]
ds_read_b64_tr_b16 a[132:133], v1 offset:50272
v_mfma_f32_16x16x32_bf16 v[88:91], a[148:151], a[56:59], v[88:91]
ds_read_b64_tr_b16 a[134:135], v1 offset:53856
v_mfma_f32_16x16x32_bf16 v[92:95], a[148:151], a[60:63], v[92:95]
buffer_load_dwordx4 a[100:103], v22, s[8:11], s20 offen offset:1024
v_mfma_f32_16x16x32_bf16 v[76:79], a[144:147], a[60:63], v[76:79]
s_waitcnt lgkmcnt(4)
v_mfma_f32_16x16x32_bf16 v[108:111], a[152:155], a[60:63], v[108:111]
ds_read_b64_tr_b16 a[136:137], v1 offset:43136
v_mfma_f32_16x16x32_bf16 v[124:127], a[156:159], a[60:63], v[124:127]
ds_read_b64_tr_b16 a[138:139], v1 offset:46720
v_mfma_f32_16x16x32_bf16 v[120:123], a[156:159], a[56:59], v[120:123]
v_mfma_f32_16x16x32_bf16 v[104:107], a[152:155], a[56:59], v[104:107]
v_mfma_f32_16x16x32_bf16 v[100:103], a[152:155], a[52:55], v[100:103]
ds_read_b64_tr_b16 a[140:141], v1 offset:50304
v_mfma_f32_16x16x32_bf16 v[116:119], a[156:159], a[52:55], v[116:119]
ds_read_b64_tr_b16 a[142:143], v1 offset:53888
v_mfma_f32_16x16x32_bf16 v[112:115], a[156:159], a[48:51], v[112:115]
buffer_load_dwordx4 a[104:107], v22, s[8:11], s20 offen offset:2048
v_mfma_f32_16x16x32_bf16 v[96:99], a[152:155], a[48:51], v[96:99]
s_waitcnt lgkmcnt(4)
v_mfma_f32_16x16x32_bf16 v[128:131], a[128:131], a[48:51], v[128:131]
ds_read_b64_tr_b16 a[144:145], v1 offset:43168
v_mfma_f32_16x16x32_bf16 v[144:147], a[132:135], a[48:51], v[144:147]
ds_read_b64_tr_b16 a[146:147], v1 offset:46752
v_mfma_f32_16x16x32_bf16 v[148:151], a[132:135], a[52:55], v[148:151]
buffer_load_dwordx4 a[108:111], v22, s[8:11], s20 offen offset:3072
v_mfma_f32_16x16x32_bf16 v[132:135], a[128:131], a[52:55], v[132:135]
s_add_u32 s20, s20, 4096
v_mfma_f32_16x16x32_bf16 v[136:139], a[128:131], a[56:59], v[136:139]
ds_read_b64_tr_b16 a[148:149], v1 offset:50336
v_mfma_f32_16x16x32_bf16 v[152:155], a[132:135], a[56:59], v[152:155]
ds_read_b64_tr_b16 a[150:151], v1 offset:53920
v_mfma_f32_16x16x32_bf16 v[156:159], a[132:135], a[60:63], v[156:159]
v_mfma_f32_16x16x32_bf16 v[140:143], a[128:131], a[60:63], v[140:143]
s_waitcnt lgkmcnt(4)
v_mfma_f32_16x16x32_bf16 v[172:175], a[136:139], a[60:63], v[172:175]
ds_read_b64_tr_b16 a[152:153], v1 offset:43200
v_mfma_f32_16x16x32_bf16 v[188:191], a[140:143], a[60:63], v[188:191]
ds_read_b64_tr_b16 a[154:155], v1 offset:46784
v_mfma_f32_16x16x32_bf16 v[184:187], a[140:143], a[56:59], v[184:187]
buffer_load_dwordx4 a[112:115], v22, s[8:11], s20 offen offset:0
v_mfma_f32_16x16x32_bf16 v[168:171], a[136:139], a[56:59], v[168:171]
v_mfma_f32_16x16x32_bf16 v[164:167], a[136:139], a[52:55], v[164:167]
ds_read_b64_tr_b16 a[156:157], v1 offset:50368
v_mfma_f32_16x16x32_bf16 v[180:183], a[140:143], a[52:55], v[180:183]
ds_read_b64_tr_b16 a[158:159], v1 offset:53952
v_mfma_f32_16x16x32_bf16 v[176:179], a[140:143], a[48:51], v[176:179]
v_mfma_f32_16x16x32_bf16 v[160:163], a[136:139], a[48:51], v[160:163]
s_waitcnt lgkmcnt(4)
v_mfma_f32_16x16x32_bf16 v[192:195], a[144:147], a[48:51], v[192:195]
ds_read_b64_tr_b16 a[128:129], v2 offset:0
v_mfma_f32_16x16x32_bf16 v[208:211], a[148:151], a[48:51], v[208:211]
ds_read_b64_tr_b16 a[130:131], v2 offset:3584
v_mfma_f32_16x16x32_bf16 v[212:215], a[148:151], a[52:55], v[212:215]
buffer_load_dwordx4 a[116:119], v22, s[8:11], s20 offen offset:1024
v_mfma_f32_16x16x32_bf16 v[196:199], a[144:147], a[52:55], v[196:199]
v_mfma_f32_16x16x32_bf16 v[200:203], a[144:147], a[56:59], v[200:203]
ds_read_b64_tr_b16 a[132:133], v2 offset:7168
v_mfma_f32_16x16x32_bf16 v[216:219], a[148:151], a[56:59], v[216:219]
ds_read_b64_tr_b16 a[134:135], v2 offset:10752
v_mfma_f32_16x16x32_bf16 v[220:223], a[148:151], a[60:63], v[220:223]
buffer_load_dwordx4 a[120:123], v22, s[8:11], s20 offen offset:2048
v_mfma_f32_16x16x32_bf16 v[204:207], a[144:147], a[60:63], v[204:207]
s_waitcnt lgkmcnt(4)
v_mfma_f32_16x16x32_bf16 v[236:239], a[152:155], a[60:63], v[236:239]
ds_read_b64_tr_b16 a[136:137], v2 offset:32
v_mfma_f32_16x16x32_bf16 v[252:255], a[156:159], a[60:63], v[252:255]
ds_read_b64_tr_b16 a[138:139], v2 offset:3616
v_mfma_f32_16x16x32_bf16 v[248:251], a[156:159], a[56:59], v[248:251]
v_mfma_f32_16x16x32_bf16 v[232:235], a[152:155], a[56:59], v[232:235]
v_mfma_f32_16x16x32_bf16 v[228:231], a[152:155], a[52:55], v[228:231]
ds_read_b64_tr_b16 a[140:141], v2 offset:7200
v_mfma_f32_16x16x32_bf16 v[244:247], a[156:159], a[52:55], v[244:247]
ds_read_b64_tr_b16 a[142:143], v2 offset:10784
s_add_u32 s69, s69, 32768
v_mfma_f32_16x16x32_bf16 v[240:243], a[156:159], a[48:51], v[240:243]
buffer_load_dwordx4 a[124:127], v22, s[8:11], s20 offen offset:3072
v_mfma_f32_16x16x32_bf16 v[224:227], a[152:155], a[48:51], v[224:227]
s_add_u32 s20, s69, s76
s_waitcnt vmcnt(20) lgkmcnt(4)
v_mfma_f32_16x16x32_bf16 v[32:35], a[128:131], a[64:67], v[32:35]
ds_read_b64_tr_b16 a[144:145], v2 offset:64
v_mfma_f32_16x16x32_bf16 v[48:51], a[132:135], a[64:67], v[48:51]
ds_read_b64_tr_b16 a[146:147], v2 offset:3648
s_add_u32 m0, s22, 0
v_mfma_f32_16x16x32_bf16 v[52:55], a[132:135], a[68:71], v[52:55]
buffer_load_dwordx4 v4, s[12:15], s21 offen offset:0  lds
v_mfma_f32_16x16x32_bf16 v[36:39], a[128:131], a[68:71], v[36:39]
v_mfma_f32_16x16x32_bf16 v[40:43], a[128:131], a[72:75], v[40:43]
ds_read_b64_tr_b16 a[148:149], v2 offset:7232
v_mfma_f32_16x16x32_bf16 v[56:59], a[132:135], a[72:75], v[56:59]
ds_read_b64_tr_b16 a[150:151], v2 offset:10816
v_mfma_f32_16x16x32_bf16 v[60:63], a[132:135], a[76:79], v[60:63]
v_mfma_f32_16x16x32_bf16 v[44:47], a[128:131], a[76:79], v[44:47]
s_waitcnt lgkmcnt(4)
v_mfma_f32_16x16x32_bf16 v[76:79], a[136:139], a[76:79], v[76:79]
ds_read_b64_tr_b16 a[152:153], v2 offset:96
v_mfma_f32_16x16x32_bf16 v[92:95], a[140:143], a[76:79], v[92:95]
ds_read_b64_tr_b16 a[154:155], v2 offset:3680
v_mfma_f32_16x16x32_bf16 v[88:91], a[140:143], a[72:75], v[88:91]
buffer_load_dwordx4 v5, s[12:15], s21 offen offset:1024  lds
v_mfma_f32_16x16x32_bf16 v[72:75], a[136:139], a[72:75], v[72:75]
v_mfma_f32_16x16x32_bf16 v[68:71], a[136:139], a[68:71], v[68:71]
ds_read_b64_tr_b16 a[156:157], v2 offset:7264
v_mfma_f32_16x16x32_bf16 v[84:87], a[140:143], a[68:71], v[84:87]
ds_read_b64_tr_b16 a[158:159], v2 offset:10848
v_mfma_f32_16x16x32_bf16 v[80:83], a[140:143], a[64:67], v[80:83]
v_mfma_f32_16x16x32_bf16 v[64:67], a[136:139], a[64:67], v[64:67]
s_waitcnt lgkmcnt(4)
v_mfma_f32_16x16x32_bf16 v[96:99], a[144:147], a[64:67], v[96:99]
ds_read_b64_tr_b16 a[128:129], v2 offset:128
v_mfma_f32_16x16x32_bf16 v[112:115], a[148:151], a[64:67], v[112:115]
ds_read_b64_tr_b16 a[130:131], v2 offset:3712
v_mfma_f32_16x16x32_bf16 v[116:119], a[148:151], a[68:71], v[116:119]
buffer_load_dwordx4 v6, s[12:15], s21 offen offset:2048  lds
v_mfma_f32_16x16x32_bf16 v[100:103], a[144:147], a[68:71], v[100:103]
v_mfma_f32_16x16x32_bf16 v[104:107], a[144:147], a[72:75], v[104:107]
ds_read_b64_tr_b16 a[132:133], v2 offset:7296
v_mfma_f32_16x16x32_bf16 v[120:123], a[148:151], a[72:75], v[120:123]
ds_read_b64_tr_b16 a[134:135], v2 offset:10880
v_mfma_f32_16x16x32_bf16 v[124:127], a[148:151], a[76:79], v[124:127]
v_mfma_f32_16x16x32_bf16 v[108:111], a[144:147], a[76:79], v[108:111]
s_waitcnt lgkmcnt(4)
v_mfma_f32_16x16x32_bf16 v[140:143], a[152:155], a[76:79], v[140:143]
ds_read_b64_tr_b16 a[136:137], v2 offset:160
v_mfma_f32_16x16x32_bf16 v[156:159], a[156:159], a[76:79], v[156:159]
ds_read_b64_tr_b16 a[138:139], v2 offset:3744
v_mfma_f32_16x16x32_bf16 v[152:155], a[156:159], a[72:75], v[152:155]
buffer_load_dwordx4 v7, s[12:15], s21 offen offset:3072  lds
v_mfma_f32_16x16x32_bf16 v[136:139], a[152:155], a[72:75], v[136:139]
v_mfma_f32_16x16x32_bf16 v[132:135], a[152:155], a[68:71], v[132:135]
ds_read_b64_tr_b16 a[140:141], v2 offset:7328
v_mfma_f32_16x16x32_bf16 v[148:151], a[156:159], a[68:71], v[148:151]
ds_read_b64_tr_b16 a[142:143], v2 offset:10912
v_mfma_f32_16x16x32_bf16 v[144:147], a[156:159], a[64:67], v[144:147]
v_mfma_f32_16x16x32_bf16 v[128:131], a[152:155], a[64:67], v[128:131]
s_waitcnt lgkmcnt(4)
v_mfma_f32_16x16x32_bf16 v[160:163], a[128:131], a[64:67], v[160:163]
ds_read_b64_tr_b16 a[144:145], v2 offset:192
v_mfma_f32_16x16x32_bf16 v[176:179], a[132:135], a[64:67], v[176:179]
ds_read_b64_tr_b16 a[146:147], v2 offset:3776
s_add_u32 m0, s22, 4096
v_mfma_f32_16x16x32_bf16 v[180:183], a[132:135], a[68:71], v[180:183]
buffer_load_dwordx4 v8, s[12:15], s21 offen offset:0  lds
v_mfma_f32_16x16x32_bf16 v[164:167], a[128:131], a[68:71], v[164:167]
v_mfma_f32_16x16x32_bf16 v[168:171], a[128:131], a[72:75], v[168:171]
ds_read_b64_tr_b16 a[148:149], v2 offset:7360
v_mfma_f32_16x16x32_bf16 v[184:187], a[132:135], a[72:75], v[184:187]
ds_read_b64_tr_b16 a[150:151], v2 offset:10944
v_mfma_f32_16x16x32_bf16 v[188:191], a[132:135], a[76:79], v[188:191]
v_mfma_f32_16x16x32_bf16 v[172:175], a[128:131], a[76:79], v[172:175]
s_waitcnt lgkmcnt(4)
v_mfma_f32_16x16x32_bf16 v[204:207], a[136:139], a[76:79], v[204:207]
ds_read_b64_tr_b16 a[152:153], v2 offset:14336
v_mfma_f32_16x16x32_bf16 v[220:223], a[140:143], a[76:79], v[220:223]
ds_read_b64_tr_b16 a[154:155], v2 offset:17920
v_mfma_f32_16x16x32_bf16 v[216:219], a[140:143], a[72:75], v[216:219]
buffer_load_dwordx4 v9, s[12:15], s21 offen offset:1024  lds
v_mfma_f32_16x16x32_bf16 v[200:203], a[136:139], a[72:75], v[200:203]
v_mfma_f32_16x16x32_bf16 v[196:199], a[136:139], a[68:71], v[196:199]
ds_read_b64_tr_b16 a[156:157], v2 offset:21504
v_mfma_f32_16x16x32_bf16 v[212:215], a[140:143], a[68:71], v[212:215]
ds_read_b64_tr_b16 a[158:159], v2 offset:25088
v_mfma_f32_16x16x32_bf16 v[208:211], a[140:143], a[64:67], v[208:211]
v_mfma_f32_16x16x32_bf16 v[192:195], a[136:139], a[64:67], v[192:195]
s_waitcnt lgkmcnt(4)
v_mfma_f32_16x16x32_bf16 v[224:227], a[144:147], a[64:67], v[224:227]
ds_read_b64_tr_b16 a[128:129], v2 offset:14368
v_mfma_f32_16x16x32_bf16 v[240:243], a[148:151], a[64:67], v[240:243]
ds_read_b64_tr_b16 a[130:131], v2 offset:17952
v_mfma_f32_16x16x32_bf16 v[244:247], a[148:151], a[68:71], v[244:247]
buffer_load_dwordx4 v10, s[12:15], s21 offen offset:2048  lds
v_mfma_f32_16x16x32_bf16 v[228:231], a[144:147], a[68:71], v[228:231]
s_add_u32 s21, s68, s65
v_mfma_f32_16x16x32_bf16 v[232:235], a[144:147], a[72:75], v[232:235]
ds_read_b64_tr_b16 a[132:133], v2 offset:21536
v_mfma_f32_16x16x32_bf16 v[248:251], a[148:151], a[72:75], v[248:251]
ds_read_b64_tr_b16 a[134:135], v2 offset:25120
s_min_u32 m0, s71, s72
v_mfma_f32_16x16x32_bf16 v[252:255], a[148:151], a[76:79], v[252:255]
buffer_load_dwordx4 v11, s[56:59], s70 offen nt lds
v_mfma_f32_16x16x32_bf16 v[236:239], a[144:147], a[76:79], v[236:239]
s_add_u32 s71, s71, 4096
s_waitcnt vmcnt(17) lgkmcnt(4)
s_barrier
v_mfma_f32_16x16x32_bf16 v[44:47], a[152:155], a[92:95], v[44:47]
ds_read_b64_tr_b16 a[136:137], v2 offset:14400
s_add_u32 s70, s70, 65536
v_mfma_f32_16x16x32_bf16 v[60:63], a[156:159], a[92:95], v[60:63]
ds_read_b64_tr_b16 a[138:139], v2 offset:17984
v_mfma_f32_16x16x32_bf16 v[56:59], a[156:159], a[88:91], v[56:59]
v_mfma_f32_16x16x32_bf16 v[40:43], a[152:155], a[88:91], v[40:43]
v_mfma_f32_16x16x32_bf16 v[36:39], a[152:155], a[84:87], v[36:39]
ds_read_b64_tr_b16 a[140:141], v2 offset:21568
v_mfma_f32_16x16x32_bf16 v[52:55], a[156:159], a[84:87], v[52:55]
ds_read_b64_tr_b16 a[142:143], v2 offset:25152
v_mfma_f32_16x16x32_bf16 v[48:51], a[156:159], a[80:83], v[48:51]
buffer_load_dwordx4 a[0:3], v22, s[8:11], s20 offen offset:0
v_mfma_f32_16x16x32_bf16 v[32:35], a[152:155], a[80:83], v[32:35]
s_waitcnt lgkmcnt(4)
v_mfma_f32_16x16x32_bf16 v[64:67], a[128:131], a[80:83], v[64:67]
ds_read_b64_tr_b16 a[144:145], v2 offset:14432
v_mfma_f32_16x16x32_bf16 v[80:83], a[132:135], a[80:83], v[80:83]
ds_read_b64_tr_b16 a[146:147], v2 offset:18016
v_mfma_f32_16x16x32_bf16 v[84:87], a[132:135], a[84:87], v[84:87]
v_mfma_f32_16x16x32_bf16 v[68:71], a[128:131], a[84:87], v[68:71]
v_mfma_f32_16x16x32_bf16 v[72:75], a[128:131], a[88:91], v[72:75]
ds_read_b64_tr_b16 a[148:149], v2 offset:21600
v_mfma_f32_16x16x32_bf16 v[88:91], a[132:135], a[88:91], v[88:91]
ds_read_b64_tr_b16 a[150:151], v2 offset:25184
v_mfma_f32_16x16x32_bf16 v[92:95], a[132:135], a[92:95], v[92:95]
buffer_load_dwordx4 a[4:7], v22, s[8:11], s20 offen offset:1024
v_mfma_f32_16x16x32_bf16 v[76:79], a[128:131], a[92:95], v[76:79]
s_waitcnt lgkmcnt(4)
v_mfma_f32_16x16x32_bf16 v[108:111], a[136:139], a[92:95], v[108:111]
ds_read_b64_tr_b16 a[152:153], v2 offset:14464
v_mfma_f32_16x16x32_bf16 v[124:127], a[140:143], a[92:95], v[124:127]
ds_read_b64_tr_b16 a[154:155], v2 offset:18048
v_mfma_f32_16x16x32_bf16 v[120:123], a[140:143], a[88:91], v[120:123]
v_mfma_f32_16x16x32_bf16 v[104:107], a[136:139], a[88:91], v[104:107]
v_mfma_f32_16x16x32_bf16 v[100:103], a[136:139], a[84:87], v[100:103]
ds_read_b64_tr_b16 a[156:157], v2 offset:21632
v_mfma_f32_16x16x32_bf16 v[116:119], a[140:143], a[84:87], v[116:119]
ds_read_b64_tr_b16 a[158:159], v2 offset:25216
v_mfma_f32_16x16x32_bf16 v[112:115], a[140:143], a[80:83], v[112:115]
buffer_load_dwordx4 a[8:11], v22, s[8:11], s20 offen offset:2048
v_mfma_f32_16x16x32_bf16 v[96:99], a[136:139], a[80:83], v[96:99]
s_waitcnt lgkmcnt(4)
v_mfma_f32_16x16x32_bf16 v[128:131], a[144:147], a[80:83], v[128:131]
ds_read_b64_tr_b16 a[128:129], v2 offset:14496
v_mfma_f32_16x16x32_bf16 v[144:147], a[148:151], a[80:83], v[144:147]
ds_read_b64_tr_b16 a[130:131], v2 offset:18080
v_mfma_f32_16x16x32_bf16 v[148:151], a[148:151], a[84:87], v[148:151]
buffer_load_dwordx4 a[12:15], v22, s[8:11], s20 offen offset:3072
v_mfma_f32_16x16x32_bf16 v[132:135], a[144:147], a[84:87], v[132:135]
s_add_u32 s20, s20, 4096
v_mfma_f32_16x16x32_bf16 v[136:139], a[144:147], a[88:91], v[136:139]
ds_read_b64_tr_b16 a[132:133], v2 offset:21664
v_mfma_f32_16x16x32_bf16 v[152:155], a[148:151], a[88:91], v[152:155]
ds_read_b64_tr_b16 a[134:135], v2 offset:25248
v_mfma_f32_16x16x32_bf16 v[156:159], a[148:151], a[92:95], v[156:159]
v_mfma_f32_16x16x32_bf16 v[140:143], a[144:147], a[92:95], v[140:143]
s_waitcnt lgkmcnt(4)
v_mfma_f32_16x16x32_bf16 v[172:175], a[152:155], a[92:95], v[172:175]
ds_read_b64_tr_b16 a[136:137], v2 offset:14528
v_mfma_f32_16x16x32_bf16 v[188:191], a[156:159], a[92:95], v[188:191]
ds_read_b64_tr_b16 a[138:139], v2 offset:18112
v_mfma_f32_16x16x32_bf16 v[184:187], a[156:159], a[88:91], v[184:187]
buffer_load_dwordx4 a[16:19], v22, s[8:11], s20 offen offset:0
v_mfma_f32_16x16x32_bf16 v[168:171], a[152:155], a[88:91], v[168:171]
v_mfma_f32_16x16x32_bf16 v[164:167], a[152:155], a[84:87], v[164:167]
ds_read_b64_tr_b16 a[140:141], v2 offset:21696
v_mfma_f32_16x16x32_bf16 v[180:183], a[156:159], a[84:87], v[180:183]
ds_read_b64_tr_b16 a[142:143], v2 offset:25280
v_mfma_f32_16x16x32_bf16 v[176:179], a[156:159], a[80:83], v[176:179]
v_mfma_f32_16x16x32_bf16 v[160:163], a[152:155], a[80:83], v[160:163]
s_waitcnt lgkmcnt(4)
v_mfma_f32_16x16x32_bf16 v[192:195], a[128:131], a[80:83], v[192:195]
ds_read_b64_tr_b16 a[144:145], v2 offset:28672
v_mfma_f32_16x16x32_bf16 v[208:211], a[132:135], a[80:83], v[208:211]
ds_read_b64_tr_b16 a[146:147], v2 offset:32256
v_mfma_f32_16x16x32_bf16 v[212:215], a[132:135], a[84:87], v[212:215]
buffer_load_dwordx4 a[20:23], v22, s[8:11], s20 offen offset:1024
v_mfma_f32_16x16x32_bf16 v[196:199], a[128:131], a[84:87], v[196:199]
v_mfma_f32_16x16x32_bf16 v[200:203], a[128:131], a[88:91], v[200:203]
ds_read_b64_tr_b16 a[148:149], v2 offset:35840
v_mfma_f32_16x16x32_bf16 v[216:219], a[132:135], a[88:91], v[216:219]
ds_read_b64_tr_b16 a[150:151], v2 offset:39424
v_mfma_f32_16x16x32_bf16 v[220:223], a[132:135], a[92:95], v[220:223]
buffer_load_dwordx4 a[24:27], v22, s[8:11], s20 offen offset:2048
v_mfma_f32_16x16x32_bf16 v[204:207], a[128:131], a[92:95], v[204:207]
s_waitcnt lgkmcnt(4)
v_mfma_f32_16x16x32_bf16 v[236:239], a[136:139], a[92:95], v[236:239]
ds_read_b64_tr_b16 a[152:153], v2 offset:28704
v_mfma_f32_16x16x32_bf16 v[252:255], a[140:143], a[92:95], v[252:255]
ds_read_b64_tr_b16 a[154:155], v2 offset:32288
v_mfma_f32_16x16x32_bf16 v[248:251], a[140:143], a[88:91], v[248:251]
v_mfma_f32_16x16x32_bf16 v[232:235], a[136:139], a[88:91], v[232:235]
v_mfma_f32_16x16x32_bf16 v[228:231], a[136:139], a[84:87], v[228:231]
ds_read_b64_tr_b16 a[156:157], v2 offset:35872
v_mfma_f32_16x16x32_bf16 v[244:247], a[140:143], a[84:87], v[244:247]
ds_read_b64_tr_b16 a[158:159], v2 offset:39456
v_mfma_f32_16x16x32_bf16 v[240:243], a[140:143], a[80:83], v[240:243]
buffer_load_dwordx4 a[28:31], v22, s[8:11], s20 offen offset:3072
v_mfma_f32_16x16x32_bf16 v[224:227], a[136:139], a[80:83], v[224:227]
s_add_u32 s20, s69, s77
s_waitcnt vmcnt(20) lgkmcnt(4)
v_mfma_f32_16x16x32_bf16 v[32:35], a[144:147], a[96:99], v[32:35]
ds_read_b64_tr_b16 a[128:129], v2 offset:28736
v_mfma_f32_16x16x32_bf16 v[48:51], a[148:151], a[96:99], v[48:51]
ds_read_b64_tr_b16 a[130:131], v2 offset:32320
s_add_u32 m0, s22, 28672
v_mfma_f32_16x16x32_bf16 v[52:55], a[148:151], a[100:103], v[52:55]
buffer_load_dwordx4 v4, s[12:15], s21 offen offset:0  lds
v_mfma_f32_16x16x32_bf16 v[36:39], a[144:147], a[100:103], v[36:39]
v_mfma_f32_16x16x32_bf16 v[40:43], a[144:147], a[104:107], v[40:43]
ds_read_b64_tr_b16 a[132:133], v2 offset:35904
v_mfma_f32_16x16x32_bf16 v[56:59], a[148:151], a[104:107], v[56:59]
ds_read_b64_tr_b16 a[134:135], v2 offset:39488
v_mfma_f32_16x16x32_bf16 v[60:63], a[148:151], a[108:111], v[60:63]
v_mfma_f32_16x16x32_bf16 v[44:47], a[144:147], a[108:111], v[44:47]
s_waitcnt lgkmcnt(4)
v_mfma_f32_16x16x32_bf16 v[76:79], a[152:155], a[108:111], v[76:79]
ds_read_b64_tr_b16 a[136:137], v2 offset:28768
v_mfma_f32_16x16x32_bf16 v[92:95], a[156:159], a[108:111], v[92:95]
ds_read_b64_tr_b16 a[138:139], v2 offset:32352
v_mfma_f32_16x16x32_bf16 v[88:91], a[156:159], a[104:107], v[88:91]
buffer_load_dwordx4 v5, s[12:15], s21 offen offset:1024  lds
v_mfma_f32_16x16x32_bf16 v[72:75], a[152:155], a[104:107], v[72:75]
v_mfma_f32_16x16x32_bf16 v[68:71], a[152:155], a[100:103], v[68:71]
ds_read_b64_tr_b16 a[140:141], v2 offset:35936
v_mfma_f32_16x16x32_bf16 v[84:87], a[156:159], a[100:103], v[84:87]
ds_read_b64_tr_b16 a[142:143], v2 offset:39520
v_mfma_f32_16x16x32_bf16 v[80:83], a[156:159], a[96:99], v[80:83]
v_mfma_f32_16x16x32_bf16 v[64:67], a[152:155], a[96:99], v[64:67]
s_waitcnt lgkmcnt(4)
v_mfma_f32_16x16x32_bf16 v[96:99], a[128:131], a[96:99], v[96:99]
ds_read_b64_tr_b16 a[144:145], v2 offset:28800
v_mfma_f32_16x16x32_bf16 v[112:115], a[132:135], a[96:99], v[112:115]
ds_read_b64_tr_b16 a[146:147], v2 offset:32384
v_mfma_f32_16x16x32_bf16 v[116:119], a[132:135], a[100:103], v[116:119]
buffer_load_dwordx4 v6, s[12:15], s21 offen offset:2048  lds
v_mfma_f32_16x16x32_bf16 v[100:103], a[128:131], a[100:103], v[100:103]
v_mfma_f32_16x16x32_bf16 v[104:107], a[128:131], a[104:107], v[104:107]
ds_read_b64_tr_b16 a[148:149], v2 offset:35968
v_mfma_f32_16x16x32_bf16 v[120:123], a[132:135], a[104:107], v[120:123]
ds_read_b64_tr_b16 a[150:151], v2 offset:39552
v_mfma_f32_16x16x32_bf16 v[124:127], a[132:135], a[108:111], v[124:127]
v_mfma_f32_16x16x32_bf16 v[108:111], a[128:131], a[108:111], v[108:111]
s_waitcnt lgkmcnt(4)
v_mfma_f32_16x16x32_bf16 v[140:143], a[136:139], a[108:111], v[140:143]
ds_read_b64_tr_b16 a[152:153], v2 offset:28832
v_mfma_f32_16x16x32_bf16 v[156:159], a[140:143], a[108:111], v[156:159]
ds_read_b64_tr_b16 a[154:155], v2 offset:32416
v_mfma_f32_16x16x32_bf16 v[152:155], a[140:143], a[104:107], v[152:155]
buffer_load_dwordx4 v7, s[12:15], s21 offen offset:3072  lds
v_mfma_f32_16x16x32_bf16 v[136:139], a[136:139], a[104:107], v[136:139]
v_mfma_f32_16x16x32_bf16 v[132:135], a[136:139], a[100:103], v[132:135]
ds_read_b64_tr_b16 a[156:157], v2 offset:36000
v_mfma_f32_16x16x32_bf16 v[148:151], a[140:143], a[100:103], v[148:151]
ds_read_b64_tr_b16 a[158:159], v2 offset:39584
v_mfma_f32_16x16x32_bf16 v[144:147], a[140:143], a[96:99], v[144:147]
v_mfma_f32_16x16x32_bf16 v[128:131], a[136:139], a[96:99], v[128:131]
s_waitcnt lgkmcnt(4)
v_mfma_f32_16x16x32_bf16 v[160:163], a[144:147], a[96:99], v[160:163]
ds_read_b64_tr_b16 a[128:129], v2 offset:28864
v_mfma_f32_16x16x32_bf16 v[176:179], a[148:151], a[96:99], v[176:179]
ds_read_b64_tr_b16 a[130:131], v2 offset:32448
s_add_u32 m0, s22, 32768
v_mfma_f32_16x16x32_bf16 v[180:183], a[148:151], a[100:103], v[180:183]
buffer_load_dwordx4 v8, s[12:15], s21 offen offset:0  lds
v_mfma_f32_16x16x32_bf16 v[164:167], a[144:147], a[100:103], v[164:167]
v_mfma_f32_16x16x32_bf16 v[168:171], a[144:147], a[104:107], v[168:171]
ds_read_b64_tr_b16 a[132:133], v2 offset:36032
v_mfma_f32_16x16x32_bf16 v[184:187], a[148:151], a[104:107], v[184:187]
ds_read_b64_tr_b16 a[134:135], v2 offset:39616
v_mfma_f32_16x16x32_bf16 v[188:191], a[148:151], a[108:111], v[188:191]
v_mfma_f32_16x16x32_bf16 v[172:175], a[144:147], a[108:111], v[172:175]
s_waitcnt lgkmcnt(4)
v_mfma_f32_16x16x32_bf16 v[204:207], a[152:155], a[108:111], v[204:207]
ds_read_b64_tr_b16 a[136:137], v2 offset:43008
v_mfma_f32_16x16x32_bf16 v[220:223], a[156:159], a[108:111], v[220:223]
ds_read_b64_tr_b16 a[138:139], v2 offset:46592
v_mfma_f32_16x16x32_bf16 v[216:219], a[156:159], a[104:107], v[216:219]
buffer_load_dwordx4 v9, s[12:15], s21 offen offset:1024  lds
v_mfma_f32_16x16x32_bf16 v[200:203], a[152:155], a[104:107], v[200:203]
v_mfma_f32_16x16x32_bf16 v[196:199], a[152:155], a[100:103], v[196:199]
ds_read_b64_tr_b16 a[140:141], v2 offset:50176
v_mfma_f32_16x16x32_bf16 v[212:215], a[156:159], a[100:103], v[212:215]
ds_read_b64_tr_b16 a[142:143], v2 offset:53760
v_mfma_f32_16x16x32_bf16 v[208:211], a[156:159], a[96:99], v[208:211]
v_mfma_f32_16x16x32_bf16 v[192:195], a[152:155], a[96:99], v[192:195]
s_waitcnt lgkmcnt(4)
v_mfma_f32_16x16x32_bf16 v[224:227], a[128:131], a[96:99], v[224:227]
ds_read_b64_tr_b16 a[144:145], v2 offset:43040
v_mfma_f32_16x16x32_bf16 v[240:243], a[132:135], a[96:99], v[240:243]
ds_read_b64_tr_b16 a[146:147], v2 offset:46624
v_mfma_f32_16x16x32_bf16 v[244:247], a[132:135], a[100:103], v[244:247]
buffer_load_dwordx4 v10, s[12:15], s21 offen offset:2048  lds
v_mfma_f32_16x16x32_bf16 v[228:231], a[128:131], a[100:103], v[228:231]
s_add_u32 s21, s68, s66
v_mfma_f32_16x16x32_bf16 v[232:235], a[128:131], a[104:107], v[232:235]
ds_read_b64_tr_b16 a[148:149], v2 offset:50208
v_mfma_f32_16x16x32_bf16 v[248:251], a[132:135], a[104:107], v[248:251]
ds_read_b64_tr_b16 a[150:151], v2 offset:53792
s_min_u32 m0, s71, s72
v_mfma_f32_16x16x32_bf16 v[252:255], a[132:135], a[108:111], v[252:255]
buffer_load_dwordx4 v11, s[56:59], s70 offen nt lds
v_mfma_f32_16x16x32_bf16 v[236:239], a[128:131], a[108:111], v[236:239]
s_add_u32 s71, s71, 4096
s_waitcnt vmcnt(17) lgkmcnt(4)
s_barrier
v_mfma_f32_16x16x32_bf16 v[44:47], a[136:139], a[124:127], v[44:47]
ds_read_b64_tr_b16 a[152:153], v2 offset:43072
s_add_u32 s70, s70, 65536
v_mfma_f32_16x16x32_bf16 v[60:63], a[140:143], a[124:127], v[60:63]
ds_read_b64_tr_b16 a[154:155], v2 offset:46656
v_mfma_f32_16x16x32_bf16 v[56:59], a[140:143], a[120:123], v[56:59]
v_mfma_f32_16x16x32_bf16 v[40:43], a[136:139], a[120:123], v[40:43]
v_mfma_f32_16x16x32_bf16 v[36:39], a[136:139], a[116:119], v[36:39]
ds_read_b64_tr_b16 a[156:157], v2 offset:50240
v_mfma_f32_16x16x32_bf16 v[52:55], a[140:143], a[116:119], v[52:55]
ds_read_b64_tr_b16 a[158:159], v2 offset:53824
v_mfma_f32_16x16x32_bf16 v[48:51], a[140:143], a[112:115], v[48:51]
buffer_load_dwordx4 a[32:35], v22, s[8:11], s20 offen offset:0
v_mfma_f32_16x16x32_bf16 v[32:35], a[136:139], a[112:115], v[32:35]
s_waitcnt lgkmcnt(4)
v_mfma_f32_16x16x32_bf16 v[64:67], a[144:147], a[112:115], v[64:67]
ds_read_b64_tr_b16 a[128:129], v2 offset:43104
v_mfma_f32_16x16x32_bf16 v[80:83], a[148:151], a[112:115], v[80:83]
ds_read_b64_tr_b16 a[130:131], v2 offset:46688
v_mfma_f32_16x16x32_bf16 v[84:87], a[148:151], a[116:119], v[84:87]
v_mfma_f32_16x16x32_bf16 v[68:71], a[144:147], a[116:119], v[68:71]
v_mfma_f32_16x16x32_bf16 v[72:75], a[144:147], a[120:123], v[72:75]
ds_read_b64_tr_b16 a[132:133], v2 offset:50272
v_mfma_f32_16x16x32_bf16 v[88:91], a[148:151], a[120:123], v[88:91]
ds_read_b64_tr_b16 a[134:135], v2 offset:53856
v_mfma_f32_16x16x32_bf16 v[92:95], a[148:151], a[124:127], v[92:95]
buffer_load_dwordx4 a[36:39], v22, s[8:11], s20 offen offset:1024
v_mfma_f32_16x16x32_bf16 v[76:79], a[144:147], a[124:127], v[76:79]
s_waitcnt lgkmcnt(4)
v_mfma_f32_16x16x32_bf16 v[108:111], a[152:155], a[124:127], v[108:111]
ds_read_b64_tr_b16 a[136:137], v2 offset:43136
v_mfma_f32_16x16x32_bf16 v[124:127], a[156:159], a[124:127], v[124:127]
ds_read_b64_tr_b16 a[138:139], v2 offset:46720
v_mfma_f32_16x16x32_bf16 v[120:123], a[156:159], a[120:123], v[120:123]
v_mfma_f32_16x16x32_bf16 v[104:107], a[152:155], a[120:123], v[104:107]
v_mfma_f32_16x16x32_bf16 v[100:103], a[152:155], a[116:119], v[100:103]
ds_read_b64_tr_b16 a[140:141], v2 offset:50304
v_mfma_f32_16x16x32_bf16 v[116:119], a[156:159], a[116:119], v[116:119]
ds_read_b64_tr_b16 a[142:143], v2 offset:53888
v_mfma_f32_16x16x32_bf16 v[112:115], a[156:159], a[112:115], v[112:115]
buffer_load_dwordx4 a[40:43], v22, s[8:11], s20 offen offset:2048
v_mfma_f32_16x16x32_bf16 v[96:99], a[152:155], a[112:115], v[96:99]
s_waitcnt lgkmcnt(4)
v_mfma_f32_16x16x32_bf16 v[128:131], a[128:131], a[112:115], v[128:131]
ds_read_b64_tr_b16 a[144:145], v2 offset:43168
v_mfma_f32_16x16x32_bf16 v[144:147], a[132:135], a[112:115], v[144:147]
ds_read_b64_tr_b16 a[146:147], v2 offset:46752
v_mfma_f32_16x16x32_bf16 v[148:151], a[132:135], a[116:119], v[148:151]
buffer_load_dwordx4 a[44:47], v22, s[8:11], s20 offen offset:3072
v_mfma_f32_16x16x32_bf16 v[132:135], a[128:131], a[116:119], v[132:135]
s_add_u32 s20, s20, 4096
v_mfma_f32_16x16x32_bf16 v[136:139], a[128:131], a[120:123], v[136:139]
ds_read_b64_tr_b16 a[148:149], v2 offset:50336
v_mfma_f32_16x16x32_bf16 v[152:155], a[132:135], a[120:123], v[152:155]
ds_read_b64_tr_b16 a[150:151], v2 offset:53920
v_mfma_f32_16x16x32_bf16 v[156:159], a[132:135], a[124:127], v[156:159]
v_mfma_f32_16x16x32_bf16 v[140:143], a[128:131], a[124:127], v[140:143]
s_waitcnt lgkmcnt(4)
v_mfma_f32_16x16x32_bf16 v[172:175], a[136:139], a[124:127], v[172:175]
ds_read_b64_tr_b16 a[152:153], v2 offset:43200
v_mfma_f32_16x16x32_bf16 v[188:191], a[140:143], a[124:127], v[188:191]
ds_read_b64_tr_b16 a[154:155], v2 offset:46784
v_mfma_f32_16x16x32_bf16 v[184:187], a[140:143], a[120:123], v[184:187]
buffer_load_dwordx4 a[48:51], v22, s[8:11], s20 offen offset:0
v_mfma_f32_16x16x32_bf16 v[168:171], a[136:139], a[120:123], v[168:171]
v_mfma_f32_16x16x32_bf16 v[164:167], a[136:139], a[116:119], v[164:167]
ds_read_b64_tr_b16 a[156:157], v2 offset:50368
v_mfma_f32_16x16x32_bf16 v[180:183], a[140:143], a[116:119], v[180:183]
ds_read_b64_tr_b16 a[158:159], v2 offset:53952
v_mfma_f32_16x16x32_bf16 v[176:179], a[140:143], a[112:115], v[176:179]
v_mfma_f32_16x16x32_bf16 v[160:163], a[136:139], a[112:115], v[160:163]
s_waitcnt lgkmcnt(4)
v_mfma_f32_16x16x32_bf16 v[192:195], a[144:147], a[112:115], v[192:195]
ds_read_b64_tr_b16 a[128:129], v1 offset:0
v_mfma_f32_16x16x32_bf16 v[208:211], a[148:151], a[112:115], v[208:211]
ds_read_b64_tr_b16 a[130:131], v1 offset:3584
v_mfma_f32_16x16x32_bf16 v[212:215], a[148:151], a[116:119], v[212:215]
buffer_load_dwordx4 a[52:55], v22, s[8:11], s20 offen offset:1024
v_mfma_f32_16x16x32_bf16 v[196:199], a[144:147], a[116:119], v[196:199]
v_mfma_f32_16x16x32_bf16 v[200:203], a[144:147], a[120:123], v[200:203]
ds_read_b64_tr_b16 a[132:133], v1 offset:7168
v_mfma_f32_16x16x32_bf16 v[216:219], a[148:151], a[120:123], v[216:219]
ds_read_b64_tr_b16 a[134:135], v1 offset:10752
v_mfma_f32_16x16x32_bf16 v[220:223], a[148:151], a[124:127], v[220:223]
buffer_load_dwordx4 a[56:59], v22, s[8:11], s20 offen offset:2048
v_mfma_f32_16x16x32_bf16 v[204:207], a[144:147], a[124:127], v[204:207]
s_waitcnt lgkmcnt(4)
v_mfma_f32_16x16x32_bf16 v[236:239], a[152:155], a[124:127], v[236:239]
ds_read_b64_tr_b16 a[136:137], v1 offset:32
v_mfma_f32_16x16x32_bf16 v[252:255], a[156:159], a[124:127], v[252:255]
ds_read_b64_tr_b16 a[138:139], v1 offset:3616
v_mfma_f32_16x16x32_bf16 v[248:251], a[156:159], a[120:123], v[248:251]
v_mfma_f32_16x16x32_bf16 v[232:235], a[152:155], a[120:123], v[232:235]
v_mfma_f32_16x16x32_bf16 v[228:231], a[152:155], a[116:119], v[228:231]
ds_read_b64_tr_b16 a[140:141], v1 offset:7200
v_mfma_f32_16x16x32_bf16 v[244:247], a[156:159], a[116:119], v[244:247]
ds_read_b64_tr_b16 a[142:143], v1 offset:10784
v_mfma_f32_16x16x32_bf16 v[240:243], a[156:159], a[112:115], v[240:243]
buffer_load_dwordx4 a[60:63], v22, s[8:11], s20 offen offset:3072
v_mfma_f32_16x16x32_bf16 v[224:227], a[152:155], a[112:115], v[224:227]
s_add_u32 s20, s69, s78
s_waitcnt vmcnt(20) lgkmcnt(4)
v_mfma_f32_16x16x32_bf16 v[32:35], a[128:131], a[0:3], v[32:35]
ds_read_b64_tr_b16 a[144:145], v1 offset:64
v_mfma_f32_16x16x32_bf16 v[48:51], a[132:135], a[0:3], v[48:51]
ds_read_b64_tr_b16 a[146:147], v1 offset:3648
s_add_u32 m0, s22, 57344
v_mfma_f32_16x16x32_bf16 v[52:55], a[132:135], a[4:7], v[52:55]
buffer_load_dwordx4 v4, s[12:15], s21 offen offset:0  lds
v_mfma_f32_16x16x32_bf16 v[36:39], a[128:131], a[4:7], v[36:39]
v_mfma_f32_16x16x32_bf16 v[40:43], a[128:131], a[8:11], v[40:43]
ds_read_b64_tr_b16 a[148:149], v1 offset:7232
v_mfma_f32_16x16x32_bf16 v[56:59], a[132:135], a[8:11], v[56:59]
ds_read_b64_tr_b16 a[150:151], v1 offset:10816
v_mfma_f32_16x16x32_bf16 v[60:63], a[132:135], a[12:15], v[60:63]
v_mfma_f32_16x16x32_bf16 v[44:47], a[128:131], a[12:15], v[44:47]
s_waitcnt lgkmcnt(4)
v_mfma_f32_16x16x32_bf16 v[76:79], a[136:139], a[12:15], v[76:79]
ds_read_b64_tr_b16 a[152:153], v1 offset:96
v_mfma_f32_16x16x32_bf16 v[92:95], a[140:143], a[12:15], v[92:95]
ds_read_b64_tr_b16 a[154:155], v1 offset:3680
v_mfma_f32_16x16x32_bf16 v[88:91], a[140:143], a[8:11], v[88:91]
buffer_load_dwordx4 v5, s[12:15], s21 offen offset:1024  lds
v_mfma_f32_16x16x32_bf16 v[72:75], a[136:139], a[8:11], v[72:75]
v_mfma_f32_16x16x32_bf16 v[68:71], a[136:139], a[4:7], v[68:71]
ds_read_b64_tr_b16 a[156:157], v1 offset:7264
v_mfma_f32_16x16x32_bf16 v[84:87], a[140:143], a[4:7], v[84:87]
ds_read_b64_tr_b16 a[158:159], v1 offset:10848
v_mfma_f32_16x16x32_bf16 v[80:83], a[140:143], a[0:3], v[80:83]
v_mfma_f32_16x16x32_bf16 v[64:67], a[136:139], a[0:3], v[64:67]
s_waitcnt lgkmcnt(4)
v_mfma_f32_16x16x32_bf16 v[96:99], a[144:147], a[0:3], v[96:99]
ds_read_b64_tr_b16 a[128:129], v1 offset:128
v_mfma_f32_16x16x32_bf16 v[112:115], a[148:151], a[0:3], v[112:115]
ds_read_b64_tr_b16 a[130:131], v1 offset:3712
v_mfma_f32_16x16x32_bf16 v[116:119], a[148:151], a[4:7], v[116:119]
buffer_load_dwordx4 v6, s[12:15], s21 offen offset:2048  lds
v_mfma_f32_16x16x32_bf16 v[100:103], a[144:147], a[4:7], v[100:103]
v_mfma_f32_16x16x32_bf16 v[104:107], a[144:147], a[8:11], v[104:107]
ds_read_b64_tr_b16 a[132:133], v1 offset:7296
v_mfma_f32_16x16x32_bf16 v[120:123], a[148:151], a[8:11], v[120:123]
ds_read_b64_tr_b16 a[134:135], v1 offset:10880
v_mfma_f32_16x16x32_bf16 v[124:127], a[148:151], a[12:15], v[124:127]
v_mfma_f32_16x16x32_bf16 v[108:111], a[144:147], a[12:15], v[108:111]
s_waitcnt lgkmcnt(4)
v_mfma_f32_16x16x32_bf16 v[140:143], a[152:155], a[12:15], v[140:143]
ds_read_b64_tr_b16 a[136:137], v1 offset:160
v_mfma_f32_16x16x32_bf16 v[156:159], a[156:159], a[12:15], v[156:159]
ds_read_b64_tr_b16 a[138:139], v1 offset:3744
v_mfma_f32_16x16x32_bf16 v[152:155], a[156:159], a[8:11], v[152:155]
buffer_load_dwordx4 v7, s[12:15], s21 offen offset:3072  lds
v_mfma_f32_16x16x32_bf16 v[136:139], a[152:155], a[8:11], v[136:139]
v_mfma_f32_16x16x32_bf16 v[132:135], a[152:155], a[4:7], v[132:135]
ds_read_b64_tr_b16 a[140:141], v1 offset:7328
v_mfma_f32_16x16x32_bf16 v[148:151], a[156:159], a[4:7], v[148:151]
ds_read_b64_tr_b16 a[142:143], v1 offset:10912
v_mfma_f32_16x16x32_bf16 v[144:147], a[156:159], a[0:3], v[144:147]
v_mfma_f32_16x16x32_bf16 v[128:131], a[152:155], a[0:3], v[128:131]
s_waitcnt lgkmcnt(4)
v_mfma_f32_16x16x32_bf16 v[160:163], a[128:131], a[0:3], v[160:163]
ds_read_b64_tr_b16 a[144:145], v1 offset:192
v_mfma_f32_16x16x32_bf16 v[176:179], a[132:135], a[0:3], v[176:179]
ds_read_b64_tr_b16 a[146:147], v1 offset:3776
s_add_u32 m0, s22, 61440
v_mfma_f32_16x16x32_bf16 v[180:183], a[132:135], a[4:7], v[180:183]
buffer_load_dwordx4 v8, s[12:15], s21 offen offset:0  lds
v_mfma_f32_16x16x32_bf16 v[164:167], a[128:131], a[4:7], v[164:167]
v_mfma_f32_16x16x32_bf16 v[168:171], a[128:131], a[8:11], v[168:171]
ds_read_b64_tr_b16 a[148:149], v1 offset:7360
v_mfma_f32_16x16x32_bf16 v[184:187], a[132:135], a[8:11], v[184:187]
ds_read_b64_tr_b16 a[150:151], v1 offset:10944
v_mfma_f32_16x16x32_bf16 v[188:191], a[132:135], a[12:15], v[188:191]
v_mfma_f32_16x16x32_bf16 v[172:175], a[128:131], a[12:15], v[172:175]
s_waitcnt lgkmcnt(4)
v_mfma_f32_16x16x32_bf16 v[204:207], a[136:139], a[12:15], v[204:207]
ds_read_b64_tr_b16 a[152:153], v1 offset:14336
v_mfma_f32_16x16x32_bf16 v[220:223], a[140:143], a[12:15], v[220:223]
ds_read_b64_tr_b16 a[154:155], v1 offset:17920
v_mfma_f32_16x16x32_bf16 v[216:219], a[140:143], a[8:11], v[216:219]
buffer_load_dwordx4 v9, s[12:15], s21 offen offset:1024  lds
v_mfma_f32_16x16x32_bf16 v[200:203], a[136:139], a[8:11], v[200:203]
v_mfma_f32_16x16x32_bf16 v[196:199], a[136:139], a[4:7], v[196:199]
ds_read_b64_tr_b16 a[156:157], v1 offset:21504
v_mfma_f32_16x16x32_bf16 v[212:215], a[140:143], a[4:7], v[212:215]
ds_read_b64_tr_b16 a[158:159], v1 offset:25088
v_mfma_f32_16x16x32_bf16 v[208:211], a[140:143], a[0:3], v[208:211]
v_mfma_f32_16x16x32_bf16 v[192:195], a[136:139], a[0:3], v[192:195]
s_waitcnt lgkmcnt(4)
v_mfma_f32_16x16x32_bf16 v[224:227], a[144:147], a[0:3], v[224:227]
ds_read_b64_tr_b16 a[128:129], v1 offset:14368
v_mfma_f32_16x16x32_bf16 v[240:243], a[148:151], a[0:3], v[240:243]
ds_read_b64_tr_b16 a[130:131], v1 offset:17952
v_mfma_f32_16x16x32_bf16 v[244:247], a[148:151], a[4:7], v[244:247]
buffer_load_dwordx4 v10, s[12:15], s21 offen offset:2048  lds
v_mfma_f32_16x16x32_bf16 v[228:231], a[144:147], a[4:7], v[228:231]
s_add_u32 s21, s68, s67
v_mfma_f32_16x16x32_bf16 v[232:235], a[144:147], a[8:11], v[232:235]
ds_read_b64_tr_b16 a[132:133], v1 offset:21536
v_mfma_f32_16x16x32_bf16 v[248:251], a[148:151], a[8:11], v[248:251]
ds_read_b64_tr_b16 a[134:135], v1 offset:25120
s_min_u32 m0, s71, s72
v_mfma_f32_16x16x32_bf16 v[252:255], a[148:151], a[12:15], v[252:255]
buffer_load_dwordx4 v11, s[56:59], s70 offen nt lds
v_mfma_f32_16x16x32_bf16 v[236:239], a[144:147], a[12:15], v[236:239]
s_add_u32 s71, s71, 4096
s_waitcnt vmcnt(17) lgkmcnt(4)
s_barrier
v_mfma_f32_16x16x32_bf16 v[44:47], a[152:155], a[28:31], v[44:47]
ds_read_b64_tr_b16 a[136:137], v1 offset:14400
s_add_u32 s70, s70, 65536
v_mfma_f32_16x16x32_bf16 v[60:63], a[156:159], a[28:31], v[60:63]
ds_read_b64_tr_b16 a[138:139], v1 offset:17984
v_mfma_f32_16x16x32_bf16 v[56:59], a[156:159], a[24:27], v[56:59]
v_mfma_f32_16x16x32_bf16 v[40:43], a[152:155], a[24:27], v[40:43]
v_mfma_f32_16x16x32_bf16 v[36:39], a[152:155], a[20:23], v[36:39]
ds_read_b64_tr_b16 a[140:141], v1 offset:21568
v_mfma_f32_16x16x32_bf16 v[52:55], a[156:159], a[20:23], v[52:55]
ds_read_b64_tr_b16 a[142:143], v1 offset:25152
v_mfma_f32_16x16x32_bf16 v[48:51], a[156:159], a[16:19], v[48:51]
buffer_load_dwordx4 a[64:67], v22, s[8:11], s20 offen offset:0
v_mfma_f32_16x16x32_bf16 v[32:35], a[152:155], a[16:19], v[32:35]
s_waitcnt lgkmcnt(4)
v_mfma_f32_16x16x32_bf16 v[64:67], a[128:131], a[16:19], v[64:67]
ds_read_b64_tr_b16 a[144:145], v1 offset:14432
v_mfma_f32_16x16x32_bf16 v[80:83], a[132:135], a[16:19], v[80:83]
ds_read_b64_tr_b16 a[146:147], v1 offset:18016
v_mfma_f32_16x16x32_bf16 v[84:87], a[132:135], a[20:23], v[84:87]
v_mfma_f32_16x16x32_bf16 v[68:71], a[128:131], a[20:23], v[68:71]
v_mfma_f32_16x16x32_bf16 v[72:75], a[128:131], a[24:27], v[72:75]
ds_read_b64_tr_b16 a[148:149], v1 offset:21600
v_mfma_f32_16x16x32_bf16 v[88:91], a[132:135], a[24:27], v[88:91]
ds_read_b64_tr_b16 a[150:151], v1 offset:25184
v_mfma_f32_16x16x32_bf16 v[92:95], a[132:135], a[28:31], v[92:95]
buffer_load_dwordx4 a[68:71], v22, s[8:11], s20 offen offset:1024
v_mfma_f32_16x16x32_bf16 v[76:79], a[128:131], a[28:31], v[76:79]
s_waitcnt lgkmcnt(4)
v_mfma_f32_16x16x32_bf16 v[108:111], a[136:139], a[28:31], v[108:111]
ds_read_b64_tr_b16 a[152:153], v1 offset:14464
v_mfma_f32_16x16x32_bf16 v[124:127], a[140:143], a[28:31], v[124:127]
ds_read_b64_tr_b16 a[154:155], v1 offset:18048
v_mfma_f32_16x16x32_bf16 v[120:123], a[140:143], a[24:27], v[120:123]
v_mfma_f32_16x16x32_bf16 v[104:107], a[136:139], a[24:27], v[104:107]
v_mfma_f32_16x16x32_bf16 v[100:103], a[136:139], a[20:23], v[100:103]
ds_read_b64_tr_b16 a[156:157], v1 offset:21632
v_mfma_f32_16x16x32_bf16 v[116:119], a[140:143], a[20:23], v[116:119]
ds_read_b64_tr_b16 a[158:159], v1 offset:25216
v_mfma_f32_16x16x32_bf16 v[112:115], a[140:143], a[16:19], v[112:115]
buffer_load_dwordx4 a[72:75], v22, s[8:11], s20 offen offset:2048
v_mfma_f32_16x16x32_bf16 v[96:99], a[136:139], a[16:19], v[96:99]
s_waitcnt lgkmcnt(4)
v_mfma_f32_16x16x32_bf16 v[128:131], a[144:147], a[16:19], v[128:131]
ds_read_b64_tr_b16 a[128:129], v1 offset:14496
v_mfma_f32_16x16x32_bf16 v[144:147], a[148:151], a[16:19], v[144:147]
ds_read_b64_tr_b16 a[130:131], v1 offset:18080
v_mfma_f32_16x16x32_bf16 v[148:151], a[148:151], a[20:23], v[148:151]
buffer_load_dwordx4 a[76:79], v22, s[8:11], s20 offen offset:3072
v_mfma_f32_16x16x32_bf16 v[132:135], a[144:147], a[20:23], v[132:135]
s_add_u32 s20, s20, 4096
v_mfma_f32_16x16x32_bf16 v[136:139], a[144:147], a[24:27], v[136:139]
ds_read_b64_tr_b16 a[132:133], v1 offset:21664
v_mfma_f32_16x16x32_bf16 v[152:155], a[148:151], a[24:27], v[152:155]
ds_read_b64_tr_b16 a[134:135], v1 offset:25248
v_mfma_f32_16x16x32_bf16 v[156:159], a[148:151], a[28:31], v[156:159]
v_mfma_f32_16x16x32_bf16 v[140:143], a[144:147], a[28:31], v[140:143]
s_waitcnt lgkmcnt(4)
v_mfma_f32_16x16x32_bf16 v[172:175], a[152:155], a[28:31], v[172:175]
ds_read_b64_tr_b16 a[136:137], v1 offset:14528
v_mfma_f32_16x16x32_bf16 v[188:191], a[156:159], a[28:31], v[188:191]
ds_read_b64_tr_b16 a[138:139], v1 offset:18112
v_mfma_f32_16x16x32_bf16 v[184:187], a[156:159], a[24:27], v[184:187]
buffer_load_dwordx4 a[80:83], v22, s[8:11], s20 offen offset:0
v_mfma_f32_16x16x32_bf16 v[168:171], a[152:155], a[24:27], v[168:171]
v_mfma_f32_16x16x32_bf16 v[164:167], a[152:155], a[20:23], v[164:167]
ds_read_b64_tr_b16 a[140:141], v1 offset:21696
v_mfma_f32_16x16x32_bf16 v[180:183], a[156:159], a[20:23], v[180:183]
ds_read_b64_tr_b16 a[142:143], v1 offset:25280
v_mfma_f32_16x16x32_bf16 v[176:179], a[156:159], a[16:19], v[176:179]
v_mfma_f32_16x16x32_bf16 v[160:163], a[152:155], a[16:19], v[160:163]
s_waitcnt lgkmcnt(4)
v_mfma_f32_16x16x32_bf16 v[192:195], a[128:131], a[16:19], v[192:195]
ds_read_b64_tr_b16 a[144:145], v1 offset:28672
v_mfma_f32_16x16x32_bf16 v[208:211], a[132:135], a[16:19], v[208:211]
ds_read_b64_tr_b16 a[146:147], v1 offset:32256
v_mfma_f32_16x16x32_bf16 v[212:215], a[132:135], a[20:23], v[212:215]
buffer_load_dwordx4 a[84:87], v22, s[8:11], s20 offen offset:1024
v_mfma_f32_16x16x32_bf16 v[196:199], a[128:131], a[20:23], v[196:199]
v_mfma_f32_16x16x32_bf16 v[200:203], a[128:131], a[24:27], v[200:203]
ds_read_b64_tr_b16 a[148:149], v1 offset:35840
v_mfma_f32_16x16x32_bf16 v[216:219], a[132:135], a[24:27], v[216:219]
ds_read_b64_tr_b16 a[150:151], v1 offset:39424
v_mfma_f32_16x16x32_bf16 v[220:223], a[132:135], a[28:31], v[220:223]
buffer_load_dwordx4 a[88:91], v22, s[8:11], s20 offen offset:2048
v_mfma_f32_16x16x32_bf16 v[204:207], a[128:131], a[28:31], v[204:207]
s_waitcnt lgkmcnt(4)
v_mfma_f32_16x16x32_bf16 v[236:239], a[136:139], a[28:31], v[236:239]
ds_read_b64_tr_b16 a[152:153], v1 offset:28704
v_mfma_f32_16x16x32_bf16 v[252:255], a[140:143], a[28:31], v[252:255]
ds_read_b64_tr_b16 a[154:155], v1 offset:32288
v_mfma_f32_16x16x32_bf16 v[248:251], a[140:143], a[24:27], v[248:251]
v_mfma_f32_16x16x32_bf16 v[232:235], a[136:139], a[24:27], v[232:235]
v_mfma_f32_16x16x32_bf16 v[228:231], a[136:139], a[20:23], v[228:231]
ds_read_b64_tr_b16 a[156:157], v1 offset:35872
v_mfma_f32_16x16x32_bf16 v[244:247], a[140:143], a[20:23], v[244:247]
ds_read_b64_tr_b16 a[158:159], v1 offset:39456
v_mfma_f32_16x16x32_bf16 v[240:243], a[140:143], a[16:19], v[240:243]
buffer_load_dwordx4 a[92:95], v22, s[8:11], s20 offen offset:3072
v_mfma_f32_16x16x32_bf16 v[224:227], a[136:139], a[16:19], v[224:227]
s_add_u32 s20, s69, s79
s_sub_u32 s35, s35, 1
s_cmp_lg_u32 s35, 0
s_cbranch_scc1 interleave_layers__ssm_conv_h3__geglu_ffn__prompt_kernel_g1loop
interleave_layers__ssm_conv_h3__geglu_ffn__prompt_kernel_g1tail:
s_cmp_eq_u32 s60, 0
s_cbranch_scc1 interleave_layers__ssm_conv_h3__geglu_ffn__prompt_kernel_nopk2
ds_read_b64_tr_b16 a[160:161], v23 offset:0
ds_read_b64_tr_b16 a[162:163], v23 offset:2048
ds_read_b64_tr_b16 a[164:165], v23 offset:4096
ds_read_b64_tr_b16 a[166:167], v23 offset:6144
ds_read_b64_tr_b16 a[168:169], v23 offset:8192
ds_read_b64_tr_b16 a[170:171], v23 offset:10240
ds_read_b64_tr_b16 a[172:173], v24
ds_read_b64_tr_b16 a[174:175], v25
ds_read_b64_tr_b16 a[176:177], v23 offset:16384
ds_read_b64_tr_b16 a[178:179], v23 offset:18432
ds_read_b64_tr_b16 a[180:181], v23 offset:20480
ds_read_b64_tr_b16 a[182:183], v23 offset:22528
ds_read_b64_tr_b16 a[184:185], v23 offset:24576
ds_read_b64_tr_b16 a[186:187], v23 offset:26624
s_waitcnt lgkmcnt(12)
buffer_store_dwordx4 a[160:163], v3, s[40:43], s44 offen sc1
s_add_u32 s44, s44, 4096
s_waitcnt lgkmcnt(10)
buffer_store_dwordx4 a[164:167], v3, s[40:43], s44 offen sc1
s_add_u32 s44, s44, 4096
s_waitcnt lgkmcnt(8)
buffer_store_dwordx4 a[168:171], v3, s[40:43], s44 offen sc1
s_add_u32 s44, s44, 4096
s_waitcnt lgkmcnt(6)
buffer_store_dwordx4 a[172:175], v3, s[40:43], s44 offen sc1
s_add_u32 s44, s44, 4096
s_waitcnt lgkmcnt(4)
buffer_store_dwordx4 a[176:179], v3, s[40:43], s44 offen sc1
s_add_u32 s44, s44, 4096
s_waitcnt lgkmcnt(2)
buffer_store_dwordx4 a[180:183], v3, s[40:43], s44 offen sc1
s_add_u32 s44, s44, 4096
s_waitcnt lgkmcnt(0)
buffer_store_dwordx4 a[184:187], v3, s[40:43], s44 offen sc1
interleave_layers__ssm_conv_h3__geglu_ffn__prompt_kernel_nopk2:
s_waitcnt vmcnt(20) lgkmcnt(4)
v_mfma_f32_16x16x32_bf16 v[32:35], a[144:147], a[32:35], v[32:35]
ds_read_b64_tr_b16 a[128:129], v1 offset:43008
v_mfma_f32_16x16x32_bf16 v[48:51], a[148:151], a[32:35], v[48:51]
ds_read_b64_tr_b16 a[130:131], v1 offset:46592
v_mfma_f32_16x16x32_bf16 v[52:55], a[148:151], a[36:39], v[52:55]
s_add_u32 m0, s22, 86016
s_nop 0
buffer_load_dwordx4 v4, s[12:15], s21 offen offset:0  lds
v_mfma_f32_16x16x32_bf16 v[36:39], a[144:147], a[36:39], v[36:39]
buffer_load_dwordx4 v5, s[12:15], s21 offen offset:1024  lds
v_mfma_f32_16x16x32_bf16 v[40:43], a[144:147], a[40:43], v[40:43]
ds_read_b64_tr_b16 a[132:133], v1 offset:50176
v_mfma_f32_16x16x32_bf16 v[56:59], a[148:151], a[40:43], v[56:59]
ds_read_b64_tr_b16 a[134:135], v1 offset:53760
v_mfma_f32_16x16x32_bf16 v[60:63], a[148:151], a[44:47], v[60:63]
buffer_load_dwordx4 v6, s[12:15], s21 offen offset:2048  lds
v_mfma_f32_16x16x32_bf16 v[44:47], a[144:147], a[44:47], v[44:47]
s_waitcnt vmcnt(12) lgkmcnt(4)
s_barrier
v_mfma_f32_16x16x32_bf16 v[76:79], a[152:155], a[44:47], v[76:79]
ds_read_b64_tr_b16 a[136:137], v2 offset:0
v_mfma_f32_16x16x32_bf16 v[92:95], a[156:159], a[44:47], v[92:95]
ds_read_b64_tr_b16 a[138:139], v2 offset:3584
v_mfma_f32_16x16x32_bf16 v[88:91], a[156:159], a[40:43], v[88:91]
buffer_load_dwordx4 v7, s[12:15], s21 offen offset:3072  lds
v_mfma_f32_16x16x32_bf16 v[72:75], a[152:155], a[40:43], v[72:75]
s_add_u32 m0, s22, 90112
s_nop 0
buffer_load_dwordx4 v8, s[12:15], s21 offen offset:0  lds
v_mfma_f32_16x16x32_bf16 v[68:71], a[152:155], a[36:39], v[68:71]
ds_read_b64_tr_b16 a[140:141], v2 offset:7168
v_mfma_f32_16x16x32_bf16 v[84:87], a[156:159], a[36:39], v[84:87]
ds_read_b64_tr_b16 a[142:143], v2 offset:10752
v_mfma_f32_16x16x32_bf16 v[80:83], a[156:159], a[32:35], v[80:83]
buffer_load_dwordx4 v9, s[12:15], s21 offen offset:1024  lds
v_mfma_f32_16x16x32_bf16 v[64:67], a[152:155], a[32:35], v[64:67]
s_waitcnt vmcnt(22) lgkmcnt(4)
v_mfma_f32_16x16x32_bf16 v[32:35], a[128:131], a[48:51], v[32:35]
ds_read_b64_tr_b16 a[144:145], v2 offset:14336
v_mfma_f32_16x16x32_bf16 v[48:51], a[132:135], a[48:51], v[48:51]
ds_read_b64_tr_b16 a[146:147], v2 offset:17920
v_mfma_f32_16x16x32_bf16 v[52:55], a[132:135], a[52:55], v[52:55]
buffer_load_dwordx4 v10, s[12:15], s21 offen offset:2048  lds
s_add_u32 s68, s68, 1835008
s_add_u32 s21, s68, s64
v_mfma_f32_16x16x32_bf16 v[36:39], a[128:131], a[52:55], v[36:39]
buffer_load_dwordx4 a[96:99], v22, s[8:11], s20 offen offset:0
v_mfma_f32_16x16x32_bf16 v[40:43], a[128:131], a[56:59], v[40:43]
ds_read_b64_tr_b16 a[148:149], v2 offset:21504
v_mfma_f32_16x16x32_bf16 v[56:59], a[132:135], a[56:59], v[56:59]
ds_read_b64_tr_b16 a[150:151], v2 offset:25088
v_mfma_f32_16x16x32_bf16 v[60:63], a[132:135], a[60:63], v[60:63]
buffer_load_dwordx4 a[100:103], v22, s[8:11], s20 offen offset:1024
v_mfma_f32_16x16x32_bf16 v[44:47], a[128:131], a[60:63], v[44:47]
s_waitcnt vmcnt(13) lgkmcnt(4)
v_mfma_f32_16x16x32_bf16 v[44:47], a[136:139], a[76:79], v[44:47]
ds_read_b64_tr_b16 a[152:153], v1 offset:43040
v_mfma_f32_16x16x32_bf16 v[60:63], a[140:143], a[76:79], v[60:63]
ds_read_b64_tr_b16 a[154:155], v1 offset:46624
v_mfma_f32_16x16x32_bf16 v[56:59], a[140:143], a[72:75], v[56:59]
buffer_load_dwordx4 a[104:107], v22, s[8:11], s20 offen offset:2048
v_mfma_f32_16x16x32_bf16 v[40:43], a[136:139], a[72:75], v[40:43]
buffer_load_dwordx4 a[108:111], v22, s[8:11], s20 offen offset:3072
s_add_u32 s20, s20, 4096
v_mfma_f32_16x16x32_bf16 v[36:39], a[136:139], a[68:71], v[36:39]
ds_read_b64_tr_b16 a[156:157], v1 offset:50208
v_mfma_f32_16x16x32_bf16 v[52:55], a[140:143], a[68:71], v[52:55]
ds_read_b64_tr_b16 a[158:159], v1 offset:53792
v_mfma_f32_16x16x32_bf16 v[48:51], a[140:143], a[64:67], v[48:51]
buffer_load_dwordx4 a[112:115], v22, s[8:11], s20 offen offset:0
v_mfma_f32_16x16x32_bf16 v[32:35], a[136:139], a[64:67], v[32:35]
s_waitcnt vmcnt(12) lgkmcnt(4)
v_mfma_f32_16x16x32_bf16 v[32:35], a[144:147], a[80:83], v[32:35]
ds_read_b64_tr_b16 a[128:129], v2 offset:32
v_mfma_f32_16x16x32_bf16 v[48:51], a[148:151], a[80:83], v[48:51]
ds_read_b64_tr_b16 a[130:131], v2 offset:3616
v_mfma_f32_16x16x32_bf16 v[52:55], a[148:151], a[84:87], v[52:55]
buffer_load_dwordx4 a[116:119], v22, s[8:11], s20 offen offset:1024
v_mfma_f32_16x16x32_bf16 v[36:39], a[144:147], a[84:87], v[36:39]
buffer_load_dwordx4 a[120:123], v22, s[8:11], s20 offen offset:2048
v_mfma_f32_16x16x32_bf16 v[40:43], a[144:147], a[88:91], v[40:43]
ds_read_b64_tr_b16 a[132:133], v2 offset:7200
v_mfma_f32_16x16x32_bf16 v[56:59], a[148:151], a[88:91], v[56:59]
ds_read_b64_tr_b16 a[134:135], v2 offset:10784
v_mfma_f32_16x16x32_bf16 v[60:63], a[148:151], a[92:95], v[60:63]
buffer_load_dwordx4 a[124:127], v22, s[8:11], s20 offen offset:3072
s_add_u32 s69, s69, 32768
s_add_u32 s20, s69, s76
v_mfma_f32_16x16x32_bf16 v[44:47], a[144:147], a[92:95], v[44:47]
s_waitcnt lgkmcnt(4)
v_mfma_f32_16x16x32_bf16 v[76:79], a[152:155], a[60:63], v[76:79]
ds_read_b64_tr_b16 a[136:137], v2 offset:14368
v_mfma_f32_16x16x32_bf16 v[92:95], a[156:159], a[60:63], v[92:95]
ds_read_b64_tr_b16 a[138:139], v2 offset:17952
v_mfma_f32_16x16x32_bf16 v[88:91], a[156:159], a[56:59], v[88:91]
v_mfma_f32_16x16x32_bf16 v[72:75], a[152:155], a[56:59], v[72:75]
v_mfma_f32_16x16x32_bf16 v[68:71], a[152:155], a[52:55], v[68:71]
ds_read_b64_tr_b16 a[140:141], v2 offset:21536
v_mfma_f32_16x16x32_bf16 v[84:87], a[156:159], a[52:55], v[84:87]
ds_read_b64_tr_b16 a[142:143], v2 offset:25120
v_mfma_f32_16x16x32_bf16 v[80:83], a[156:159], a[48:51], v[80:83]
v_mfma_f32_16x16x32_bf16 v[64:67], a[152:155], a[48:51], v[64:67]
s_waitcnt lgkmcnt(4)
v_mfma_f32_16x16x32_bf16 v[64:67], a[128:131], a[64:67], v[64:67]
ds_read_b64_tr_b16 a[144:145], v1 offset:28736
v_mfma_f32_16x16x32_bf16 v[80:83], a[132:135], a[64:67], v[80:83]
ds_read_b64_tr_b16 a[146:147], v1 offset:32320
v_mfma_f32_16x16x32_bf16 v[84:87], a[132:135], a[68:71], v[84:87]
v_mfma_f32_16x16x32_bf16 v[68:71], a[128:131], a[68:71], v[68:71]
v_mfma_f32_16x16x32_bf16 v[72:75], a[128:131], a[72:75], v[72:75]
ds_read_b64_tr_b16 a[148:149], v1 offset:35904
v_mfma_f32_16x16x32_bf16 v[88:91], a[132:135], a[72:75], v[88:91]
ds_read_b64_tr_b16 a[150:151], v1 offset:39488
v_mfma_f32_16x16x32_bf16 v[92:95], a[132:135], a[76:79], v[92:95]
v_mfma_f32_16x16x32_bf16 v[76:79], a[128:131], a[76:79], v[76:79]
s_waitcnt lgkmcnt(4)
v_mfma_f32_16x16x32_bf16 v[76:79], a[136:139], a[92:95], v[76:79]
ds_read_b64_tr_b16 a[152:153], v1 offset:43072
v_mfma_f32_16x16x32_bf16 v[92:95], a[140:143], a[92:95], v[92:95]
ds_read_b64_tr_b16 a[154:155], v1 offset:46656
v_mfma_f32_16x16x32_bf16 v[88:91], a[140:143], a[88:91], v[88:91]
v_mfma_f32_16x16x32_bf16 v[72:75], a[136:139], a[88:91], v[72:75]
v_mfma_f32_16x16x32_bf16 v[68:71], a[136:139], a[84:87], v[68:71]
ds_read_b64_tr_b16 a[156:157], v1 offset:50240
v_mfma_f32_16x16x32_bf16 v[84:87], a[140:143], a[84:87], v[84:87]
ds_read_b64_tr_b16 a[158:159], v1 offset:53824
v_mfma_f32_16x16x32_bf16 v[80:83], a[140:143], a[80:83], v[80:83]
v_mfma_f32_16x16x32_bf16 v[64:67], a[136:139], a[80:83], v[64:67]
s_waitcnt lgkmcnt(4)
v_mfma_f32_16x16x32_bf16 v[96:99], a[144:147], a[32:35], v[96:99]
ds_read_b64_tr_b16 a[128:129], v2 offset:64
v_mfma_f32_16x16x32_bf16 v[112:115], a[148:151], a[32:35], v[112:115]
ds_read_b64_tr_b16 a[130:131], v2 offset:3648
v_mfma_f32_16x16x32_bf16 v[116:119], a[148:151], a[36:39], v[116:119]
v_mfma_f32_16x16x32_bf16 v[100:103], a[144:147], a[36:39], v[100:103]
v_mfma_f32_16x16x32_bf16 v[104:107], a[144:147], a[40:43], v[104:107]
ds_read_b64_tr_b16 a[132:133], v2 offset:7232
v_mfma_f32_16x16x32_bf16 v[120:123], a[148:151], a[40:43], v[120:123]
ds_read_b64_tr_b16 a[134:135], v2 offset:10816
v_mfma_f32_16x16x32_bf16 v[124:127], a[148:151], a[44:47], v[124:127]
v_mfma_f32_16x16x32_bf16 v[108:111], a[144:147], a[44:47], v[108:111]
s_waitcnt lgkmcnt(4)
v_mfma_f32_16x16x32_bf16 v[108:111], a[152:155], a[60:63], v[108:111]
ds_read_b64_tr_b16 a[136:137], v2 offset:14400
v_mfma_f32_16x16x32_bf16 v[124:127], a[156:159], a[60:63], v[124:127]
ds_read_b64_tr_b16 a[138:139], v2 offset:17984
v_mfma_f32_16x16x32_bf16 v[120:123], a[156:159], a[56:59], v[120:123]
v_mfma_f32_16x16x32_bf16 v[104:107], a[152:155], a[56:59], v[104:107]
v_mfma_f32_16x16x32_bf16 v[100:103], a[152:155], a[52:55], v[100:103]
ds_read_b64_tr_b16 a[140:141], v2 offset:21568
v_mfma_f32_16x16x32_bf16 v[116:119], a[156:159], a[52:55], v[116:119]
ds_read_b64_tr_b16 a[142:143], v2 offset:25152
v_mfma_f32_16x16x32_bf16 v[112:115], a[156:159], a[48:51], v[112:115]
v_mfma_f32_16x16x32_bf16 v[96:99], a[152:155], a[48:51], v[96:99]
s_waitcnt vmcnt(8) lgkmcnt(4)
s_barrier
s_cmp_eq_u32 s60, 0
s_cbranch_scc1 interleave_layers__ssm_conv_h3__geglu_ffn__prompt_kernel_noc
v_lshrrev_b32 v26, 2, v31
v_lshlrev_b32 v26, 1, v26
v_and_b32 v27, 3, v31
v_lshl_add_u32 v26, v27, 3, v26
v_mul_u32_u24 v26, 10368, v26
v_mov_b32 v27, 1
s_cmp_lg_u32 s26, 0
s_cbranch_scc1 sig6
s_mov_b64 exec, 0xffff
buffer_store_byte v27, v26, s[88:91], s45 offen sc1
s_mov_b64 exec, -1
sig6:
interleave_layers__ssm_conv_h3__geglu_ffn__prompt_kernel_noc:
v_mfma_f32_16x16x32_bf16 v[96:99], a[128:131], a[64:67], v[96:99]
ds_read_b64_tr_b16 a[144:145], v2 offset:28672
v_mfma_f32_16x16x32_bf16 v[112:115], a[132:135], a[64:67], v[112:115]
ds_read_b64_tr_b16 a[146:147], v2 offset:32256
v_mfma_f32_16x16x32_bf16 v[116:119], a[132:135], a[68:71], v[116:119]
v_mfma_f32_16x16x32_bf16 v[100:103], a[128:131], a[68:71], v[100:103]
v_mfma_f32_16x16x32_bf16 v[104:107], a[128:131], a[72:75], v[104:107]
ds_read_b64_tr_b16 a[148:149], v2 offset:35840
v_mfma_f32_16x16x32_bf16 v[120:123], a[132:135], a[72:75], v[120:123]
ds_read_b64_tr_b16 a[150:151], v2 offset:39424
v_mfma_f32_16x16x32_bf16 v[124:127], a[132:135], a[76:79], v[124:127]
v_mfma_f32_16x16x32_bf16 v[108:111], a[128:131], a[76:79], v[108:111]
s_waitcnt lgkmcnt(4)
v_mfma_f32_16x16x32_bf16 v[108:111], a[136:139], a[92:95], v[108:111]
ds_read_b64_tr_b16 a[152:153], v2 offset:43008
v_mfma_f32_16x16x32_bf16 v[124:127], a[140:143], a[92:95], v[124:127]
ds_read_b64_tr_b16 a[154:155], v2 offset:46592
v_mfma_f32_16x16x32_bf16 v[120:123], a[140:143], a[88:91], v[120:123]
v_mfma_f32_16x16x32_bf16 v[104:107], a[136:139], a[88:91], v[104:107]
v_mfma_f32_16x16x32_bf16 v[100:103], a[136:139], a[84:87], v[100:103]
ds_read_b64_tr_b16 a[156:157], v2 offset:50176
v_mfma_f32_16x16x32_bf16 v[116:119], a[140:143], a[84:87], v[116:119]
ds_read_b64_tr_b16 a[158:159], v2 offset:53760
v_mfma_f32_16x16x32_bf16 v[112:115], a[140:143], a[80:83], v[112:115]
v_mfma_f32_16x16x32_bf16 v[96:99], a[136:139], a[80:83], v[96:99]
s_waitcnt vmcnt(4) lgkmcnt(4)
v_mfma_f32_16x16x32_bf16 v[32:35], a[144:147], a[96:99], v[32:35]
ds_read_b64_tr_b16 a[128:129], v2 offset:28704
v_mfma_f32_16x16x32_bf16 v[48:51], a[148:151], a[96:99], v[48:51]
ds_read_b64_tr_b16 a[130:131], v2 offset:32288
v_mfma_f32_16x16x32_bf16 v[52:55], a[148:151], a[100:103], v[52:55]
v_mfma_f32_16x16x32_bf16 v[36:39], a[144:147], a[100:103], v[36:39]
v_mfma_f32_16x16x32_bf16 v[40:43], a[144:147], a[104:107], v[40:43]
ds_read_b64_tr_b16 a[132:133], v2 offset:35872
v_mfma_f32_16x16x32_bf16 v[56:59], a[148:151], a[104:107], v[56:59]
ds_read_b64_tr_b16 a[134:135], v2 offset:39456
v_mfma_f32_16x16x32_bf16 v[60:63], a[148:151], a[108:111], v[60:63]
v_mfma_f32_16x16x32_bf16 v[44:47], a[144:147], a[108:111], v[44:47]
s_waitcnt vmcnt(0) lgkmcnt(4)
v_mfma_f32_16x16x32_bf16 v[44:47], a[152:155], a[124:127], v[44:47]
ds_read_b64_tr_b16 a[136:137], v2 offset:43040
v_mfma_f32_16x16x32_bf16 v[60:63], a[156:159], a[124:127], v[60:63]
ds_read_b64_tr_b16 a[138:139], v2 offset:46624
v_mfma_f32_16x16x32_bf16 v[56:59], a[156:159], a[120:123], v[56:59]
v_mfma_f32_16x16x32_bf16 v[40:43], a[152:155], a[120:123], v[40:43]
v_mfma_f32_16x16x32_bf16 v[36:39], a[152:155], a[116:119], v[36:39]
ds_read_b64_tr_b16 a[140:141], v2 offset:50208
v_mfma_f32_16x16x32_bf16 v[52:55], a[156:159], a[116:119], v[52:55]
ds_read_b64_tr_b16 a[142:143], v2 offset:53792
v_mfma_f32_16x16x32_bf16 v[48:51], a[156:159], a[112:115], v[48:51]
v_mfma_f32_16x16x32_bf16 v[32:35], a[152:155], a[112:115], v[32:35]
s_waitcnt lgkmcnt(4)
v_mfma_f32_16x16x32_bf16 v[64:67], a[128:131], a[96:99], v[64:67]
ds_read_b64_tr_b16 a[144:145], v2 offset:28736
v_mfma_f32_16x16x32_bf16 v[80:83], a[132:135], a[96:99], v[80:83]
ds_read_b64_tr_b16 a[146:147], v2 offset:32320
v_mfma_f32_16x16x32_bf16 v[84:87], a[132:135], a[100:103], v[84:87]
v_mfma_f32_16x16x32_bf16 v[68:71], a[128:131], a[100:103], v[68:71]
v_mfma_f32_16x16x32_bf16 v[72:75], a[128:131], a[104:107], v[72:75]
ds_read_b64_tr_b16 a[148:149], v2 offset:35904
v_mul_f32 v12, v44, v44
v_mfma_f32_16x16x32_bf16 v[88:91], a[132:135], a[104:107], v[88:91]
ds_read_b64_tr_b16 a[150:151], v2 offset:39488
v_fma_f32 v12, v12, s36, v28
v_mfma_f32_16x16x32_bf16 v[92:95], a[132:135], a[108:111], v[92:95]
v_mul_f32 v12, v12, v44
v_mfma_f32_16x16x32_bf16 v[76:79], a[128:131], a[108:111], v[76:79]
v_exp_f32 v12, v12
s_waitcnt lgkmcnt(4)
v_mfma_f32_16x16x32_bf16 v[76:79], a[136:139], a[124:127], v[76:79]
ds_read_b64_tr_b16 a[152:153], v2 offset:43072
v_add_f32 v12, 1.0, v12
v_mfma_f32_16x16x32_bf16 v[92:95], a[140:143], a[124:127], v[92:95]
ds_read_b64_tr_b16 a[154:155], v2 offset:46656
v_mul_f32 v60, v44, v60
v_mfma_f32_16x16x32_bf16 v[88:91], a[140:143], a[120:123], v[88:91]
v_rcp_f32 v12, v12
v_mfma_f32_16x16x32_bf16 v[72:75], a[136:139], a[120:123], v[72:75]
v_mul_f32 v60, v60, v12
v_mfma_f32_16x16x32_bf16 v[68:71], a[136:139], a[116:119], v[68:71]
ds_read_b64_tr_b16 a[156:157], v2 offset:50240
v_mul_f32 v13, v45, v45
v_mfma_f32_16x16x32_bf16 v[84:87], a[140:143], a[116:119], v[84:87]
ds_read_b64_tr_b16 a[158:159], v2 offset:53824
v_fma_f32 v13, v13, s36, v28
v_mfma_f32_16x16x32_bf16 v[80:83], a[140:143], a[112:115], v[80:83]
v_mul_f32 v13, v13, v45
v_mfma_f32_16x16x32_bf16 v[64:67], a[136:139], a[112:115], v[64:67]
v_exp_f32 v13, v13
s_waitcnt lgkmcnt(4)
v_mfma_f32_16x16x32_bf16 v[96:99], a[144:147], a[96:99], v[96:99]
ds_read_b64_tr_b16 a[128:129], v1 offset:28768
v_add_f32 v13, 1.0, v13
v_mfma_f32_16x16x32_bf16 v[112:115], a[148:151], a[96:99], v[112:115]
ds_read_b64_tr_b16 a[130:131], v1 offset:32352
v_mul_f32 v61, v45, v61
v_mfma_f32_16x16x32_bf16 v[116:119], a[148:151], a[100:103], v[116:119]
v_rcp_f32 v13, v13
v_mfma_f32_16x16x32_bf16 v[100:103], a[144:147], a[100:103], v[100:103]
v_mul_f32 v61, v61, v13
v_mfma_f32_16x16x32_bf16 v[104:107], a[144:147], a[104:107], v[104:107]
ds_read_b64_tr_b16 a[132:133], v1 offset:35936
v_mul_f32 v14, v46, v46
v_mfma_f32_16x16x32_bf16 v[120:123], a[148:151], a[104:107], v[120:123]
ds_read_b64_tr_b16 a[134:135], v1 offset:39520
v_fma_f32 v14, v14, s36, v28
v_mfma_f32_16x16x32_bf16 v[124:127], a[148:151], a[108:111], v[124:127]
v_mul_f32 v14, v14, v46
v_mfma_f32_16x16x32_bf16 v[108:111], a[144:147], a[108:111], v[108:111]
v_exp_f32 v14, v14
s_waitcnt lgkmcnt(4)
v_mfma_f32_16x16x32_bf16 v[108:111], a[152:155], a[124:127], v[108:111]
ds_read_b64_tr_b16 a[136:137], v1 offset:43104
v_add_f32 v14, 1.0, v14
v_mfma_f32_16x16x32_bf16 v[124:127], a[156:159], a[124:127], v[124:127]
ds_read_b64_tr_b16 a[138:139], v1 offset:46688
v_mul_f32 v62, v46, v62
v_mfma_f32_16x16x32_bf16 v[120:123], a[156:159], a[120:123], v[120:123]
v_rcp_f32 v14, v14
v_mfma_f32_16x16x32_bf16 v[104:107], a[152:155], a[120:123], v[104:107]
v_mul_f32 v62, v62, v14
v_mfma_f32_16x16x32_bf16 v[100:103], a[152:155], a[116:119], v[100:103]
ds_read_b64_tr_b16 a[140:141], v1 offset:50272
v_mul_f32 v15, v47, v47
v_mfma_f32_16x16x32_bf16 v[116:119], a[156:159], a[116:119], v[116:119]
ds_read_b64_tr_b16 a[142:143], v1 offset:53856
v_fma_f32 v15, v15, s36, v28
v_mfma_f32_16x16x32_bf16 v[112:115], a[156:159], a[112:115], v[112:115]
v_mul_f32 v15, v15, v47
v_mfma_f32_16x16x32_bf16 v[96:99], a[152:155], a[112:115], v[96:99]
v_exp_f32 v15, v15
s_waitcnt lgkmcnt(4)
v_mfma_f32_16x16x32_bf16 v[128:131], a[128:131], a[32:35], v[128:131]
ds_read_b64_tr_b16 a[144:145], v2 offset:96
v_add_f32 v15, 1.0, v15
v_mfma_f32_16x16x32_bf16 v[144:147], a[132:135], a[32:35], v[144:147]
ds_read_b64_tr_b16 a[146:147], v2 offset:3680
v_mul_f32 v63, v47, v63
v_mfma_f32_16x16x32_bf16 v[148:151], a[132:135], a[36:39], v[148:151]
v_rcp_f32 v15, v15
v_mfma_f32_16x16x32_bf16 v[132:135], a[128:131], a[36:39], v[132:135]
v_mul_f32 v63, v63, v15
v_mfma_f32_16x16x32_bf16 v[136:139], a[128:131], a[40:43], v[136:139]
ds_read_b64_tr_b16 a[148:149], v2 offset:7264
v_cvt_pk_bf16_f32 v44, v60, v61
v_mfma_f32_16x16x32_bf16 v[152:155], a[132:135], a[40:43], v[152:155]
ds_read_b64_tr_b16 a[150:151], v2 offset:10848
v_cvt_pk_bf16_f32 v45, v62, v63
v_mfma_f32_16x16x32_bf16 v[156:159], a[132:135], a[44:47], v[156:159]
v_mul_f32 v16, v40, v40
v_mfma_f32_16x16x32_bf16 v[140:143], a[128:131], a[44:47], v[140:143]
v_fma_f32 v16, v16, s36, v28
s_waitcnt lgkmcnt(4)
v_mfma_f32_16x16x32_bf16 v[140:143], a[136:139], a[60:63], v[140:143]
ds_read_b64_tr_b16 a[152:153], v2 offset:14432
v_mul_f32 v16, v16, v40
v_mfma_f32_16x16x32_bf16 v[156:159], a[140:143], a[60:63], v[156:159]
ds_read_b64_tr_b16 a[154:155], v2 offset:18016
v_mul_f32 v56, v40, v56
v_mfma_f32_16x16x32_bf16 v[152:155], a[140:143], a[56:59], v[152:155]
v_exp_f32 v16, v16
v_mfma_f32_16x16x32_bf16 v[136:139], a[136:139], a[56:59], v[136:139]
v_add_f32 v16, 1.0, v16
v_mfma_f32_16x16x32_bf16 v[132:135], a[136:139], a[52:55], v[132:135]
ds_read_b64_tr_b16 a[156:157], v2 offset:21600
v_mul_f32 v17, v41, v41
v_mfma_f32_16x16x32_bf16 v[148:151], a[140:143], a[52:55], v[148:151]
ds_read_b64_tr_b16 a[158:159], v2 offset:25184
v_fma_f32 v17, v17, s36, v28
v_mfma_f32_16x16x32_bf16 v[144:147], a[140:143], a[48:51], v[144:147]
v_rcp_f32 v16, v16
v_mfma_f32_16x16x32_bf16 v[128:131], a[136:139], a[48:51], v[128:131]
v_mul_f32 v56, v56, v16
s_waitcnt lgkmcnt(4)
v_mfma_f32_16x16x32_bf16 v[128:131], a[144:147], a[64:67], v[128:131]
ds_read_b64_tr_b16 a[128:129], v2 offset:28768
v_mul_f32 v17, v17, v41
v_mfma_f32_16x16x32_bf16 v[144:147], a[148:151], a[64:67], v[144:147]
ds_read_b64_tr_b16 a[130:131], v2 offset:32352
v_mul_f32 v57, v41, v57
v_mfma_f32_16x16x32_bf16 v[148:151], a[148:151], a[68:71], v[148:151]
v_exp_f32 v17, v17
v_mfma_f32_16x16x32_bf16 v[132:135], a[144:147], a[68:71], v[132:135]
v_add_f32 v17, 1.0, v17
v_mfma_f32_16x16x32_bf16 v[136:139], a[144:147], a[72:75], v[136:139]
ds_read_b64_tr_b16 a[132:133], v2 offset:35936
v_mul_f32 v18, v42, v42
v_mfma_f32_16x16x32_bf16 v[152:155], a[148:151], a[72:75], v[152:155]
ds_read_b64_tr_b16 a[134:135], v2 offset:39520
v_fma_f32 v18, v18, s36, v28
v_mfma_f32_16x16x32_bf16 v[156:159], a[148:151], a[76:79], v[156:159]
v_rcp_f32 v17, v17
v_mfma_f32_16x16x32_bf16 v[140:143], a[144:147], a[76:79], v[140:143]
v_mul_f32 v57, v57, v17
s_waitcnt lgkmcnt(4)
v_mfma_f32_16x16x32_bf16 v[140:143], a[152:155], a[92:95], v[140:143]
ds_read_b64_tr_b16 a[136:137], v2 offset:43104
v_mul_f32 v18, v18, v42
v_mfma_f32_16x16x32_bf16 v[156:159], a[156:159], a[92:95], v[156:159]
ds_read_b64_tr_b16 a[138:139], v2 offset:46688
v_mul_f32 v58, v42, v58
v_mfma_f32_16x16x32_bf16 v[152:155], a[156:159], a[88:91], v[152:155]
v_exp_f32 v18, v18
v_mfma_f32_16x16x32_bf16 v[136:139], a[152:155], a[88:91], v[136:139]
v_add_f32 v18, 1.0, v18
v_mfma_f32_16x16x32_bf16 v[132:135], a[152:155], a[84:87], v[132:135]
ds_read_b64_tr_b16 a[140:141], v2 offset:50272
v_mul_f32 v19, v43, v43
v_mfma_f32_16x16x32_bf16 v[148:151], a[156:159], a[84:87], v[148:151]
ds_read_b64_tr_b16 a[142:143], v2 offset:53856
v_fma_f32 v19, v19, s36, v28
v_mfma_f32_16x16x32_bf16 v[144:147], a[156:159], a[80:83], v[144:147]
v_rcp_f32 v18, v18
v_mfma_f32_16x16x32_bf16 v[128:131], a[152:155], a[80:83], v[128:131]
v_mul_f32 v58, v58, v18
s_waitcnt lgkmcnt(4)
v_mfma_f32_16x16x32_bf16 v[128:131], a[128:131], a[96:99], v[128:131]
ds_read_b64_tr_b16 a[144:145], v1 offset:28800
v_mul_f32 v19, v19, v43
v_mfma_f32_16x16x32_bf16 v[144:147], a[132:135], a[96:99], v[144:147]
ds_read_b64_tr_b16 a[146:147], v1 offset:32384
v_mul_f32 v59, v43, v59
v_mfma_f32_16x16x32_bf16 v[148:151], a[132:135], a[100:103], v[148:151]
v_exp_f32 v19, v19
v_mfma_f32_16x16x32_bf16 v[132:135], a[128:131], a[100:103], v[132:135]
v_add_f32 v19, 1.0, v19
v_mfma_f32_16x16x32_bf16 v[136:139], a[128:131], a[104:107], v[136:139]
ds_read_b64_tr_b16 a[148:149], v1 offset:35968
v_cvt_pk_bf16_f32 v40, v56, v57
v_mfma_f32_16x16x32_bf16 v[152:155], a[132:135], a[104:107], v[152:155]
ds_read_b64_tr_b16 a[150:151], v1 offset:39552
v_mul_f32 v12, v36, v36
v_mfma_f32_16x16x32_bf16 v[156:159], a[132:135], a[108:111], v[156:159]
v_rcp_f32 v19, v19
v_mfma_f32_16x16x32_bf16 v[140:143], a[128:131], a[108:111], v[140:143]
v_mul_f32 v59, v59, v19
s_waitcnt lgkmcnt(4)
v_mfma_f32_16x16x32_bf16 v[140:143], a[136:139], a[124:127], v[140:143]
ds_read_b64_tr_b16 a[152:153], v1 offset:43136
v_cvt_pk_bf16_f32 v41, v58, v59
v_mfma_f32_16x16x32_bf16 v[156:159], a[140:143], a[124:127], v[156:159]
ds_read_b64_tr_b16 a[154:155], v1 offset:46720
v_fma_f32 v12, v12, s36, v28
v_mfma_f32_16x16x32_bf16 v[152:155], a[140:143], a[120:123], v[152:155]
v_mul_f32 v12, v12, v36
v_mfma_f32_16x16x32_bf16 v[136:139], a[136:139], a[120:123], v[136:139]
v_exp_f32 v12, v12
v_mfma_f32_16x16x32_bf16 v[132:135], a[136:139], a[116:119], v[132:135]
ds_read_b64_tr_b16 a[156:157], v1 offset:50304
v_add_f32 v12, 1.0, v12
v_mfma_f32_16x16x32_bf16 v[148:151], a[140:143], a[116:119], v[148:151]
ds_read_b64_tr_b16 a[158:159], v1 offset:53888
v_mul_f32 v52, v36, v52
v_mfma_f32_16x16x32_bf16 v[144:147], a[140:143], a[112:115], v[144:147]
v_rcp_f32 v12, v12
v_mfma_f32_16x16x32_bf16 v[128:131], a[136:139], a[112:115], v[128:131]
v_mul_f32 v52, v52, v12
s_waitcnt lgkmcnt(4)
v_mfma_f32_16x16x32_bf16 v[160:163], a[144:147], a[32:35], v[160:163]
ds_read_b64_tr_b16 a[128:129], v2 offset:128
v_mul_f32 v13, v37, v37
v_mfma_f32_16x16x32_bf16 v[176:179], a[148:151], a[32:35], v[176:179]
ds_read_b64_tr_b16 a[130:131], v2 offset:3712
v_fma_f32 v13, v13, s36, v28
v_mfma_f32_16x16x32_bf16 v[180:183], a[148:151], a[36:39], v[180:183]
v_mul_f32 v13, v13, v37
v_mfma_f32_16x16x32_bf16 v[164:167], a[144:147], a[36:39], v[164:167]
v_exp_f32 v13, v13
v_mfma_f32_16x16x32_bf16 v[168:171], a[144:147], a[40:43], v[168:171]
ds_read_b64_tr_b16 a[132:133], v2 offset:7296
v_add_f32 v13, 1.0, v13
v_mfma_f32_16x16x32_bf16 v[184:187], a[148:151], a[40:43], v[184:187]
ds_read_b64_tr_b16 a[134:135], v2 offset:10880
v_mul_f32 v53, v37, v53
v_mfma_f32_16x16x32_bf16 v[188:191], a[148:151], a[44:47], v[188:191]
v_rcp_f32 v13, v13
v_mfma_f32_16x16x32_bf16 v[172:175], a[144:147], a[44:47], v[172:175]
v_mul_f32 v53, v53, v13
s_waitcnt lgkmcnt(4)
v_mfma_f32_16x16x32_bf16 v[172:175], a[152:155], a[60:63], v[172:175]
ds_read_b64_tr_b16 a[136:137], v2 offset:14464
v_mul_f32 v14, v38, v38
v_mfma_f32_16x16x32_bf16 v[188:191], a[156:159], a[60:63], v[188:191]
ds_read_b64_tr_b16 a[138:139], v2 offset:18048
v_fma_f32 v14, v14, s36, v28
v_mfma_f32_16x16x32_bf16 v[184:187], a[156:159], a[56:59], v[184:187]
v_mul_f32 v14, v14, v38
v_mfma_f32_16x16x32_bf16 v[168:171], a[152:155], a[56:59], v[168:171]
v_exp_f32 v14, v14
v_mfma_f32_16x16x32_bf16 v[164:167], a[152:155], a[52:55], v[164:167]
ds_read_b64_tr_b16 a[140:141], v2 offset:21632
v_add_f32 v14, 1.0, v14
v_mfma_f32_16x16x32_bf16 v[180:183], a[156:159], a[52:55], v[180:183]
ds_read_b64_tr_b16 a[142:143], v2 offset:25216
v_mul_f32 v54, v38, v54
v_mfma_f32_16x16x32_bf16 v[176:179], a[156:159], a[48:51], v[176:179]
v_rcp_f32 v14, v14
v_mfma_f32_16x16x32_bf16 v[160:163], a[152:155], a[48:51], v[160:163]
v_mul_f32 v54, v54, v14
s_waitcnt lgkmcnt(4)
v_mfma_f32_16x16x32_bf16 v[160:163], a[128:131], a[64:67], v[160:163]
ds_read_b64_tr_b16 a[144:145], v2 offset:28800
v_mul_f32 v15, v39, v39
v_mfma_f32_16x16x32_bf16 v[176:179], a[132:135], a[64:67], v[176:179]
ds_read_b64_tr_b16 a[146:147], v2 offset:32384
v_fma_f32 v15, v15, s36, v28
v_mfma_f32_16x16x32_bf16 v[180:183], a[132:135], a[68:71], v[180:183]
v_mul_f32 v15, v15, v39
v_mfma_f32_16x16x32_bf16 v[164:167], a[128:131], a[68:71], v[164:167]
v_exp_f32 v15, v15
v_mfma_f32_16x16x32_bf16 v[168:171], a[128:131], a[72:75], v[168:171]
ds_read_b64_tr_b16 a[148:149], v2 offset:35968
v_add_f32 v15, 1.0, v15
v_mfma_f32_16x16x32_bf16 v[184:187], a[132:135], a[72:75], v[184:187]
ds_read_b64_tr_b16 a[150:151], v2 offset:39552
v_mul_f32 v55, v39, v55
v_mfma_f32_16x16x32_bf16 v[188:191], a[132:135], a[76:79], v[188:191]
v_rcp_f32 v15, v15
v_mfma_f32_16x16x32_bf16 v[172:175], a[128:131], a[76:79], v[172:175]
v_mul_f32 v55, v55, v15
s_waitcnt lgkmcnt(4)
v_mfma_f32_16x16x32_bf16 v[172:175], a[136:139], a[92:95], v[172:175]
ds_read_b64_tr_b16 a[152:153], v2 offset:43136
v_cvt_pk_bf16_f32 v36, v52, v53
v_mfma_f32_16x16x32_bf16 v[188:191], a[140:143], a[92:95], v[188:191]
ds_read_b64_tr_b16 a[154:155], v2 offset:46720
v_cvt_pk_bf16_f32 v37, v54, v55
v_mfma_f32_16x16x32_bf16 v[184:187], a[140:143], a[88:91], v[184:187]
v_mul_f32 v16, v32, v32
v_mfma_f32_16x16x32_bf16 v[168:171], a[136:139], a[88:91], v[168:171]
v_fma_f32 v16, v16, s36, v28
v_mfma_f32_16x16x32_bf16 v[164:167], a[136:139], a[84:87], v[164:167]
ds_read_b64_tr_b16 a[156:157], v2 offset:50304
v_mul_f32 v16, v16, v32
v_mfma_f32_16x16x32_bf16 v[180:183], a[140:143], a[84:87], v[180:183]
ds_read_b64_tr_b16 a[158:159], v2 offset:53888
v_mul_f32 v48, v32, v48
v_mfma_f32_16x16x32_bf16 v[176:179], a[140:143], a[80:83], v[176:179]
v_exp_f32 v16, v16
v_mfma_f32_16x16x32_bf16 v[160:163], a[136:139], a[80:83], v[160:163]
v_add_f32 v16, 1.0, v16
s_waitcnt lgkmcnt(4)
v_mfma_f32_16x16x32_bf16 v[160:163], a[144:147], a[96:99], v[160:163]
ds_read_b64_tr_b16 a[128:129], v1 offset:28832
v_mul_f32 v17, v33, v33
v_mfma_f32_16x16x32_bf16 v[176:179], a[148:151], a[96:99], v[176:179]
ds_read_b64_tr_b16 a[130:131], v1 offset:32416
v_fma_f32 v17, v17, s36, v28
v_mfma_f32_16x16x32_bf16 v[180:183], a[148:151], a[100:103], v[180:183]
v_rcp_f32 v16, v16
v_mfma_f32_16x16x32_bf16 v[164:167], a[144:147], a[100:103], v[164:167]
v_mul_f32 v48, v48, v16
v_mfma_f32_16x16x32_bf16 v[168:171], a[144:147], a[104:107], v[168:171]
ds_read_b64_tr_b16 a[132:133], v1 offset:36000
v_mul_f32 v17, v17, v33
v_mfma_f32_16x16x32_bf16 v[184:187], a[148:151], a[104:107], v[184:187]
ds_read_b64_tr_b16 a[134:135], v1 offset:39584
v_mul_f32 v49, v33, v49
v_mfma_f32_16x16x32_bf16 v[188:191], a[148:151], a[108:111], v[188:191]
v_exp_f32 v17, v17
v_mfma_f32_16x16x32_bf16 v[172:175], a[144:147], a[108:111], v[172:175]
v_add_f32 v17, 1.0, v17
s_waitcnt lgkmcnt(4)
v_mfma_f32_16x16x32_bf16 v[172:175], a[152:155], a[124:127], v[172:175]
ds_read_b64_tr_b16 a[136:137], v1 offset:43168
v_mul_f32 v18, v34, v34
v_mfma_f32_16x16x32_bf16 v[188:191], a[156:159], a[124:127], v[188:191]
ds_read_b64_tr_b16 a[138:139], v1 offset:46752
v_fma_f32 v18, v18, s36, v28
v_mfma_f32_16x16x32_bf16 v[184:187], a[156:159], a[120:123], v[184:187]
v_rcp_f32 v17, v17
v_mfma_f32_16x16x32_bf16 v[168:171], a[152:155], a[120:123], v[168:171]
v_mul_f32 v49, v49, v17
v_mfma_f32_16x16x32_bf16 v[164:167], a[152:155], a[116:119], v[164:167]
ds_read_b64_tr_b16 a[140:141], v1 offset:50336
v_mul_f32 v18, v18, v34
v_mfma_f32_16x16x32_bf16 v[180:183], a[156:159], a[116:119], v[180:183]
ds_read_b64_tr_b16 a[142:143], v1 offset:53920
v_mul_f32 v50, v34, v50
v_mfma_f32_16x16x32_bf16 v[176:179], a[156:159], a[112:115], v[176:179]
v_exp_f32 v18, v18
v_mfma_f32_16x16x32_bf16 v[160:163], a[152:155], a[112:115], v[160:163]
v_add_f32 v18, 1.0, v18
s_waitcnt lgkmcnt(4)
v_mfma_f32_16x16x32_bf16 v[192:195], a[128:131], a[32:35], v[192:195]
ds_read_b64_tr_b16 a[144:145], v2 offset:160
v_mul_f32 v19, v35, v35
v_mfma_f32_16x16x32_bf16 v[208:211], a[132:135], a[32:35], v[208:211]
ds_read_b64_tr_b16 a[146:147], v2 offset:3744
v_fma_f32 v19, v19, s36, v28
v_mfma_f32_16x16x32_bf16 v[212:215], a[132:135], a[36:39], v[212:215]
v_rcp_f32 v18, v18
v_mfma_f32_16x16x32_bf16 v[196:199], a[128:131], a[36:39], v[196:199]
v_mul_f32 v50, v50, v18
v_mfma_f32_16x16x32_bf16 v[200:203], a[128:131], a[40:43], v[200:203]
ds_read_b64_tr_b16 a[148:149], v2 offset:7328
v_mul_f32 v19, v19, v35
v_mfma_f32_16x16x32_bf16 v[216:219], a[132:135], a[40:43], v[216:219]
ds_read_b64_tr_b16 a[150:151], v2 offset:10912
v_mul_f32 v51, v35, v51
v_mfma_f32_16x16x32_bf16 v[220:223], a[132:135], a[44:47], v[220:223]
v_exp_f32 v19, v19
v_mfma_f32_16x16x32_bf16 v[204:207], a[128:131], a[44:47], v[204:207]
v_add_f32 v19, 1.0, v19
s_waitcnt lgkmcnt(4)
v_mfma_f32_16x16x32_bf16 v[204:207], a[136:139], a[60:63], v[204:207]
ds_read_b64_tr_b16 a[152:153], v2 offset:14496
v_cvt_pk_bf16_f32 v32, v48, v49
v_mfma_f32_16x16x32_bf16 v[220:223], a[140:143], a[60:63], v[220:223]
ds_read_b64_tr_b16 a[154:155], v2 offset:18080
v_mul_f32 v12, v76, v76
v_mfma_f32_16x16x32_bf16 v[216:219], a[140:143], a[56:59], v[216:219]
v_rcp_f32 v19, v19
v_mfma_f32_16x16x32_bf16 v[200:203], a[136:139], a[56:59], v[200:203]
v_mul_f32 v51, v51, v19
v_mfma_f32_16x16x32_bf16 v[196:199], a[136:139], a[52:55], v[196:199]
ds_read_b64_tr_b16 a[156:157], v2 offset:21664
v_cvt_pk_bf16_f32 v33, v50, v51
v_mfma_f32_16x16x32_bf16 v[212:215], a[140:143], a[52:55], v[212:215]
ds_read_b64_tr_b16 a[158:159], v2 offset:25248
v_fma_f32 v12, v12, s36, v28
v_mfma_f32_16x16x32_bf16 v[208:211], a[140:143], a[48:51], v[208:211]
v_mul_f32 v12, v12, v76
v_mfma_f32_16x16x32_bf16 v[192:195], a[136:139], a[48:51], v[192:195]
v_exp_f32 v12, v12
s_waitcnt lgkmcnt(4)
v_mfma_f32_16x16x32_bf16 v[192:195], a[144:147], a[64:67], v[192:195]
ds_read_b64_tr_b16 a[128:129], v2 offset:28832
v_add_f32 v12, 1.0, v12
v_mfma_f32_16x16x32_bf16 v[208:211], a[148:151], a[64:67], v[208:211]
ds_read_b64_tr_b16 a[130:131], v2 offset:32416
v_mul_f32 v92, v76, v92
v_mfma_f32_16x16x32_bf16 v[212:215], a[148:151], a[68:71], v[212:215]
v_rcp_f32 v12, v12
v_mfma_f32_16x16x32_bf16 v[196:199], a[144:147], a[68:71], v[196:199]
v_mul_f32 v92, v92, v12
v_mfma_f32_16x16x32_bf16 v[200:203], a[144:147], a[72:75], v[200:203]
ds_read_b64_tr_b16 a[132:133], v2 offset:36000
v_mul_f32 v13, v77, v77
v_mfma_f32_16x16x32_bf16 v[216:219], a[148:151], a[72:75], v[216:219]
ds_read_b64_tr_b16 a[134:135], v2 offset:39584
v_fma_f32 v13, v13, s36, v28
v_mfma_f32_16x16x32_bf16 v[220:223], a[148:151], a[76:79], v[220:223]
v_mul_f32 v13, v13, v77
v_mfma_f32_16x16x32_bf16 v[204:207], a[144:147], a[76:79], v[204:207]
v_exp_f32 v13, v13
s_waitcnt lgkmcnt(4)
v_mfma_f32_16x16x32_bf16 v[204:207], a[152:155], a[92:95], v[204:207]
ds_read_b64_tr_b16 a[136:137], v2 offset:43168
v_add_f32 v13, 1.0, v13
v_mfma_f32_16x16x32_bf16 v[220:223], a[156:159], a[92:95], v[220:223]
ds_read_b64_tr_b16 a[138:139], v2 offset:46752
v_mul_f32 v93, v77, v93
v_mfma_f32_16x16x32_bf16 v[216:219], a[156:159], a[88:91], v[216:219]
v_rcp_f32 v13, v13
v_mfma_f32_16x16x32_bf16 v[200:203], a[152:155], a[88:91], v[200:203]
v_mul_f32 v93, v93, v13
v_mfma_f32_16x16x32_bf16 v[196:199], a[152:155], a[84:87], v[196:199]
ds_read_b64_tr_b16 a[140:141], v2 offset:50336
v_mul_f32 v14, v78, v78
v_mfma_f32_16x16x32_bf16 v[212:215], a[156:159], a[84:87], v[212:215]
ds_read_b64_tr_b16 a[142:143], v2 offset:53920
v_fma_f32 v14, v14, s36, v28
v_mfma_f32_16x16x32_bf16 v[208:211], a[156:159], a[80:83], v[208:211]
v_mul_f32 v14, v14, v78
v_mfma_f32_16x16x32_bf16 v[192:195], a[152:155], a[80:83], v[192:195]
v_exp_f32 v14, v14
s_waitcnt lgkmcnt(4)
v_mfma_f32_16x16x32_bf16 v[192:195], a[128:131], a[96:99], v[192:195]
ds_read_b64_tr_b16 a[144:145], v1 offset:28864
v_add_f32 v14, 1.0, v14
v_mfma_f32_16x16x32_bf16 v[208:211], a[132:135], a[96:99], v[208:211]
ds_read_b64_tr_b16 a[146:147], v1 offset:32448
v_mul_f32 v94, v78, v94
v_mfma_f32_16x16x32_bf16 v[212:215], a[132:135], a[100:103], v[212:215]
v_rcp_f32 v14, v14
v_mfma_f32_16x16x32_bf16 v[196:199], a[128:131], a[100:103], v[196:199]
v_mul_f32 v94, v94, v14
v_mfma_f32_16x16x32_bf16 v[200:203], a[128:131], a[104:107], v[200:203]
ds_read_b64_tr_b16 a[148:149], v1 offset:36032
v_mul_f32 v15, v79, v79
v_mfma_f32_16x16x32_bf16 v[216:219], a[132:135], a[104:107], v[216:219]
ds_read_b64_tr_b16 a[150:151], v1 offset:39616
v_fma_f32 v15, v15, s36, v28
v_mfma_f32_16x16x32_bf16 v[220:223], a[132:135], a[108:111], v[220:223]
v_mul_f32 v15, v15, v79
v_mfma_f32_16x16x32_bf16 v[204:207], a[128:131], a[108:111], v[204:207]
v_exp_f32 v15, v15
s_waitcnt lgkmcnt(4)
v_mfma_f32_16x16x32_bf16 v[204:207], a[136:139], a[124:127], v[204:207]
ds_read_b64_tr_b16 a[152:153], v1 offset:43200
v_add_f32 v15, 1.0, v15
v_mfma_f32_16x16x32_bf16 v[220:223], a[140:143], a[124:127], v[220:223]
ds_read_b64_tr_b16 a[154:155], v1 offset:46784
v_mul_f32 v95, v79, v95
v_mfma_f32_16x16x32_bf16 v[216:219], a[140:143], a[120:123], v[216:219]
v_rcp_f32 v15, v15
v_mfma_f32_16x16x32_bf16 v[200:203], a[136:139], a[120:123], v[200:203]
v_mul_f32 v95, v95, v15
v_mfma_f32_16x16x32_bf16 v[196:199], a[136:139], a[116:119], v[196:199]
ds_read_b64_tr_b16 a[156:157], v1 offset:50368
v_cvt_pk_bf16_f32 v46, v92, v93
v_mfma_f32_16x16x32_bf16 v[212:215], a[140:143], a[116:119], v[212:215]
ds_read_b64_tr_b16 a[158:159], v1 offset:53952
v_cvt_pk_bf16_f32 v47, v94, v95
v_mfma_f32_16x16x32_bf16 v[208:211], a[140:143], a[112:115], v[208:211]
buffer_store_dwordx4 v[44:47], v3, s[16:19], s38 offen offset:3072 sc1
v_mfma_f32_16x16x32_bf16 v[192:195], a[136:139], a[112:115], v[192:195]
v_mul_f32 v16, v72, v72
s_waitcnt lgkmcnt(4)
v_mfma_f32_16x16x32_bf16 v[224:227], a[144:147], a[32:35], v[224:227]
ds_read_b64_tr_b16 a[128:129], v2 offset:192
v_fma_f32 v16, v16, s36, v28
v_mfma_f32_16x16x32_bf16 v[240:243], a[148:151], a[32:35], v[240:243]
ds_read_b64_tr_b16 a[130:131], v2 offset:3776
v_mul_f32 v16, v16, v72
v_mfma_f32_16x16x32_bf16 v[244:247], a[148:151], a[36:39], v[244:247]
v_exp_f32 v16, v16
v_mfma_f32_16x16x32_bf16 v[228:231], a[144:147], a[36:39], v[228:231]
v_add_f32 v16, 1.0, v16
v_mfma_f32_16x16x32_bf16 v[232:235], a[144:147], a[40:43], v[232:235]
ds_read_b64_tr_b16 a[132:133], v2 offset:7360
v_mul_f32 v88, v72, v88
v_mfma_f32_16x16x32_bf16 v[248:251], a[148:151], a[40:43], v[248:251]
ds_read_b64_tr_b16 a[134:135], v2 offset:10944
v_mul_f32 v17, v73, v73
v_mfma_f32_16x16x32_bf16 v[252:255], a[148:151], a[44:47], v[252:255]
v_rcp_f32 v16, v16
v_mfma_f32_16x16x32_bf16 v[236:239], a[144:147], a[44:47], v[236:239]
v_mul_f32 v88, v88, v16
s_waitcnt lgkmcnt(4)
v_mfma_f32_16x16x32_bf16 v[236:239], a[152:155], a[60:63], v[236:239]
ds_read_b64_tr_b16 a[136:137], v2 offset:14528
v_fma_f32 v17, v17, s36, v28
v_mfma_f32_16x16x32_bf16 v[252:255], a[156:159], a[60:63], v[252:255]
ds_read_b64_tr_b16 a[138:139], v2 offset:18112
v_mul_f32 v17, v17, v73
v_mfma_f32_16x16x32_bf16 v[248:251], a[156:159], a[56:59], v[248:251]
v_exp_f32 v17, v17
v_mfma_f32_16x16x32_bf16 v[232:235], a[152:155], a[56:59], v[232:235]
v_add_f32 v17, 1.0, v17
v_mfma_f32_16x16x32_bf16 v[228:231], a[152:155], a[52:55], v[228:231]
ds_read_b64_tr_b16 a[140:141], v2 offset:21696
v_mul_f32 v89, v73, v89
v_mfma_f32_16x16x32_bf16 v[244:247], a[156:159], a[52:55], v[244:247]
ds_read_b64_tr_b16 a[142:143], v2 offset:25280
v_mul_f32 v18, v74, v74
v_mfma_f32_16x16x32_bf16 v[240:243], a[156:159], a[48:51], v[240:243]
v_rcp_f32 v17, v17
v_mfma_f32_16x16x32_bf16 v[224:227], a[152:155], a[48:51], v[224:227]
v_mul_f32 v89, v89, v17
s_waitcnt lgkmcnt(4)
v_mfma_f32_16x16x32_bf16 v[224:227], a[128:131], a[64:67], v[224:227]
ds_read_b64_tr_b16 a[144:145], v2 offset:28864
v_fma_f32 v18, v18, s36, v28
v_mfma_f32_16x16x32_bf16 v[240:243], a[132:135], a[64:67], v[240:243]
ds_read_b64_tr_b16 a[146:147], v2 offset:32448
v_mul_f32 v18, v18, v74
v_mfma_f32_16x16x32_bf16 v[244:247], a[132:135], a[68:71], v[244:247]
v_exp_f32 v18, v18
v_mfma_f32_16x16x32_bf16 v[228:231], a[128:131], a[68:71], v[228:231]
v_add_f32 v18, 1.0, v18
v_mfma_f32_16x16x32_bf16 v[232:235], a[128:131], a[72:75], v[232:235]
ds_read_b64_tr_b16 a[148:149], v2 offset:36032
v_mul_f32 v90, v74, v90
v_mfma_f32_16x16x32_bf16 v[248:251], a[132:135], a[72:75], v[248:251]
ds_read_b64_tr_b16 a[150:151], v2 offset:39616
v_mul_f32 v19, v75, v75
v_mfma_f32_16x16x32_bf16 v[252:255], a[132:135], a[76:79], v[252:255]
v_rcp_f32 v18, v18
v_mfma_f32_16x16x32_bf16 v[236:239], a[128:131], a[76:79], v[236:239]
v_mul_f32 v90, v90, v18
s_waitcnt lgkmcnt(4)
v_mfma_f32_16x16x32_bf16 v[236:239], a[136:139], a[92:95], v[236:239]
ds_read_b64_tr_b16 a[152:153], v2 offset:43200
v_fma_f32 v19, v19, s36, v28
v_mfma_f32_16x16x32_bf16 v[252:255], a[140:143], a[92:95], v[252:255]
ds_read_b64_tr_b16 a[154:155], v2 offset:46784
v_mul_f32 v19, v19, v75
v_mfma_f32_16x16x32_bf16 v[248:251], a[140:143], a[88:91], v[248:251]
v_exp_f32 v19, v19
v_mfma_f32_16x16x32_bf16 v[232:235], a[136:139], a[88:91], v[232:235]
v_add_f32 v19, 1.0, v19
v_mfma_f32_16x16x32_bf16 v[228:231], a[136:139], a[84:87], v[228:231]
ds_read_b64_tr_b16 a[156:157], v2 offset:50368
v_mul_f32 v91, v75, v91
v_mfma_f32_16x16x32_bf16 v[244:247], a[140:143], a[84:87], v[244:247]
ds_read_b64_tr_b16 a[158:159], v2 offset:53952
v_cvt_pk_bf16_f32 v42, v88, v89
v_mfma_f32_16x16x32_bf16 v[240:243], a[140:143], a[80:83], v[240:243]
v_rcp_f32 v19, v19
v_mfma_f32_16x16x32_bf16 v[224:227], a[136:139], a[80:83], v[224:227]
v_mul_f32 v91, v91, v19
s_waitcnt lgkmcnt(4)
v_mfma_f32_16x16x32_bf16 v[224:227], a[144:147], a[96:99], v[224:227]
v_cvt_pk_bf16_f32 v43, v90, v91
v_mfma_f32_16x16x32_bf16 v[240:243], a[148:151], a[96:99], v[240:243]
buffer_store_dwordx4 v[40:43], v3, s[16:19], s38 offen offset:2048 sc1
v_mfma_f32_16x16x32_bf16 v[244:247], a[148:151], a[100:103], v[244:247]
v_mul_f32 v12, v68, v68
v_mfma_f32_16x16x32_bf16 v[228:231], a[144:147], a[100:103], v[228:231]
v_fma_f32 v12, v12, s36, v28
v_mfma_f32_16x16x32_bf16 v[232:235], a[144:147], a[104:107], v[232:235]
v_mul_f32 v12, v12, v68
v_mfma_f32_16x16x32_bf16 v[248:251], a[148:151], a[104:107], v[248:251]
v_mul_f32 v84, v68, v84
v_mfma_f32_16x16x32_bf16 v[252:255], a[148:151], a[108:111], v[252:255]
v_exp_f32 v12, v12
v_mfma_f32_16x16x32_bf16 v[236:239], a[144:147], a[108:111], v[236:239]
v_add_f32 v12, 1.0, v12
s_waitcnt lgkmcnt(0)
v_mfma_f32_16x16x32_bf16 v[236:239], a[152:155], a[124:127], v[236:239]
v_mul_f32 v13, v69, v69
v_mfma_f32_16x16x32_bf16 v[252:255], a[156:159], a[124:127], v[252:255]
v_fma_f32 v13, v13, s36, v28
v_mfma_f32_16x16x32_bf16 v[248:251], a[156:159], a[120:123], v[248:251]
v_rcp_f32 v12, v12
v_mfma_f32_16x16x32_bf16 v[232:235], a[152:155], a[120:123], v[232:235]
v_mul_f32 v84, v84, v12
v_mfma_f32_16x16x32_bf16 v[228:231], a[152:155], a[116:119], v[228:231]
v_mul_f32 v13, v13, v69
v_mfma_f32_16x16x32_bf16 v[244:247], a[156:159], a[116:119], v[244:247]
v_mul_f32 v85, v69, v85
v_mfma_f32_16x16x32_bf16 v[240:243], a[156:159], a[112:115], v[240:243]
v_exp_f32 v13, v13
v_mfma_f32_16x16x32_bf16 v[224:227], a[152:155], a[112:115], v[224:227]
v_add_f32 v13, 1.0, v13
s_nop 7
v_rcp_f32 v13, v13
v_mul_f32 v16, v64, v64
v_mul_f32 v85, v85, v13
v_fma_f32 v16, v16, s36, v28
v_mul_f32 v14, v70, v70
v_mul_f32 v16, v16, v64
v_fma_f32 v14, v14, s36, v28
v_exp_f32 v16, v16
v_mul_f32 v14, v14, v70
v_add_f32 v16, 1.0, v16
v_exp_f32 v14, v14
v_rcp_f32 v16, v16
v_add_f32 v14, 1.0, v14
v_mul_f32 v80, v64, v80
v_rcp_f32 v14, v14
v_mul_f32 v80, v80, v16
v_mul_f32 v86, v70, v86
v_mul_f32 v17, v65, v65
v_mul_f32 v86, v86, v14
v_fma_f32 v17, v17, s36, v28
v_mul_f32 v15, v71, v71
v_mul_f32 v17, v17, v65
v_fma_f32 v15, v15, s36, v28
v_exp_f32 v17, v17
v_mul_f32 v15, v15, v71
v_add_f32 v17, 1.0, v17
v_exp_f32 v15, v15
v_rcp_f32 v17, v17
v_add_f32 v15, 1.0, v15
v_mul_f32 v81, v65, v81
v_rcp_f32 v15, v15
v_mul_f32 v81, v81, v17
v_mul_f32 v87, v71, v87
v_mul_f32 v18, v66, v66
v_mul_f32 v87, v87, v15
v_fma_f32 v18, v18, s36, v28
v_cvt_pk_bf16_f32 v38, v84, v85
v_mul_f32 v18, v18, v66
v_cvt_pk_bf16_f32 v39, v86, v87
v_exp_f32 v18, v18
buffer_store_dwordx4 v[36:39], v3, s[16:19], s38 offen offset:1024 sc1
v_add_f32 v18, 1.0, v18
v_rcp_f32 v18, v18
v_mul_f32 v82, v66, v82
v_mul_f32 v82, v82, v18
v_mul_f32 v19, v67, v67
v_fma_f32 v19, v19, s36, v28
v_mul_f32 v19, v19, v67
v_exp_f32 v19, v19
v_mul_f32 v83, v67, v83
v_add_f32 v19, 1.0, v19
v_rcp_f32 v19, v19
v_cvt_pk_bf16_f32 v34, v80, v81
v_mul_f32 v83, v83, v19
v_cvt_pk_bf16_f32 v35, v82, v83
buffer_store_dwordx4 v[32:35], v3, s[16:19], s38 offen offset:0 sc1
v_pk_mul_f32 v[12:13], v[108:109], v[108:109]
v_pk_mul_f32 v[14:15], v[110:111], v[110:111]
v_pk_fma_f32 v[12:13], v[12:13], s[36:37], v[28:29]
v_pk_fma_f32 v[14:15], v[14:15], s[36:37], v[28:29]
v_pk_mul_f32 v[12:13], v[12:13], v[108:109]
v_pk_mul_f32 v[14:15], v[14:15], v[110:111]
v_exp_f32 v12, v12
v_exp_f32 v13, v13
v_exp_f32 v14, v14
v_exp_f32 v15, v15
v_pk_mul_f32 v[124:125], v[108:109], v[124:125]
v_pk_add_f32 v[12:13], v[12:13], 1.0 op_sel_hi:[1,0]
v_pk_add_f32 v[14:15], v[14:15], 1.0 op_sel_hi:[1,0]
v_rcp_f32 v12, v12
v_rcp_f32 v13, v13
v_rcp_f32 v14, v14
v_rcp_f32 v15, v15
v_pk_mul_f32 v[126:127], v[110:111], v[126:127]
v_pk_mul_f32 v[124:125], v[124:125], v[12:13]
v_pk_mul_f32 v[126:127], v[126:127], v[14:15]
v_cvt_pk_bf16_f32 v108, v124, v125
v_cvt_pk_bf16_f32 v109, v126, v127
v_pk_mul_f32 v[16:17], v[104:105], v[104:105]
v_pk_mul_f32 v[18:19], v[106:107], v[106:107]
v_pk_fma_f32 v[16:17], v[16:17], s[36:37], v[28:29]
v_pk_fma_f32 v[18:19], v[18:19], s[36:37], v[28:29]
v_pk_mul_f32 v[16:17], v[16:17], v[104:105]
v_pk_mul_f32 v[18:19], v[18:19], v[106:107]
v_exp_f32 v16, v16
v_exp_f32 v17, v17
v_exp_f32 v18, v18
v_exp_f32 v19, v19
v_pk_mul_f32 v[120:121], v[104:105], v[120:121]
v_pk_add_f32 v[16:17], v[16:17], 1.0 op_sel_hi:[1,0]
v_pk_add_f32 v[18:19], v[18:19], 1.0 op_sel_hi:[1,0]
v_rcp_f32 v16, v16
v_rcp_f32 v17, v17
v_rcp_f32 v18, v18
v_rcp_f32 v19, v19
v_pk_mul_f32 v[122:123], v[106:107], v[122:123]
v_pk_mul_f32 v[120:121], v[120:121], v[16:17]
v_pk_mul_f32 v[122:123], v[122:123], v[18:19]
v_cvt_pk_bf16_f32 v104, v120, v121
v_cvt_pk_bf16_f32 v105, v122, v123
v_pk_mul_f32 v[12:13], v[100:101], v[100:101]
v_pk_mul_f32 v[14:15], v[102:103], v[102:103]
v_pk_fma_f32 v[12:13], v[12:13], s[36:37], v[28:29]
v_pk_fma_f32 v[14:15], v[14:15], s[36:37], v[28:29]
v_pk_mul_f32 v[12:13], v[12:13], v[100:101]
v_pk_mul_f32 v[14:15], v[14:15], v[102:103]
v_exp_f32 v12, v12
v_exp_f32 v13, v13
v_exp_f32 v14, v14
v_exp_f32 v15, v15
v_pk_mul_f32 v[116:117], v[100:101], v[116:117]
v_pk_add_f32 v[12:13], v[12:13], 1.0 op_sel_hi:[1,0]
v_pk_add_f32 v[14:15], v[14:15], 1.0 op_sel_hi:[1,0]
v_rcp_f32 v12, v12
v_rcp_f32 v13, v13
v_rcp_f32 v14, v14
v_rcp_f32 v15, v15
v_pk_mul_f32 v[118:119], v[102:103], v[118:119]
v_pk_mul_f32 v[116:117], v[116:117], v[12:13]
v_pk_mul_f32 v[118:119], v[118:119], v[14:15]
v_cvt_pk_bf16_f32 v100, v116, v117
v_cvt_pk_bf16_f32 v101, v118, v119
v_pk_mul_f32 v[16:17], v[96:97], v[96:97]
v_pk_mul_f32 v[18:19], v[98:99], v[98:99]
v_pk_fma_f32 v[16:17], v[16:17], s[36:37], v[28:29]
v_pk_fma_f32 v[18:19], v[18:19], s[36:37], v[28:29]
v_pk_mul_f32 v[16:17], v[16:17], v[96:97]
v_pk_mul_f32 v[18:19], v[18:19], v[98:99]
v_exp_f32 v16, v16
v_exp_f32 v17, v17
v_exp_f32 v18, v18
v_exp_f32 v19, v19
v_pk_mul_f32 v[112:113], v[96:97], v[112:113]
v_pk_add_f32 v[16:17], v[16:17], 1.0 op_sel_hi:[1,0]
v_pk_add_f32 v[18:19], v[18:19], 1.0 op_sel_hi:[1,0]
v_rcp_f32 v16, v16
v_rcp_f32 v17, v17
v_rcp_f32 v18, v18
v_rcp_f32 v19, v19
v_pk_mul_f32 v[114:115], v[98:99], v[114:115]
v_pk_mul_f32 v[112:113], v[112:113], v[16:17]
v_pk_mul_f32 v[114:115], v[114:115], v[18:19]
v_cvt_pk_bf16_f32 v96, v112, v113
v_cvt_pk_bf16_f32 v97, v114, v115
v_pk_mul_f32 v[12:13], v[140:141], v[140:141]
v_pk_mul_f32 v[14:15], v[142:143], v[142:143]
v_pk_fma_f32 v[12:13], v[12:13], s[36:37], v[28:29]
v_pk_fma_f32 v[14:15], v[14:15], s[36:37], v[28:29]
v_pk_mul_f32 v[12:13], v[12:13], v[140:141]
v_pk_mul_f32 v[14:15], v[14:15], v[142:143]
v_exp_f32 v12, v12
v_exp_f32 v13, v13
v_exp_f32 v14, v14
v_exp_f32 v15, v15
v_pk_mul_f32 v[156:157], v[140:141], v[156:157]
v_pk_add_f32 v[12:13], v[12:13], 1.0 op_sel_hi:[1,0]
v_pk_add_f32 v[14:15], v[14:15], 1.0 op_sel_hi:[1,0]
v_rcp_f32 v12, v12
v_rcp_f32 v13, v13
v_rcp_f32 v14, v14
v_rcp_f32 v15, v15
v_pk_mul_f32 v[158:159], v[142:143], v[158:159]
v_pk_mul_f32 v[156:157], v[156:157], v[12:13]
v_pk_mul_f32 v[158:159], v[158:159], v[14:15]
v_cvt_pk_bf16_f32 v110, v156, v157
v_cvt_pk_bf16_f32 v111, v158, v159
buffer_store_dwordx4 v[108:111], v3, s[16:19], s61 offen offset:3072 sc1
v_pk_mul_f32 v[16:17], v[136:137], v[136:137]
v_pk_mul_f32 v[18:19], v[138:139], v[138:139]
v_pk_fma_f32 v[16:17], v[16:17], s[36:37], v[28:29]
v_pk_fma_f32 v[18:19], v[18:19], s[36:37], v[28:29]
v_pk_mul_f32 v[16:17], v[16:17], v[136:137]
v_pk_mul_f32 v[18:19], v[18:19], v[138:139]
v_exp_f32 v16, v16
v_exp_f32 v17, v17
v_exp_f32 v18, v18
v_exp_f32 v19, v19
v_pk_mul_f32 v[152:153], v[136:137], v[152:153]
v_pk_add_f32 v[16:17], v[16:17], 1.0 op_sel_hi:[1,0]
v_pk_add_f32 v[18:19], v[18:19], 1.0 op_sel_hi:[1,0]
v_rcp_f32 v16, v16
v_rcp_f32 v17, v17
v_rcp_f32 v18, v18
v_rcp_f32 v19, v19
v_pk_mul_f32 v[154:155], v[138:139], v[154:155]
v_pk_mul_f32 v[152:153], v[152:153], v[16:17]
v_pk_mul_f32 v[154:155], v[154:155], v[18:19]
v_cvt_pk_bf16_f32 v106, v152, v153
v_cvt_pk_bf16_f32 v107, v154, v155
buffer_store_dwordx4 v[104:107], v3, s[16:19], s61 offen offset:2048 sc1
v_pk_mul_f32 v[12:13], v[132:133], v[132:133]
v_pk_mul_f32 v[14:15], v[134:135], v[134:135]
v_pk_fma_f32 v[12:13], v[12:13], s[36:37], v[28:29]
v_pk_fma_f32 v[14:15], v[14:15], s[36:37], v[28:29]
v_pk_mul_f32 v[12:13], v[12:13], v[132:133]
v_pk_mul_f32 v[14:15], v[14:15], v[134:135]
v_exp_f32 v12, v12
v_exp_f32 v13, v13
v_exp_f32 v14, v14
v_exp_f32 v15, v15
v_pk_mul_f32 v[148:149], v[132:133], v[148:149]
v_pk_add_f32 v[12:13], v[12:13], 1.0 op_sel_hi:[1,0]
v_pk_add_f32 v[14:15], v[14:15], 1.0 op_sel_hi:[1,0]
v_rcp_f32 v12, v12
v_rcp_f32 v13, v13
v_rcp_f32 v14, v14
v_rcp_f32 v15, v15
v_pk_mul_f32 v[150:151], v[134:135], v[150:151]
v_pk_mul_f32 v[148:149], v[148:149], v[12:13]
v_pk_mul_f32 v[150:151], v[150:151], v[14:15]
v_cvt_pk_bf16_f32 v102, v148, v149
v_cvt_pk_bf16_f32 v103, v150, v151
buffer_store_dwordx4 v[100:103], v3, s[16:19], s61 offen offset:1024 sc1
v_pk_mul_f32 v[16:17], v[128:129], v[128:129]
v_pk_mul_f32 v[18:19], v[130:131], v[130:131]
v_pk_fma_f32 v[16:17], v[16:17], s[36:37], v[28:29]
v_pk_fma_f32 v[18:19], v[18:19], s[36:37], v[28:29]
v_pk_mul_f32 v[16:17], v[16:17], v[128:129]
v_pk_mul_f32 v[18:19], v[18:19], v[130:131]
v_exp_f32 v16, v16
v_exp_f32 v17, v17
v_exp_f32 v18, v18
v_exp_f32 v19, v19
v_pk_mul_f32 v[144:145], v[128:129], v[144:145]
v_pk_add_f32 v[16:17], v[16:17], 1.0 op_sel_hi:[1,0]
v_pk_add_f32 v[18:19], v[18:19], 1.0 op_sel_hi:[1,0]
v_rcp_f32 v16, v16
v_rcp_f32 v17, v17
v_rcp_f32 v18, v18
v_rcp_f32 v19, v19
v_pk_mul_f32 v[146:147], v[130:131], v[146:147]
v_pk_mul_f32 v[144:145], v[144:145], v[16:17]
v_pk_mul_f32 v[146:147], v[146:147], v[18:19]
v_cvt_pk_bf16_f32 v98, v144, v145
v_cvt_pk_bf16_f32 v99, v146, v147
buffer_store_dwordx4 v[96:99], v3, s[16:19], s61 offen offset:0 sc1
v_pk_mul_f32 v[12:13], v[172:173], v[172:173]
v_pk_mul_f32 v[14:15], v[174:175], v[174:175]
v_pk_fma_f32 v[12:13], v[12:13], s[36:37], v[28:29]
v_pk_fma_f32 v[14:15], v[14:15], s[36:37], v[28:29]
v_pk_mul_f32 v[12:13], v[12:13], v[172:173]
v_pk_mul_f32 v[14:15], v[14:15], v[174:175]
v_exp_f32 v12, v12
v_exp_f32 v13, v13
v_exp_f32 v14, v14
v_exp_f32 v15, v15
v_pk_mul_f32 v[188:189], v[172:173], v[188:189]
v_pk_add_f32 v[12:13], v[12:13], 1.0 op_sel_hi:[1,0]
v_pk_add_f32 v[14:15], v[14:15], 1.0 op_sel_hi:[1,0]
v_rcp_f32 v12, v12
v_rcp_f32 v13, v13
v_rcp_f32 v14, v14
v_rcp_f32 v15, v15
v_pk_mul_f32 v[190:191], v[174:175], v[190:191]
v_pk_mul_f32 v[188:189], v[188:189], v[12:13]
v_pk_mul_f32 v[190:191], v[190:191], v[14:15]
v_cvt_pk_bf16_f32 v172, v188, v189
v_cvt_pk_bf16_f32 v173, v190, v191
v_pk_mul_f32 v[16:17], v[168:169], v[168:169]
v_pk_mul_f32 v[18:19], v[170:171], v[170:171]
v_pk_fma_f32 v[16:17], v[16:17], s[36:37], v[28:29]
v_pk_fma_f32 v[18:19], v[18:19], s[36:37], v[28:29]
v_pk_mul_f32 v[16:17], v[16:17], v[168:169]
v_pk_mul_f32 v[18:19], v[18:19], v[170:171]
v_exp_f32 v16, v16
v_exp_f32 v17, v17
v_exp_f32 v18, v18
v_exp_f32 v19, v19
v_pk_mul_f32 v[184:185], v[168:169], v[184:185]
v_pk_add_f32 v[16:17], v[16:17], 1.0 op_sel_hi:[1,0]
v_pk_add_f32 v[18:19], v[18:19], 1.0 op_sel_hi:[1,0]
v_rcp_f32 v16, v16
v_rcp_f32 v17, v17
v_rcp_f32 v18, v18
v_rcp_f32 v19, v19
v_pk_mul_f32 v[186:187], v[170:171], v[186:187]
v_pk_mul_f32 v[184:185], v[184:185], v[16:17]
v_pk_mul_f32 v[186:187], v[186:187], v[18:19]
v_cvt_pk_bf16_f32 v168, v184, v185
v_cvt_pk_bf16_f32 v169, v186, v187
v_pk_mul_f32 v[12:13], v[164:165], v[164:165]
v_pk_mul_f32 v[14:15], v[166:167], v[166:167]
v_pk_fma_f32 v[12:13], v[12:13], s[36:37], v[28:29]
v_pk_fma_f32 v[14:15], v[14:15], s[36:37], v[28:29]
v_pk_mul_f32 v[12:13], v[12:13], v[164:165]
v_pk_mul_f32 v[14:15], v[14:15], v[166:167]
v_exp_f32 v12, v12
v_exp_f32 v13, v13
v_exp_f32 v14, v14
v_exp_f32 v15, v15
v_pk_mul_f32 v[180:181], v[164:165], v[180:181]
v_pk_add_f32 v[12:13], v[12:13], 1.0 op_sel_hi:[1,0]
v_pk_add_f32 v[14:15], v[14:15], 1.0 op_sel_hi:[1,0]
v_rcp_f32 v12, v12
v_rcp_f32 v13, v13
v_rcp_f32 v14, v14
v_rcp_f32 v15, v15
v_pk_mul_f32 v[182:183], v[166:167], v[182:183]
v_pk_mul_f32 v[180:181], v[180:181], v[12:13]
v_pk_mul_f32 v[182:183], v[182:183], v[14:15]
v_cvt_pk_bf16_f32 v164, v180, v181
v_cvt_pk_bf16_f32 v165, v182, v183
v_pk_mul_f32 v[16:17], v[160:161], v[160:161]
v_pk_mul_f32 v[18:19], v[162:163], v[162:163]
v_pk_fma_f32 v[16:17], v[16:17], s[36:37], v[28:29]
v_pk_fma_f32 v[18:19], v[18:19], s[36:37], v[28:29]
v_pk_mul_f32 v[16:17], v[16:17], v[160:161]
v_pk_mul_f32 v[18:19], v[18:19], v[162:163]
v_exp_f32 v16, v16
v_exp_f32 v17, v17
v_exp_f32 v18, v18
v_exp_f32 v19, v19
v_pk_mul_f32 v[176:177], v[160:161], v[176:177]
v_pk_add_f32 v[16:17], v[16:17], 1.0 op_sel_hi:[1,0]
v_pk_add_f32 v[18:19], v[18:19], 1.0 op_sel_hi:[1,0]
v_rcp_f32 v16, v16
v_rcp_f32 v17, v17
v_rcp_f32 v18, v18
v_rcp_f32 v19, v19
v_pk_mul_f32 v[178:179], v[162:163], v[178:179]
v_pk_mul_f32 v[176:177], v[176:177], v[16:17]
v_pk_mul_f32 v[178:179], v[178:179], v[18:19]
v_cvt_pk_bf16_f32 v160, v176, v177
v_cvt_pk_bf16_f32 v161, v178, v179
v_pk_mul_f32 v[12:13], v[204:205], v[204:205]
v_pk_mul_f32 v[14:15], v[206:207], v[206:207]
v_pk_fma_f32 v[12:13], v[12:13], s[36:37], v[28:29]
v_pk_fma_f32 v[14:15], v[14:15], s[36:37], v[28:29]
v_pk_mul_f32 v[12:13], v[12:13], v[204:205]
v_pk_mul_f32 v[14:15], v[14:15], v[206:207]
v_exp_f32 v12, v12
v_exp_f32 v13, v13
v_exp_f32 v14, v14
v_exp_f32 v15, v15
v_pk_mul_f32 v[220:221], v[204:205], v[220:221]
v_pk_add_f32 v[12:13], v[12:13], 1.0 op_sel_hi:[1,0]
v_pk_add_f32 v[14:15], v[14:15], 1.0 op_sel_hi:[1,0]
v_rcp_f32 v12, v12
v_rcp_f32 v13, v13
v_rcp_f32 v14, v14
v_rcp_f32 v15, v15
v_pk_mul_f32 v[222:223], v[206:207], v[222:223]
v_pk_mul_f32 v[220:221], v[220:221], v[12:13]
v_pk_mul_f32 v[222:223], v[222:223], v[14:15]
v_cvt_pk_bf16_f32 v174, v220, v221
v_cvt_pk_bf16_f32 v175, v222, v223
buffer_store_dwordx4 v[172:175], v3, s[16:19], s62 offen offset:3072 sc1
v_pk_mul_f32 v[16:17], v[200:201], v[200:201]
v_pk_mul_f32 v[18:19], v[202:203], v[202:203]
v_pk_fma_f32 v[16:17], v[16:17], s[36:37], v[28:29]
v_pk_fma_f32 v[18:19], v[18:19], s[36:37], v[28:29]
v_pk_mul_f32 v[16:17], v[16:17], v[200:201]
v_pk_mul_f32 v[18:19], v[18:19], v[202:203]
v_exp_f32 v16, v16
v_exp_f32 v17, v17
v_exp_f32 v18, v18
v_exp_f32 v19, v19
v_pk_mul_f32 v[216:217], v[200:201], v[216:217]
v_pk_add_f32 v[16:17], v[16:17], 1.0 op_sel_hi:[1,0]
v_pk_add_f32 v[18:19], v[18:19], 1.0 op_sel_hi:[1,0]
v_rcp_f32 v16, v16
v_rcp_f32 v17, v17
v_rcp_f32 v18, v18
v_rcp_f32 v19, v19
v_pk_mul_f32 v[218:219], v[202:203], v[218:219]
v_pk_mul_f32 v[216:217], v[216:217], v[16:17]
v_pk_mul_f32 v[218:219], v[218:219], v[18:19]
v_cvt_pk_bf16_f32 v170, v216, v217
v_cvt_pk_bf16_f32 v171, v218, v219
buffer_store_dwordx4 v[168:171], v3, s[16:19], s62 offen offset:2048 sc1
v_pk_mul_f32 v[12:13], v[196:197], v[196:197]
v_pk_mul_f32 v[14:15], v[198:199], v[198:199]
v_pk_fma_f32 v[12:13], v[12:13], s[36:37], v[28:29]
v_pk_fma_f32 v[14:15], v[14:15], s[36:37], v[28:29]
v_pk_mul_f32 v[12:13], v[12:13], v[196:197]
v_pk_mul_f32 v[14:15], v[14:15], v[198:199]
v_exp_f32 v12, v12
v_exp_f32 v13, v13
v_exp_f32 v14, v14
v_exp_f32 v15, v15
v_pk_mul_f32 v[212:213], v[196:197], v[212:213]
v_pk_add_f32 v[12:13], v[12:13], 1.0 op_sel_hi:[1,0]
v_pk_add_f32 v[14:15], v[14:15], 1.0 op_sel_hi:[1,0]
v_rcp_f32 v12, v12
v_rcp_f32 v13, v13
v_rcp_f32 v14, v14
v_rcp_f32 v15, v15
v_pk_mul_f32 v[214:215], v[198:199], v[214:215]
v_pk_mul_f32 v[212:213], v[212:213], v[12:13]
v_pk_mul_f32 v[214:215], v[214:215], v[14:15]
v_cvt_pk_bf16_f32 v166, v212, v213
v_cvt_pk_bf16_f32 v167, v214, v215
buffer_store_dwordx4 v[164:167], v3, s[16:19], s62 offen offset:1024 sc1
v_pk_mul_f32 v[16:17], v[192:193], v[192:193]
v_pk_mul_f32 v[18:19], v[194:195], v[194:195]
v_pk_fma_f32 v[16:17], v[16:17], s[36:37], v[28:29]
v_pk_fma_f32 v[18:19], v[18:19], s[36:37], v[28:29]
v_pk_mul_f32 v[16:17], v[16:17], v[192:193]
v_pk_mul_f32 v[18:19], v[18:19], v[194:195]
v_exp_f32 v16, v16
v_exp_f32 v17, v17
v_exp_f32 v18, v18
v_exp_f32 v19, v19
v_pk_mul_f32 v[208:209], v[192:193], v[208:209]
v_pk_add_f32 v[16:17], v[16:17], 1.0 op_sel_hi:[1,0]
v_pk_add_f32 v[18:19], v[18:19], 1.0 op_sel_hi:[1,0]
v_rcp_f32 v16, v16
v_rcp_f32 v17, v17
v_rcp_f32 v18, v18
v_rcp_f32 v19, v19
v_pk_mul_f32 v[210:211], v[194:195], v[210:211]
v_pk_mul_f32 v[208:209], v[208:209], v[16:17]
v_pk_mul_f32 v[210:211], v[210:211], v[18:19]
v_cvt_pk_bf16_f32 v162, v208, v209
v_cvt_pk_bf16_f32 v163, v210, v211
buffer_store_dwordx4 v[160:163], v3, s[16:19], s62 offen offset:0 sc1
v_pk_mul_f32 v[12:13], v[236:237], v[236:237]
v_pk_mul_f32 v[14:15], v[238:239], v[238:239]
v_pk_fma_f32 v[12:13], v[12:13], s[36:37], v[28:29]
v_pk_fma_f32 v[14:15], v[14:15], s[36:37], v[28:29]
v_pk_mul_f32 v[12:13], v[12:13], v[236:237]
v_pk_mul_f32 v[14:15], v[14:15], v[238:239]
v_exp_f32 v12, v12
v_exp_f32 v13, v13
v_exp_f32 v14, v14
v_exp_f32 v15, v15
v_pk_mul_f32 v[252:253], v[236:237], v[252:253]
v_pk_add_f32 v[12:13], v[12:13], 1.0 op_sel_hi:[1,0]
v_pk_add_f32 v[14:15], v[14:15], 1.0 op_sel_hi:[1,0]
v_rcp_f32 v12, v12
v_rcp_f32 v13, v13
v_rcp_f32 v14, v14
v_rcp_f32 v15, v15
v_pk_mul_f32 v[254:255], v[238:239], v[254:255]
v_pk_mul_f32 v[252:253], v[252:253], v[12:13]
v_pk_mul_f32 v[254:255], v[254:255], v[14:15]
v_cvt_pk_bf16_f32 v236, v252, v253
v_cvt_pk_bf16_f32 v237, v254, v255
v_mov_b32 v238, v236
v_mov_b32 v239, v237
s_nop 1
v_permlane16_swap_b32 v236, v238
v_permlane16_swap_b32 v237, v239
v_pk_mul_f32 v[16:17], v[232:233], v[232:233]
v_pk_mul_f32 v[18:19], v[234:235], v[234:235]
v_pk_fma_f32 v[16:17], v[16:17], s[36:37], v[28:29]
v_pk_fma_f32 v[18:19], v[18:19], s[36:37], v[28:29]
v_pk_mul_f32 v[16:17], v[16:17], v[232:233]
v_pk_mul_f32 v[18:19], v[18:19], v[234:235]
v_exp_f32 v16, v16
v_exp_f32 v17, v17
v_exp_f32 v18, v18
v_exp_f32 v19, v19
v_pk_mul_f32 v[248:249], v[232:233], v[248:249]
v_pk_add_f32 v[16:17], v[16:17], 1.0 op_sel_hi:[1,0]
v_pk_add_f32 v[18:19], v[18:19], 1.0 op_sel_hi:[1,0]
v_rcp_f32 v16, v16
v_rcp_f32 v17, v17
v_rcp_f32 v18, v18
v_rcp_f32 v19, v19
v_pk_mul_f32 v[250:251], v[234:235], v[250:251]
v_pk_mul_f32 v[248:249], v[248:249], v[16:17]
v_pk_mul_f32 v[250:251], v[250:251], v[18:19]
v_cvt_pk_bf16_f32 v232, v248, v249
v_cvt_pk_bf16_f32 v233, v250, v251
v_mov_b32 v234, v232
v_mov_b32 v235, v233
s_nop 1
v_permlane16_swap_b32 v232, v234
v_permlane16_swap_b32 v233, v235
v_pk_mul_f32 v[12:13], v[228:229], v[228:229]
v_pk_mul_f32 v[14:15], v[230:231], v[230:231]
v_pk_fma_f32 v[12:13], v[12:13], s[36:37], v[28:29]
v_pk_fma_f32 v[14:15], v[14:15], s[36:37], v[28:29]
v_pk_mul_f32 v[12:13], v[12:13], v[228:229]
v_pk_mul_f32 v[14:15], v[14:15], v[230:231]
v_exp_f32 v12, v12
v_exp_f32 v13, v13
v_exp_f32 v14, v14
v_exp_f32 v15, v15
v_pk_mul_f32 v[244:245], v[228:229], v[244:245]
v_pk_add_f32 v[12:13], v[12:13], 1.0 op_sel_hi:[1,0]
v_pk_add_f32 v[14:15], v[14:15], 1.0 op_sel_hi:[1,0]
v_rcp_f32 v12, v12
v_rcp_f32 v13, v13
v_rcp_f32 v14, v14
v_rcp_f32 v15, v15
v_pk_mul_f32 v[246:247], v[230:231], v[246:247]
v_pk_mul_f32 v[244:245], v[244:245], v[12:13]
v_pk_mul_f32 v[246:247], v[246:247], v[14:15]
v_cvt_pk_bf16_f32 v228, v244, v245
v_cvt_pk_bf16_f32 v229, v246, v247
v_mov_b32 v230, v228
v_mov_b32 v231, v229
s_nop 1
v_permlane16_swap_b32 v228, v230
v_permlane16_swap_b32 v229, v231
v_pk_mul_f32 v[16:17], v[224:225], v[224:225]
v_pk_mul_f32 v[18:19], v[226:227], v[226:227]
v_pk_fma_f32 v[16:17], v[16:17], s[36:37], v[28:29]
v_pk_fma_f32 v[18:19], v[18:19], s[36:37], v[28:29]
v_pk_mul_f32 v[16:17], v[16:17], v[224:225]
v_pk_mul_f32 v[18:19], v[18:19], v[226:227]
v_exp_f32 v16, v16
v_exp_f32 v17, v17
v_exp_f32 v18, v18
v_exp_f32 v19, v19
v_pk_mul_f32 v[240:241], v[224:225], v[240:241]
v_pk_add_f32 v[16:17], v[16:17], 1.0 op_sel_hi:[1,0]
v_pk_add_f32 v[18:19], v[18:19], 1.0 op_sel_hi:[1,0]
v_rcp_f32 v16, v16
v_rcp_f32 v17, v17
v_rcp_f32 v18, v18
v_rcp_f32 v19, v19
v_pk_mul_f32 v[242:243], v[226:227], v[242:243]
v_pk_mul_f32 v[240:241], v[240:241], v[16:17]
v_pk_mul_f32 v[242:243], v[242:243], v[18:19]
v_cvt_pk_bf16_f32 v224, v240, v241
v_cvt_pk_bf16_f32 v225, v242, v243
v_mov_b32 v226, v224
v_mov_b32 v227, v225
s_nop 1
v_permlane16_swap_b32 v224, v226
v_permlane16_swap_b32 v225, v227
s_mov_b32 exec_lo, 0xffff
s_mov_b32 exec_hi, 0xffff
buffer_store_dwordx4 v[224:227], v30, s[16:19], s39 offen offset:0 sc1
buffer_store_dwordx4 v[228:231], v30, s[16:19], s39 offen offset:1024 sc1
buffer_store_dwordx4 v[232:235], v30, s[16:19], s39 offen offset:2048 sc1
buffer_store_dwordx4 v[236:239], v30, s[16:19], s39 offen offset:3072 sc1
s_mov_b64 exec, -1
s_load_dword s96, s[74:75], 1536 glc
s_load_dword s97, s[74:75], 1664 glc
s_load_dword s98, s[74:75], 1792 glc
s_load_dword s99, s[74:75], 1920 glc
s_and_b32 s33, s2, 1
s_bfe_u32 s27, s2, 0x20001
s_lshl_b32 s27, s27, 2
s_bfe_u32 s29, s2, 0x20003
s_add_u32 s27, s27, s29
s_lshr_b32 s28, s2, 5
s_mul_i32 s30, s33, 56
s_mul_i32 s29, s27, 112
s_add_u32 s29, s29, s30
s_lshl_b32 s29, s29, 13
s_add_u32 s29, s29, 5242880
s_lshl_b32 s31, s28, 1
s_lshr_b32 s32, s26, 1
s_add_u32 s31, s31, s32
s_mul_i32 s31, s31, 112
s_add_u32 s31, s31, s30
s_lshl_b32 s31, s31, 12
s_and_b32 s32, s26, 1
s_lshl_b32 s32, s32, 11
s_add_u32 s31, s31, s32
s_add_u32 s31, s31, 33554432
s_lshl_b32 s22, s26, 13
s_mov_b32 s34, 458752
s_sub_u32 s32, 229376, s32
s_mov_b32 s21, 0
s_mov_b32 s20, s22
s_add_u32 s8, s86, s29
s_addc_u32 s9, s87, 0
s_mov_b32 s10, s34
s_mov_b32 s11, 0x20000
s_add_u32 s12, s24, s31
s_addc_u32 s13, s25, 0
s_mov_b32 s14, s32
s_mov_b32 s15, 0x20000
v_lshlrev_b32 v128, 4, v31
v_add_u32 v129, 4096, v128
v_mov_b32 v130, v128
v_add_u32 v131, 65536, v128
s_lshl_b32 s30, s33, 12
v_add_u32 v137, s30, v128
v_subrev_u32 v136, s30, v129
v_and_b32 v12, 15, v31
v_bfe_u32 v13, v31, 4, 1
v_lshrrev_b32 v14, 5, v31
v_lshl_add_u32 v13, v13, 1, v14
v_and_b32 v132, 7, v12
v_lshlrev_b32 v132, 4, v132
v_lshl_add_u32 v132, v13, 7, v132
v_lshrrev_b32 v12, 3, v12
v_lshl_add_u32 v132, v12, 9, v132
v_add_u32 v133, 131072, v132
s_mul_i32 s30, s33, 131072
v_subrev_u32 v134, s30, v133
v_add_u32 v133, s30, v132
v_mov_b32 v132, v134
v_and_b32 v138, 15, v31
v_lshlrev_b32 v138, 11, v138
v_lshl_add_u32 v138, v13, 4, v138
s_lshl_b32 s29, s27, 6
s_lshl_b32 s30, s28, 2
s_add_u32 s29, s29, s30
s_add_u32 s29, s29, s26
s_mul_i32 s36, s29, 4096
s_mul_i32 s29, s33, 6291456
s_add_u32 s29, s29, 20971520
s_add_u32 s16, s86, s29
s_addc_u32 s17, s87, 0
s_mov_b32 s18, 4194304
s_mov_b32 s19, 0x20000
s_mov_b32 s40, s16
s_mov_b32 s41, s17
s_mul_i32 s42, s60, 4194304
s_mov_b32 s43, 0x20000
s_add_u32 s56, s86, 33554432
s_addc_u32 s57, s87, 0
s_sub_u32 s58, 1, s60
s_mul_i32 s58, s58, 4194304
s_mov_b32 s59, 0x20000
s_mul_i32 s49, s27, 165888
s_lshl_b32 s30, s28, 1
s_add_u32 s30, s30, s33
s_lshr_b32 s101, s30, 2
s_lshl_b32 s101, s101, 7
s_and_b32 s30, s30, 3
s_add_u32 s30, s30, s101
s_add_u32 s49, s49, s30
s_add_u32 s49, s49, 151040
s_add_u32 s49, s49, s85
v_and_b32 v26, 1, v31
v_lshlrev_b32 v26, 3, v26
v_lshrrev_b32 v27, 1, v31
v_lshl_add_u32 v26, v27, 5, v26
v_mul_u32_u24 v26, 10368, v26
v_mov_b32 v27, 1
s_waitcnt vmcnt(0)
s_barrier
s_cmp_lg_u32 s26, 0
s_cbranch_scc1 sig7
s_mov_b64 exec, 0xffff
buffer_store_byte v27, v26, s[88:91], s46 offen sc1
s_mov_b64 exec, -1
sig7:
s_waitcnt lgkmcnt(0)
s_and_b32 s96, s96, s97
s_and_b32 s98, s98, s99
s_and_b32 s96, s96, s98
s_cmp_eq_u32 s96, 0x01010101
s_cbranch_scc1 interleave_layers__ssm_conv_h3__geglu_ffn__prompt_kernel_nocw
s_mov_b32 s101, 1536
s_add_u32 vcc_lo, s74, s101
s_addc_u32 vcc_hi, s75, 0
s_mov_b32 s100, 0x200000
wpc:
s_load_dword s92, vcc, 0 glc
s_load_dword s93, vcc, 128 glc
s_load_dword s94, vcc, 256 glc
s_load_dword s95, vcc, 384 glc
s_waitcnt lgkmcnt(0)
s_and_b32 s92, s92, s93
s_and_b32 s92, s92, s94
s_and_b32 s92, s92, s95
s_cmp_eq_u32 s92, 0x01010101
s_cbranch_scc1 wdc
s_sleep 2
s_sub_u32 s100, s100, 1
s_cmp_lg_u32 s100, 0
s_cbranch_scc1 wpc
wdc:
interleave_layers__ssm_conv_h3__geglu_ffn__prompt_kernel_nocw:
s_cmp_lg_u32 s26, 0
s_cbranch_scc1 interleave_layers__ssm_conv_h3__geglu_ffn__prompt_kernel_bp0
s_add_u32 s101, s85, 3072
s_add_u32 vcc_lo, s74, s101
s_addc_u32 vcc_hi, s75, 0
s_load_dword s92, vcc, 0 glc
s_load_dword s93, vcc, 128 glc
s_load_dword s94, vcc, 256 glc
s_load_dword s95, vcc, 384 glc
interleave_layers__ssm_conv_h3__geglu_ffn__prompt_kernel_bp0:
buffer_load_dwordx4 a[0:3], v128, s[12:15], s21 offen offset:0
buffer_load_dwordx4 a[4:7], v128, s[12:15], s21 offen offset:1024
s_add_u32 s21, s21, 4096
buffer_load_dwordx4 a[8:11], v128, s[12:15], s21 offen offset:0
buffer_load_dwordx4 a[12:15], v128, s[12:15], s21 offen offset:1024
s_add_u32 s21, s21, 4096
buffer_load_dwordx4 a[16:19], v128, s[12:15], s21 offen offset:0
buffer_load_dwordx4 a[20:23], v128, s[12:15], s21 offen offset:1024
s_add_u32 s21, s21, 4096
buffer_load_dwordx4 a[24:27], v128, s[12:15], s21 offen offset:0
buffer_load_dwordx4 a[28:31], v128, s[12:15], s21 offen offset:1024
s_add_u32 s21, s21, 4096
buffer_load_dwordx4 a[32:35], v128, s[12:15], s21 offen offset:0
buffer_load_dwordx4 a[36:39], v128, s[12:15], s21 offen offset:1024
s_add_u32 s21, s21, 4096
buffer_load_dwordx4 a[40:43], v128, s[12:15], s21 offen offset:0
buffer_load_dwordx4 a[44:47], v128, s[12:15], s21 offen offset:1024
s_add_u32 s21, s21, 4096
buffer_load_dwordx4 a[48:51], v128, s[12:15], s21 offen offset:0
buffer_load_dwordx4 a[52:55], v128, s[12:15], s21 offen offset:1024
s_add_u32 s21, s21, 4096
buffer_load_dwordx4 a[56:59], v128, s[12:15], s21 offen offset:0
buffer_load_dwordx4 a[60:63], v128, s[12:15], s21 offen offset:1024
s_add_u32 s21, s21, 4096
v_mov_b32 v64, 0
v_mov_b32 v65, 0
v_mov_b32 v66, 0
v_mov_b32 v67, 0
v_mov_b32 v68, 0
v_mov_b32 v69, 0
v_mov_b32 v70, 0
v_mov_b32 v71, 0
v_mov_b32 v72, 0
v_mov_b32 v73, 0
v_mov_b32 v74, 0
v_mov_b32 v75, 0
v_mov_b32 v76, 0
v_mov_b32 v77, 0
v_mov_b32 v78, 0
v_mov_b32 v79, 0
v_mov_b32 v80, 0
v_mov_b32 v81, 0
v_mov_b32 v82, 0
v_mov_b32 v83, 0
v_mov_b32 v84, 0
v_mov_b32 v85, 0
v_mov_b32 v86, 0
v_mov_b32 v87, 0
v_mov_b32 v88, 0
v_mov_b32 v89, 0
v_mov_b32 v90, 0
v_mov_b32 v91, 0
v_mov_b32 v92, 0
v_mov_b32 v93, 0
v_mov_b32 v94, 0
v_mov_b32 v95, 0
v_mov_b32 v96, 0
v_mov_b32 v97, 0
v_mov_b32 v98, 0
v_mov_b32 v99, 0
v_mov_b32 v100, 0
v_mov_b32 v101, 0
v_mov_b32 v102, 0
v_mov_b32 v103, 0
v_mov_b32 v104, 0
v_mov_b32 v105, 0
v_mov_b32 v106, 0
v_mov_b32 v107, 0
v_mov_b32 v108, 0
v_mov_b32 v109, 0
v_mov_b32 v110, 0
v_mov_b32 v111, 0
v_mov_b32 v112, 0
v_mov_b32 v113, 0
v_mov_b32 v114, 0
v_mov_b32 v115, 0
v_mov_b32 v116, 0
v_mov_b32 v117, 0
v_mov_b32 v118, 0
v_mov_b32 v119, 0
v_mov_b32 v120, 0
v_mov_b32 v121, 0
v_mov_b32 v122, 0
v_mov_b32 v123, 0
v_mov_b32 v124, 0
v_mov_b32 v125, 0
v_mov_b32 v126, 0
v_mov_b32 v127, 0
s_cmp_lg_u32 s26, 0
s_cbranch_scc1 interleave_layers__ssm_conv_h3__geglu_ffn__prompt_kernel_bp1
s_waitcnt lgkmcnt(0)
s_and_b32 s92, s92, s93
s_and_b32 s94, s94, s95
s_and_b32 s92, s92, s94
s_cmp_eq_u32 s92, 0x01010101
s_cbranch_scc1 interleave_layers__ssm_conv_h3__geglu_ffn__prompt_kernel_bp1
s_add_u32 s101, s85, 3072
s_add_u32 vcc_lo, s74, s101
s_addc_u32 vcc_hi, s75, 0
s_mov_b32 s100, 0x200000
wpb:
s_load_dword s92, vcc, 0 glc
s_load_dword s93, vcc, 128 glc
s_load_dword s94, vcc, 256 glc
s_load_dword s95, vcc, 384 glc
s_waitcnt lgkmcnt(0)
s_and_b32 s92, s92, s93
s_and_b32 s92, s92, s94
s_and_b32 s92, s92, s95
s_cmp_eq_u32 s92, 0x01010101
s_cbranch_scc1 wdb
s_sleep 2
s_sub_u32 s100, s100, 1
s_cmp_lg_u32 s100, 0
s_cbranch_scc1 wpb
wdb:
interleave_layers__ssm_conv_h3__geglu_ffn__prompt_kernel_bp1:
s_barrier
s_add_u32 m0, s22, 0
s_nop 0
buffer_load_dwordx4 v136, s[8:11], s20 offen offset:0  lds
buffer_load_dwordx4 v136, s[8:11], s20 offen offset:1024  lds
buffer_load_dwordx4 v136, s[8:11], s20 offen offset:2048  lds
buffer_load_dwordx4 v136, s[8:11], s20 offen offset:3072  lds
s_add_u32 m0, s22, 4096
s_nop 0
buffer_load_dwordx4 v137, s[8:11], s20 offen offset:0  lds
buffer_load_dwordx4 v137, s[8:11], s20 offen offset:1024  lds
buffer_load_dwordx4 v137, s[8:11], s20 offen offset:2048  lds
buffer_load_dwordx4 v137, s[8:11], s20 offen offset:3072  lds
s_add_u32 s20, s20, 32768
s_add_u32 m0, s22, 32768
s_nop 0
buffer_load_dwordx4 v136, s[8:11], s20 offen offset:0  lds
buffer_load_dwordx4 v136, s[8:11], s20 offen offset:1024  lds
buffer_load_dwordx4 v136, s[8:11], s20 offen offset:2048  lds
buffer_load_dwordx4 v136, s[8:11], s20 offen offset:3072  lds
s_add_u32 m0, s22, 36864
s_nop 0
buffer_load_dwordx4 v137, s[8:11], s20 offen offset:0  lds
buffer_load_dwordx4 v137, s[8:11], s20 offen offset:1024  lds
buffer_load_dwordx4 v137, s[8:11], s20 offen offset:2048  lds
buffer_load_dwordx4 v137, s[8:11], s20 offen offset:3072  lds
s_add_u32 s20, s20, 32768
s_waitcnt vmcnt(8)
s_barrier
ds_read_b128 a[64:67], v130 offset:0
ds_read_b128 a[68:71], v130 offset:1024
ds_read_b128 a[72:75], v130 offset:2048
ds_read_b128 a[76:79], v130 offset:3072
ds_read_b128 a[80:83], v130 offset:4096
ds_read_b128 a[84:87], v130 offset:5120
s_mov_b32 s35, 3
.p2align 6
interleave_layers__ssm_conv_h3__geglu_ffn__prompt_kernel_g2loop:
s_waitcnt vmcnt(28) lgkmcnt(4)
v_mfma_f32_16x16x32_bf16 v[64:67], a[0:3], a[64:67], v[64:67]
ds_read_b128 a[88:91], v130 offset:6144
v_mfma_f32_16x16x32_bf16 v[68:71], a[4:7], a[64:67], v[68:71]
s_add_u32 m0, s22, 65536
s_nop 0
buffer_load_dwordx4 v136, s[8:11], s20 offen offset:0  lds
v_mfma_f32_16x16x32_bf16 v[76:79], a[4:7], a[68:71], v[76:79]
ds_read_b128 a[92:95], v130 offset:7168
v_mfma_f32_16x16x32_bf16 v[72:75], a[0:3], a[68:71], v[72:75]
s_waitcnt lgkmcnt(4)
v_mfma_f32_16x16x32_bf16 v[80:83], a[0:3], a[72:75], v[80:83]
ds_read_b128 a[64:67], v130 offset:8192
v_mfma_f32_16x16x32_bf16 v[84:87], a[4:7], a[72:75], v[84:87]
buffer_load_dwordx4 a[96:99], v128, s[12:15], s21 offen offset:0
v_mfma_f32_16x16x32_bf16 v[92:95], a[4:7], a[76:79], v[92:95]
ds_read_b128 a[68:71], v130 offset:9216
v_mfma_f32_16x16x32_bf16 v[88:91], a[0:3], a[76:79], v[88:91]
buffer_load_dwordx4 v136, s[8:11], s20 offen offset:1024  lds
s_waitcnt lgkmcnt(4)
v_mfma_f32_16x16x32_bf16 v[96:99], a[0:3], a[80:83], v[96:99]
ds_read_b128 a[72:75], v130 offset:10240
v_mfma_f32_16x16x32_bf16 v[100:103], a[4:7], a[80:83], v[100:103]
v_mfma_f32_16x16x32_bf16 v[108:111], a[4:7], a[84:87], v[108:111]
ds_read_b128 a[76:79], v130 offset:11264
v_mfma_f32_16x16x32_bf16 v[104:107], a[0:3], a[84:87], v[104:107]
buffer_load_dwordx4 a[100:103], v128, s[12:15], s21 offen offset:1024
s_add_u32 s21, s21, 4096
s_waitcnt lgkmcnt(4)
v_mfma_f32_16x16x32_bf16 v[112:115], a[0:3], a[88:91], v[112:115]
ds_read_b128 a[80:83], v130 offset:12288
v_mfma_f32_16x16x32_bf16 v[116:119], a[4:7], a[88:91], v[116:119]
buffer_load_dwordx4 v136, s[8:11], s20 offen offset:2048  lds
v_mfma_f32_16x16x32_bf16 v[124:127], a[4:7], a[92:95], v[124:127]
ds_read_b128 a[84:87], v130 offset:13312
v_mfma_f32_16x16x32_bf16 v[120:123], a[0:3], a[92:95], v[120:123]
s_waitcnt vmcnt(28) lgkmcnt(4)
v_mfma_f32_16x16x32_bf16 v[64:67], a[8:11], a[64:67], v[64:67]
ds_read_b128 a[88:91], v130 offset:14336
v_mfma_f32_16x16x32_bf16 v[68:71], a[12:15], a[64:67], v[68:71]
v_mfma_f32_16x16x32_bf16 v[76:79], a[12:15], a[68:71], v[76:79]
ds_read_b128 a[92:95], v130 offset:15360
v_mfma_f32_16x16x32_bf16 v[72:75], a[8:11], a[68:71], v[72:75]
buffer_load_dwordx4 v136, s[8:11], s20 offen offset:3072  lds
s_waitcnt lgkmcnt(4)
v_mfma_f32_16x16x32_bf16 v[80:83], a[8:11], a[72:75], v[80:83]
ds_read_b128 a[64:67], v130 offset:16384
v_mfma_f32_16x16x32_bf16 v[84:87], a[12:15], a[72:75], v[84:87]
buffer_load_dwordx4 a[104:107], v128, s[12:15], s21 offen offset:0
v_mfma_f32_16x16x32_bf16 v[92:95], a[12:15], a[76:79], v[92:95]
ds_read_b128 a[68:71], v130 offset:17408
v_mfma_f32_16x16x32_bf16 v[88:91], a[8:11], a[76:79], v[88:91]
s_waitcnt lgkmcnt(4)
v_mfma_f32_16x16x32_bf16 v[96:99], a[8:11], a[80:83], v[96:99]
ds_read_b128 a[72:75], v130 offset:18432
v_mfma_f32_16x16x32_bf16 v[100:103], a[12:15], a[80:83], v[100:103]
s_add_u32 m0, s22, 69632
s_nop 0
buffer_load_dwordx4 v137, s[8:11], s20 offen offset:0  lds
v_mfma_f32_16x16x32_bf16 v[108:111], a[12:15], a[84:87], v[108:111]
ds_read_b128 a[76:79], v130 offset:19456
v_mfma_f32_16x16x32_bf16 v[104:107], a[8:11], a[84:87], v[104:107]
buffer_load_dwordx4 a[108:111], v128, s[12:15], s21 offen offset:1024
s_add_u32 s21, s21, 4096
s_waitcnt lgkmcnt(4)
v_mfma_f32_16x16x32_bf16 v[112:115], a[8:11], a[88:91], v[112:115]
ds_read_b128 a[80:83], v130 offset:20480
v_mfma_f32_16x16x32_bf16 v[116:119], a[12:15], a[88:91], v[116:119]
v_mfma_f32_16x16x32_bf16 v[124:127], a[12:15], a[92:95], v[124:127]
ds_read_b128 a[84:87], v130 offset:21504
v_mfma_f32_16x16x32_bf16 v[120:123], a[8:11], a[92:95], v[120:123]
buffer_load_dwordx4 v137, s[8:11], s20 offen offset:1024  lds
s_waitcnt vmcnt(10) lgkmcnt(4)
s_barrier
v_mfma_f32_16x16x32_bf16 v[64:67], a[16:19], a[64:67], v[64:67]
ds_read_b128 a[88:91], v130 offset:22528
v_mfma_f32_16x16x32_bf16 v[68:71], a[20:23], a[64:67], v[68:71]
v_mfma_f32_16x16x32_bf16 v[76:79], a[20:23], a[68:71], v[76:79]
ds_read_b128 a[92:95], v130 offset:23552
v_mfma_f32_16x16x32_bf16 v[72:75], a[16:19], a[68:71], v[72:75]
s_waitcnt lgkmcnt(4)
v_mfma_f32_16x16x32_bf16 v[80:83], a[16:19], a[72:75], v[80:83]
ds_read_b128 a[64:67], v130 offset:24576
v_mfma_f32_16x16x32_bf16 v[84:87], a[20:23], a[72:75], v[84:87]
buffer_load_dwordx4 v137, s[8:11], s20 offen offset:2048  lds
buffer_load_dwordx4 a[112:115], v128, s[12:15], s21 offen offset:0
v_mfma_f32_16x16x32_bf16 v[92:95], a[20:23], a[76:79], v[92:95]
ds_read_b128 a[68:71], v130 offset:25600
v_mfma_f32_16x16x32_bf16 v[88:91], a[16:19], a[76:79], v[88:91]
s_waitcnt lgkmcnt(4)
v_mfma_f32_16x16x32_bf16 v[96:99], a[16:19], a[80:83], v[96:99]
ds_read_b128 a[72:75], v130 offset:26624
v_mfma_f32_16x16x32_bf16 v[100:103], a[20:23], a[80:83], v[100:103]
v_mfma_f32_16x16x32_bf16 v[108:111], a[20:23], a[84:87], v[108:111]
ds_read_b128 a[76:79], v130 offset:27648
v_mfma_f32_16x16x32_bf16 v[104:107], a[16:19], a[84:87], v[104:107]
buffer_load_dwordx4 v137, s[8:11], s20 offen offset:3072  lds
s_add_u32 s20, s20, 32768
buffer_load_dwordx4 a[116:119], v128, s[12:15], s21 offen offset:1024
s_add_u32 s21, s21, 4096
s_waitcnt lgkmcnt(4)
v_mfma_f32_16x16x32_bf16 v[112:115], a[16:19], a[88:91], v[112:115]
ds_read_b128 a[80:83], v130 offset:28672
v_mfma_f32_16x16x32_bf16 v[116:119], a[20:23], a[88:91], v[116:119]
v_mfma_f32_16x16x32_bf16 v[124:127], a[20:23], a[92:95], v[124:127]
ds_read_b128 a[84:87], v130 offset:29696
v_mfma_f32_16x16x32_bf16 v[120:123], a[16:19], a[92:95], v[120:123]
s_waitcnt vmcnt(30) lgkmcnt(4)
v_mfma_f32_16x16x32_bf16 v[64:67], a[24:27], a[64:67], v[64:67]
ds_read_b128 a[88:91], v130 offset:30720
v_mfma_f32_16x16x32_bf16 v[68:71], a[28:31], a[64:67], v[68:71]
v_mfma_f32_16x16x32_bf16 v[76:79], a[28:31], a[68:71], v[76:79]
ds_read_b128 a[92:95], v130 offset:31744
v_mfma_f32_16x16x32_bf16 v[72:75], a[24:27], a[68:71], v[72:75]
s_waitcnt lgkmcnt(4)
v_mfma_f32_16x16x32_bf16 v[80:83], a[24:27], a[72:75], v[80:83]
ds_read_b128 a[64:67], v130 offset:32768
v_mfma_f32_16x16x32_bf16 v[84:87], a[28:31], a[72:75], v[84:87]
buffer_load_dwordx4 a[120:123], v128, s[12:15], s21 offen offset:0
v_mfma_f32_16x16x32_bf16 v[92:95], a[28:31], a[76:79], v[92:95]
ds_read_b128 a[68:71], v130 offset:33792
v_mfma_f32_16x16x32_bf16 v[88:91], a[24:27], a[76:79], v[88:91]
s_waitcnt lgkmcnt(4)
v_mfma_f32_16x16x32_bf16 v[96:99], a[24:27], a[80:83], v[96:99]
ds_read_b128 a[72:75], v130 offset:34816
v_mfma_f32_16x16x32_bf16 v[100:103], a[28:31], a[80:83], v[100:103]
v_mfma_f32_16x16x32_bf16 v[108:111], a[28:31], a[84:87], v[108:111]
ds_read_b128 a[76:79], v130 offset:35840
v_mfma_f32_16x16x32_bf16 v[104:107], a[24:27], a[84:87], v[104:107]
buffer_load_dwordx4 a[124:127], v128, s[12:15], s21 offen offset:1024
s_add_u32 s21, s21, 4096
s_waitcnt lgkmcnt(4)
v_mfma_f32_16x16x32_bf16 v[112:115], a[24:27], a[88:91], v[112:115]
ds_read_b128 a[80:83], v130 offset:36864
v_mfma_f32_16x16x32_bf16 v[116:119], a[28:31], a[88:91], v[116:119]
v_mfma_f32_16x16x32_bf16 v[124:127], a[28:31], a[92:95], v[124:127]
ds_read_b128 a[84:87], v130 offset:37888
v_mfma_f32_16x16x32_bf16 v[120:123], a[24:27], a[92:95], v[120:123]
s_waitcnt vmcnt(28) lgkmcnt(4)
v_mfma_f32_16x16x32_bf16 v[64:67], a[32:35], a[64:67], v[64:67]
ds_read_b128 a[88:91], v130 offset:38912
v_mfma_f32_16x16x32_bf16 v[68:71], a[36:39], a[64:67], v[68:71]
s_add_u32 m0, s22, 98304
s_nop 0
buffer_load_dwordx4 v136, s[8:11], s20 offen offset:0  lds
v_mfma_f32_16x16x32_bf16 v[76:79], a[36:39], a[68:71], v[76:79]
ds_read_b128 a[92:95], v130 offset:39936
v_mfma_f32_16x16x32_bf16 v[72:75], a[32:35], a[68:71], v[72:75]
s_waitcnt lgkmcnt(4)
v_mfma_f32_16x16x32_bf16 v[80:83], a[32:35], a[72:75], v[80:83]
ds_read_b128 a[64:67], v130 offset:40960
v_mfma_f32_16x16x32_bf16 v[84:87], a[36:39], a[72:75], v[84:87]
buffer_load_dwordx4 a[128:131], v128, s[12:15], s21 offen offset:0
v_mfma_f32_16x16x32_bf16 v[92:95], a[36:39], a[76:79], v[92:95]
ds_read_b128 a[68:71], v130 offset:41984
v_mfma_f32_16x16x32_bf16 v[88:91], a[32:35], a[76:79], v[88:91]
buffer_load_dwordx4 v136, s[8:11], s20 offen offset:1024  lds
s_waitcnt lgkmcnt(4)
v_mfma_f32_16x16x32_bf16 v[96:99], a[32:35], a[80:83], v[96:99]
ds_read_b128 a[72:75], v130 offset:43008
v_mfma_f32_16x16x32_bf16 v[100:103], a[36:39], a[80:83], v[100:103]
v_mfma_f32_16x16x32_bf16 v[108:111], a[36:39], a[84:87], v[108:111]
ds_read_b128 a[76:79], v130 offset:44032
v_mfma_f32_16x16x32_bf16 v[104:107], a[32:35], a[84:87], v[104:107]
buffer_load_dwordx4 a[132:135], v128, s[12:15], s21 offen offset:1024
s_add_u32 s21, s21, 4096
s_waitcnt lgkmcnt(4)
v_mfma_f32_16x16x32_bf16 v[112:115], a[32:35], a[88:91], v[112:115]
ds_read_b128 a[80:83], v130 offset:45056
v_mfma_f32_16x16x32_bf16 v[116:119], a[36:39], a[88:91], v[116:119]
buffer_load_dwordx4 v136, s[8:11], s20 offen offset:2048  lds
v_mfma_f32_16x16x32_bf16 v[124:127], a[36:39], a[92:95], v[124:127]
ds_read_b128 a[84:87], v130 offset:46080
v_mfma_f32_16x16x32_bf16 v[120:123], a[32:35], a[92:95], v[120:123]
s_waitcnt vmcnt(28) lgkmcnt(4)
v_mfma_f32_16x16x32_bf16 v[64:67], a[40:43], a[64:67], v[64:67]
ds_read_b128 a[88:91], v130 offset:47104
v_mfma_f32_16x16x32_bf16 v[68:71], a[44:47], a[64:67], v[68:71]
v_mfma_f32_16x16x32_bf16 v[76:79], a[44:47], a[68:71], v[76:79]
ds_read_b128 a[92:95], v130 offset:48128
v_mfma_f32_16x16x32_bf16 v[72:75], a[40:43], a[68:71], v[72:75]
buffer_load_dwordx4 v136, s[8:11], s20 offen offset:3072  lds
s_waitcnt lgkmcnt(4)
v_mfma_f32_16x16x32_bf16 v[80:83], a[40:43], a[72:75], v[80:83]
ds_read_b128 a[64:67], v130 offset:49152
v_mfma_f32_16x16x32_bf16 v[84:87], a[44:47], a[72:75], v[84:87]
buffer_load_dwordx4 a[136:139], v128, s[12:15], s21 offen offset:0
v_mfma_f32_16x16x32_bf16 v[92:95], a[44:47], a[76:79], v[92:95]
ds_read_b128 a[68:71], v130 offset:50176
v_mfma_f32_16x16x32_bf16 v[88:91], a[40:43], a[76:79], v[88:91]
s_waitcnt lgkmcnt(4)
v_mfma_f32_16x16x32_bf16 v[96:99], a[40:43], a[80:83], v[96:99]
ds_read_b128 a[72:75], v130 offset:51200
v_mfma_f32_16x16x32_bf16 v[100:103], a[44:47], a[80:83], v[100:103]
s_add_u32 m0, s22, 102400
s_nop 0
buffer_load_dwordx4 v137, s[8:11], s20 offen offset:0  lds
v_mfma_f32_16x16x32_bf16 v[108:111], a[44:47], a[84:87], v[108:111]
ds_read_b128 a[76:79], v130 offset:52224
v_mfma_f32_16x16x32_bf16 v[104:107], a[40:43], a[84:87], v[104:107]
buffer_load_dwordx4 a[140:143], v128, s[12:15], s21 offen offset:1024
s_add_u32 s21, s21, 4096
s_waitcnt lgkmcnt(4)
v_mfma_f32_16x16x32_bf16 v[112:115], a[40:43], a[88:91], v[112:115]
ds_read_b128 a[80:83], v130 offset:53248
v_mfma_f32_16x16x32_bf16 v[116:119], a[44:47], a[88:91], v[116:119]
v_mfma_f32_16x16x32_bf16 v[124:127], a[44:47], a[92:95], v[124:127]
ds_read_b128 a[84:87], v130 offset:54272
v_mfma_f32_16x16x32_bf16 v[120:123], a[40:43], a[92:95], v[120:123]
buffer_load_dwordx4 v137, s[8:11], s20 offen offset:1024  lds
s_waitcnt vmcnt(13) lgkmcnt(4)
s_barrier
v_mfma_f32_16x16x32_bf16 v[64:67], a[48:51], a[64:67], v[64:67]
ds_read_b128 a[88:91], v130 offset:55296
v_mfma_f32_16x16x32_bf16 v[68:71], a[52:55], a[64:67], v[68:71]
v_mfma_f32_16x16x32_bf16 v[76:79], a[52:55], a[68:71], v[76:79]
ds_read_b128 a[92:95], v130 offset:56320
v_mfma_f32_16x16x32_bf16 v[72:75], a[48:51], a[68:71], v[72:75]
s_waitcnt lgkmcnt(4)
v_mfma_f32_16x16x32_bf16 v[80:83], a[48:51], a[72:75], v[80:83]
ds_read_b128 a[64:67], v130 offset:57344
v_mfma_f32_16x16x32_bf16 v[84:87], a[52:55], a[72:75], v[84:87]
buffer_load_dwordx4 v137, s[8:11], s20 offen offset:2048  lds
buffer_load_dwordx4 a[144:147], v128, s[12:15], s21 offen offset:0
v_mfma_f32_16x16x32_bf16 v[92:95], a[52:55], a[76:79], v[92:95]
ds_read_b128 a[68:71], v130 offset:58368
v_mfma_f32_16x16x32_bf16 v[88:91], a[48:51], a[76:79], v[88:91]
s_waitcnt lgkmcnt(4)
v_mfma_f32_16x16x32_bf16 v[96:99], a[48:51], a[80:83], v[96:99]
ds_read_b128 a[72:75], v130 offset:59392
v_mfma_f32_16x16x32_bf16 v[100:103], a[52:55], a[80:83], v[100:103]
v_mfma_f32_16x16x32_bf16 v[108:111], a[52:55], a[84:87], v[108:111]
ds_read_b128 a[76:79], v130 offset:60416
v_mfma_f32_16x16x32_bf16 v[104:107], a[48:51], a[84:87], v[104:107]
buffer_load_dwordx4 v137, s[8:11], s20 offen offset:3072  lds
s_add_u32 s20, s20, 32768
buffer_load_dwordx4 a[148:151], v128, s[12:15], s21 offen offset:1024
s_add_u32 s21, s21, 4096
s_waitcnt lgkmcnt(4)
v_mfma_f32_16x16x32_bf16 v[112:115], a[48:51], a[88:91], v[112:115]
ds_read_b128 a[80:83], v130 offset:61440
v_mfma_f32_16x16x32_bf16 v[116:119], a[52:55], a[88:91], v[116:119]
v_mfma_f32_16x16x32_bf16 v[124:127], a[52:55], a[92:95], v[124:127]
ds_read_b128 a[84:87], v130 offset:62464
v_mfma_f32_16x16x32_bf16 v[120:123], a[48:51], a[92:95], v[120:123]
s_waitcnt vmcnt(30) lgkmcnt(4)
v_mfma_f32_16x16x32_bf16 v[64:67], a[56:59], a[64:67], v[64:67]
ds_read_b128 a[88:91], v130 offset:63488
v_mfma_f32_16x16x32_bf16 v[68:71], a[60:63], a[64:67], v[68:71]
v_mfma_f32_16x16x32_bf16 v[76:79], a[60:63], a[68:71], v[76:79]
ds_read_b128 a[92:95], v130 offset:64512
v_mfma_f32_16x16x32_bf16 v[72:75], a[56:59], a[68:71], v[72:75]
s_waitcnt lgkmcnt(4)
v_mfma_f32_16x16x32_bf16 v[80:83], a[56:59], a[72:75], v[80:83]
ds_read_b128 a[64:67], v131 offset:0
v_mfma_f32_16x16x32_bf16 v[84:87], a[60:63], a[72:75], v[84:87]
buffer_load_dwordx4 a[152:155], v128, s[12:15], s21 offen offset:0
v_mfma_f32_16x16x32_bf16 v[92:95], a[60:63], a[76:79], v[92:95]
ds_read_b128 a[68:71], v131 offset:1024
v_mfma_f32_16x16x32_bf16 v[88:91], a[56:59], a[76:79], v[88:91]
s_waitcnt lgkmcnt(4)
v_mfma_f32_16x16x32_bf16 v[96:99], a[56:59], a[80:83], v[96:99]
ds_read_b128 a[72:75], v131 offset:2048
v_mfma_f32_16x16x32_bf16 v[100:103], a[60:63], a[80:83], v[100:103]
v_mfma_f32_16x16x32_bf16 v[108:111], a[60:63], a[84:87], v[108:111]
ds_read_b128 a[76:79], v131 offset:3072
v_mfma_f32_16x16x32_bf16 v[104:107], a[56:59], a[84:87], v[104:107]
buffer_load_dwordx4 a[156:159], v128, s[12:15], s21 offen offset:1024
s_add_u32 s21, s21, 4096
s_waitcnt lgkmcnt(4)
v_mfma_f32_16x16x32_bf16 v[112:115], a[56:59], a[88:91], v[112:115]
ds_read_b128 a[80:83], v131 offset:4096
v_mfma_f32_16x16x32_bf16 v[116:119], a[60:63], a[88:91], v[116:119]
v_mfma_f32_16x16x32_bf16 v[124:127], a[60:63], a[92:95], v[124:127]
ds_read_b128 a[84:87], v131 offset:5120
v_mfma_f32_16x16x32_bf16 v[120:123], a[56:59], a[92:95], v[120:123]
s_waitcnt vmcnt(28) lgkmcnt(4)
v_mfma_f32_16x16x32_bf16 v[64:67], a[96:99], a[64:67], v[64:67]
ds_read_b128 a[88:91], v131 offset:6144
v_mfma_f32_16x16x32_bf16 v[68:71], a[100:103], a[64:67], v[68:71]
s_add_u32 m0, s22, 0
s_nop 0
buffer_load_dwordx4 v136, s[8:11], s20 offen offset:0  lds
v_mfma_f32_16x16x32_bf16 v[76:79], a[100:103], a[68:71], v[76:79]
ds_read_b128 a[92:95], v131 offset:7168
v_mfma_f32_16x16x32_bf16 v[72:75], a[96:99], a[68:71], v[72:75]
s_waitcnt lgkmcnt(4)
v_mfma_f32_16x16x32_bf16 v[80:83], a[96:99], a[72:75], v[80:83]
ds_read_b128 a[64:67], v131 offset:8192
v_mfma_f32_16x16x32_bf16 v[84:87], a[100:103], a[72:75], v[84:87]
buffer_load_dwordx4 a[0:3], v128, s[12:15], s21 offen offset:0
v_mfma_f32_16x16x32_bf16 v[92:95], a[100:103], a[76:79], v[92:95]
ds_read_b128 a[68:71], v131 offset:9216
v_mfma_f32_16x16x32_bf16 v[88:91], a[96:99], a[76:79], v[88:91]
buffer_load_dwordx4 v136, s[8:11], s20 offen offset:1024  lds
s_waitcnt lgkmcnt(4)
v_mfma_f32_16x16x32_bf16 v[96:99], a[96:99], a[80:83], v[96:99]
ds_read_b128 a[72:75], v131 offset:10240
v_mfma_f32_16x16x32_bf16 v[100:103], a[100:103], a[80:83], v[100:103]
v_mfma_f32_16x16x32_bf16 v[108:111], a[100:103], a[84:87], v[108:111]
ds_read_b128 a[76:79], v131 offset:11264
v_mfma_f32_16x16x32_bf16 v[104:107], a[96:99], a[84:87], v[104:107]
buffer_load_dwordx4 a[4:7], v128, s[12:15], s21 offen offset:1024
s_add_u32 s21, s21, 4096
s_waitcnt lgkmcnt(4)
v_mfma_f32_16x16x32_bf16 v[112:115], a[96:99], a[88:91], v[112:115]
ds_read_b128 a[80:83], v131 offset:12288
v_mfma_f32_16x16x32_bf16 v[116:119], a[100:103], a[88:91], v[116:119]
buffer_load_dwordx4 v136, s[8:11], s20 offen offset:2048  lds
v_mfma_f32_16x16x32_bf16 v[124:127], a[100:103], a[92:95], v[124:127]
ds_read_b128 a[84:87], v131 offset:13312
v_mfma_f32_16x16x32_bf16 v[120:123], a[96:99], a[92:95], v[120:123]
s_waitcnt vmcnt(28) lgkmcnt(4)
v_mfma_f32_16x16x32_bf16 v[64:67], a[104:107], a[64:67], v[64:67]
ds_read_b128 a[88:91], v131 offset:14336
v_mfma_f32_16x16x32_bf16 v[68:71], a[108:111], a[64:67], v[68:71]
v_mfma_f32_16x16x32_bf16 v[76:79], a[108:111], a[68:71], v[76:79]
ds_read_b128 a[92:95], v131 offset:15360
v_mfma_f32_16x16x32_bf16 v[72:75], a[104:107], a[68:71], v[72:75]
buffer_load_dwordx4 v136, s[8:11], s20 offen offset:3072  lds
s_waitcnt lgkmcnt(4)
v_mfma_f32_16x16x32_bf16 v[80:83], a[104:107], a[72:75], v[80:83]
ds_read_b128 a[64:67], v131 offset:16384
v_mfma_f32_16x16x32_bf16 v[84:87], a[108:111], a[72:75], v[84:87]
buffer_load_dwordx4 a[8:11], v128, s[12:15], s21 offen offset:0
v_mfma_f32_16x16x32_bf16 v[92:95], a[108:111], a[76:79], v[92:95]
ds_read_b128 a[68:71], v131 offset:17408
v_mfma_f32_16x16x32_bf16 v[88:91], a[104:107], a[76:79], v[88:91]
s_waitcnt lgkmcnt(4)
v_mfma_f32_16x16x32_bf16 v[96:99], a[104:107], a[80:83], v[96:99]
ds_read_b128 a[72:75], v131 offset:18432
v_mfma_f32_16x16x32_bf16 v[100:103], a[108:111], a[80:83], v[100:103]
s_add_u32 m0, s22, 4096
s_nop 0
buffer_load_dwordx4 v137, s[8:11], s20 offen offset:0  lds
v_mfma_f32_16x16x32_bf16 v[108:111], a[108:111], a[84:87], v[108:111]
ds_read_b128 a[76:79], v131 offset:19456
v_mfma_f32_16x16x32_bf16 v[104:107], a[104:107], a[84:87], v[104:107]
buffer_load_dwordx4 a[12:15], v128, s[12:15], s21 offen offset:1024
s_add_u32 s21, s21, 4096
s_waitcnt lgkmcnt(4)
v_mfma_f32_16x16x32_bf16 v[112:115], a[104:107], a[88:91], v[112:115]
ds_read_b128 a[80:83], v131 offset:20480
v_mfma_f32_16x16x32_bf16 v[116:119], a[108:111], a[88:91], v[116:119]
v_mfma_f32_16x16x32_bf16 v[124:127], a[108:111], a[92:95], v[124:127]
ds_read_b128 a[84:87], v131 offset:21504
v_mfma_f32_16x16x32_bf16 v[120:123], a[104:107], a[92:95], v[120:123]
buffer_load_dwordx4 v137, s[8:11], s20 offen offset:1024  lds
s_waitcnt vmcnt(13) lgkmcnt(4)
s_barrier
v_mfma_f32_16x16x32_bf16 v[64:67], a[112:115], a[64:67], v[64:67]
ds_read_b128 a[88:91], v131 offset:22528
v_mfma_f32_16x16x32_bf16 v[68:71], a[116:119], a[64:67], v[68:71]
v_mfma_f32_16x16x32_bf16 v[76:79], a[116:119], a[68:71], v[76:79]
ds_read_b128 a[92:95], v131 offset:23552
v_mfma_f32_16x16x32_bf16 v[72:75], a[112:115], a[68:71], v[72:75]
s_waitcnt lgkmcnt(4)
v_mfma_f32_16x16x32_bf16 v[80:83], a[112:115], a[72:75], v[80:83]
ds_read_b128 a[64:67], v131 offset:24576
v_mfma_f32_16x16x32_bf16 v[84:87], a[116:119], a[72:75], v[84:87]
buffer_load_dwordx4 v137, s[8:11], s20 offen offset:2048  lds
buffer_load_dwordx4 a[16:19], v128, s[12:15], s21 offen offset:0
v_mfma_f32_16x16x32_bf16 v[92:95], a[116:119], a[76:79], v[92:95]
ds_read_b128 a[68:71], v131 offset:25600
v_mfma_f32_16x16x32_bf16 v[88:91], a[112:115], a[76:79], v[88:91]
s_waitcnt lgkmcnt(4)
v_mfma_f32_16x16x32_bf16 v[96:99], a[112:115], a[80:83], v[96:99]
ds_read_b128 a[72:75], v131 offset:26624
v_mfma_f32_16x16x32_bf16 v[100:103], a[116:119], a[80:83], v[100:103]
v_mfma_f32_16x16x32_bf16 v[108:111], a[116:119], a[84:87], v[108:111]
ds_read_b128 a[76:79], v131 offset:27648
v_mfma_f32_16x16x32_bf16 v[104:107], a[112:115], a[84:87], v[104:107]
buffer_load_dwordx4 v137, s[8:11], s20 offen offset:3072  lds
s_add_u32 s20, s20, 32768
buffer_load_dwordx4 a[20:23], v128, s[12:15], s21 offen offset:1024
s_add_u32 s21, s21, 4096
s_waitcnt lgkmcnt(4)
v_mfma_f32_16x16x32_bf16 v[112:115], a[112:115], a[88:91], v[112:115]
ds_read_b128 a[80:83], v131 offset:28672
v_mfma_f32_16x16x32_bf16 v[116:119], a[116:119], a[88:91], v[116:119]
v_mfma_f32_16x16x32_bf16 v[124:127], a[116:119], a[92:95], v[124:127]
ds_read_b128 a[84:87], v131 offset:29696
v_mfma_f32_16x16x32_bf16 v[120:123], a[112:115], a[92:95], v[120:123]
s_waitcnt vmcnt(30) lgkmcnt(4)
v_mfma_f32_16x16x32_bf16 v[64:67], a[120:123], a[64:67], v[64:67]
ds_read_b128 a[88:91], v131 offset:30720
v_mfma_f32_16x16x32_bf16 v[68:71], a[124:127], a[64:67], v[68:71]
v_mfma_f32_16x16x32_bf16 v[76:79], a[124:127], a[68:71], v[76:79]
ds_read_b128 a[92:95], v131 offset:31744
v_mfma_f32_16x16x32_bf16 v[72:75], a[120:123], a[68:71], v[72:75]
s_waitcnt lgkmcnt(4)
v_mfma_f32_16x16x32_bf16 v[80:83], a[120:123], a[72:75], v[80:83]
ds_read_b128 a[64:67], v131 offset:32768
v_mfma_f32_16x16x32_bf16 v[84:87], a[124:127], a[72:75], v[84:87]
buffer_load_dwordx4 a[24:27], v128, s[12:15], s21 offen offset:0
v_mfma_f32_16x16x32_bf16 v[92:95], a[124:127], a[76:79], v[92:95]
ds_read_b128 a[68:71], v131 offset:33792
v_mfma_f32_16x16x32_bf16 v[88:91], a[120:123], a[76:79], v[88:91]
s_waitcnt lgkmcnt(4)
v_mfma_f32_16x16x32_bf16 v[96:99], a[120:123], a[80:83], v[96:99]
ds_read_b128 a[72:75], v131 offset:34816
v_mfma_f32_16x16x32_bf16 v[100:103], a[124:127], a[80:83], v[100:103]
v_mfma_f32_16x16x32_bf16 v[108:111], a[124:127], a[84:87], v[108:111]
ds_read_b128 a[76:79], v131 offset:35840
v_mfma_f32_16x16x32_bf16 v[104:107], a[120:123], a[84:87], v[104:107]
buffer_load_dwordx4 a[28:31], v128, s[12:15], s21 offen offset:1024
s_add_u32 s21, s21, 4096
s_waitcnt lgkmcnt(4)
v_mfma_f32_16x16x32_bf16 v[112:115], a[120:123], a[88:91], v[112:115]
ds_read_b128 a[80:83], v131 offset:36864
v_mfma_f32_16x16x32_bf16 v[116:119], a[124:127], a[88:91], v[116:119]
v_mfma_f32_16x16x32_bf16 v[124:127], a[124:127], a[92:95], v[124:127]
ds_read_b128 a[84:87], v131 offset:37888
v_mfma_f32_16x16x32_bf16 v[120:123], a[120:123], a[92:95], v[120:123]
s_waitcnt vmcnt(28) lgkmcnt(4)
v_mfma_f32_16x16x32_bf16 v[64:67], a[128:131], a[64:67], v[64:67]
ds_read_b128 a[88:91], v131 offset:38912
v_mfma_f32_16x16x32_bf16 v[68:71], a[132:135], a[64:67], v[68:71]
s_add_u32 m0, s22, 32768
s_nop 0
buffer_load_dwordx4 v136, s[8:11], s20 offen offset:0  lds
v_mfma_f32_16x16x32_bf16 v[76:79], a[132:135], a[68:71], v[76:79]
ds_read_b128 a[92:95], v131 offset:39936
v_mfma_f32_16x16x32_bf16 v[72:75], a[128:131], a[68:71], v[72:75]
s_waitcnt lgkmcnt(4)
v_mfma_f32_16x16x32_bf16 v[80:83], a[128:131], a[72:75], v[80:83]
ds_read_b128 a[64:67], v131 offset:40960
v_mfma_f32_16x16x32_bf16 v[84:87], a[132:135], a[72:75], v[84:87]
buffer_load_dwordx4 a[32:35], v128, s[12:15], s21 offen offset:0
v_mfma_f32_16x16x32_bf16 v[92:95], a[132:135], a[76:79], v[92:95]
ds_read_b128 a[68:71], v131 offset:41984
v_mfma_f32_16x16x32_bf16 v[88:91], a[128:131], a[76:79], v[88:91]
buffer_load_dwordx4 v136, s[8:11], s20 offen offset:1024  lds
s_waitcnt lgkmcnt(4)
v_mfma_f32_16x16x32_bf16 v[96:99], a[128:131], a[80:83], v[96:99]
ds_read_b128 a[72:75], v131 offset:43008
v_mfma_f32_16x16x32_bf16 v[100:103], a[132:135], a[80:83], v[100:103]
v_mfma_f32_16x16x32_bf16 v[108:111], a[132:135], a[84:87], v[108:111]
ds_read_b128 a[76:79], v131 offset:44032
v_mfma_f32_16x16x32_bf16 v[104:107], a[128:131], a[84:87], v[104:107]
buffer_load_dwordx4 a[36:39], v128, s[12:15], s21 offen offset:1024
s_add_u32 s21, s21, 4096
s_waitcnt lgkmcnt(4)
v_mfma_f32_16x16x32_bf16 v[112:115], a[128:131], a[88:91], v[112:115]
ds_read_b128 a[80:83], v131 offset:45056
v_mfma_f32_16x16x32_bf16 v[116:119], a[132:135], a[88:91], v[116:119]
buffer_load_dwordx4 v136, s[8:11], s20 offen offset:2048  lds
v_mfma_f32_16x16x32_bf16 v[124:127], a[132:135], a[92:95], v[124:127]
ds_read_b128 a[84:87], v131 offset:46080
v_mfma_f32_16x16x32_bf16 v[120:123], a[128:131], a[92:95], v[120:123]
s_waitcnt vmcnt(28) lgkmcnt(4)
v_mfma_f32_16x16x32_bf16 v[64:67], a[136:139], a[64:67], v[64:67]
ds_read_b128 a[88:91], v131 offset:47104
v_mfma_f32_16x16x32_bf16 v[68:71], a[140:143], a[64:67], v[68:71]
v_mfma_f32_16x16x32_bf16 v[76:79], a[140:143], a[68:71], v[76:79]
ds_read_b128 a[92:95], v131 offset:48128
v_mfma_f32_16x16x32_bf16 v[72:75], a[136:139], a[68:71], v[72:75]
buffer_load_dwordx4 v136, s[8:11], s20 offen offset:3072  lds
s_waitcnt lgkmcnt(4)
v_mfma_f32_16x16x32_bf16 v[80:83], a[136:139], a[72:75], v[80:83]
ds_read_b128 a[64:67], v131 offset:49152
v_mfma_f32_16x16x32_bf16 v[84:87], a[140:143], a[72:75], v[84:87]
buffer_load_dwordx4 a[40:43], v128, s[12:15], s21 offen offset:0
v_mfma_f32_16x16x32_bf16 v[92:95], a[140:143], a[76:79], v[92:95]
ds_read_b128 a[68:71], v131 offset:50176
v_mfma_f32_16x16x32_bf16 v[88:91], a[136:139], a[76:79], v[88:91]
s_waitcnt lgkmcnt(4)
v_mfma_f32_16x16x32_bf16 v[96:99], a[136:139], a[80:83], v[96:99]
ds_read_b128 a[72:75], v131 offset:51200
v_mfma_f32_16x16x32_bf16 v[100:103], a[140:143], a[80:83], v[100:103]
s_add_u32 m0, s22, 36864
s_nop 0
buffer_load_dwordx4 v137, s[8:11], s20 offen offset:0  lds
v_mfma_f32_16x16x32_bf16 v[108:111], a[140:143], a[84:87], v[108:111]
ds_read_b128 a[76:79], v131 offset:52224
v_mfma_f32_16x16x32_bf16 v[104:107], a[136:139], a[84:87], v[104:107]
buffer_load_dwordx4 a[44:47], v128, s[12:15], s21 offen offset:1024
s_add_u32 s21, s21, 4096
s_waitcnt lgkmcnt(4)
v_mfma_f32_16x16x32_bf16 v[112:115], a[136:139], a[88:91], v[112:115]
ds_read_b128 a[80:83], v131 offset:53248
v_mfma_f32_16x16x32_bf16 v[116:119], a[140:143], a[88:91], v[116:119]
v_mfma_f32_16x16x32_bf16 v[124:127], a[140:143], a[92:95], v[124:127]
ds_read_b128 a[84:87], v131 offset:54272
v_mfma_f32_16x16x32_bf16 v[120:123], a[136:139], a[92:95], v[120:123]
buffer_load_dwordx4 v137, s[8:11], s20 offen offset:1024  lds
s_waitcnt vmcnt(13) lgkmcnt(4)
s_barrier
v_mfma_f32_16x16x32_bf16 v[64:67], a[144:147], a[64:67], v[64:67]
ds_read_b128 a[88:91], v131 offset:55296
v_mfma_f32_16x16x32_bf16 v[68:71], a[148:151], a[64:67], v[68:71]
v_mfma_f32_16x16x32_bf16 v[76:79], a[148:151], a[68:71], v[76:79]
ds_read_b128 a[92:95], v131 offset:56320
v_mfma_f32_16x16x32_bf16 v[72:75], a[144:147], a[68:71], v[72:75]
s_waitcnt lgkmcnt(4)
v_mfma_f32_16x16x32_bf16 v[80:83], a[144:147], a[72:75], v[80:83]
ds_read_b128 a[64:67], v131 offset:57344
v_mfma_f32_16x16x32_bf16 v[84:87], a[148:151], a[72:75], v[84:87]
buffer_load_dwordx4 v137, s[8:11], s20 offen offset:2048  lds
buffer_load_dwordx4 a[48:51], v128, s[12:15], s21 offen offset:0
v_mfma_f32_16x16x32_bf16 v[92:95], a[148:151], a[76:79], v[92:95]
ds_read_b128 a[68:71], v131 offset:58368
v_mfma_f32_16x16x32_bf16 v[88:91], a[144:147], a[76:79], v[88:91]
s_waitcnt lgkmcnt(4)
v_mfma_f32_16x16x32_bf16 v[96:99], a[144:147], a[80:83], v[96:99]
ds_read_b128 a[72:75], v131 offset:59392
v_mfma_f32_16x16x32_bf16 v[100:103], a[148:151], a[80:83], v[100:103]
v_mfma_f32_16x16x32_bf16 v[108:111], a[148:151], a[84:87], v[108:111]
ds_read_b128 a[76:79], v131 offset:60416
v_mfma_f32_16x16x32_bf16 v[104:107], a[144:147], a[84:87], v[104:107]
buffer_load_dwordx4 v137, s[8:11], s20 offen offset:3072  lds
s_add_u32 s20, s20, 32768
buffer_load_dwordx4 a[52:55], v128, s[12:15], s21 offen offset:1024
s_add_u32 s21, s21, 4096
s_waitcnt lgkmcnt(4)
v_mfma_f32_16x16x32_bf16 v[112:115], a[144:147], a[88:91], v[112:115]
ds_read_b128 a[80:83], v131 offset:61440
v_mfma_f32_16x16x32_bf16 v[116:119], a[148:151], a[88:91], v[116:119]
v_mfma_f32_16x16x32_bf16 v[124:127], a[148:151], a[92:95], v[124:127]
ds_read_b128 a[84:87], v131 offset:62464
v_mfma_f32_16x16x32_bf16 v[120:123], a[144:147], a[92:95], v[120:123]
s_waitcnt vmcnt(30) lgkmcnt(4)
v_mfma_f32_16x16x32_bf16 v[64:67], a[152:155], a[64:67], v[64:67]
ds_read_b128 a[88:91], v131 offset:63488
v_mfma_f32_16x16x32_bf16 v[68:71], a[156:159], a[64:67], v[68:71]
v_mfma_f32_16x16x32_bf16 v[76:79], a[156:159], a[68:71], v[76:79]
ds_read_b128 a[92:95], v131 offset:64512
v_mfma_f32_16x16x32_bf16 v[72:75], a[152:155], a[68:71], v[72:75]
s_waitcnt lgkmcnt(4)
v_mfma_f32_16x16x32_bf16 v[80:83], a[152:155], a[72:75], v[80:83]
ds_read_b128 a[64:67], v130 offset:0
v_mfma_f32_16x16x32_bf16 v[84:87], a[156:159], a[72:75], v[84:87]
buffer_load_dwordx4 a[56:59], v128, s[12:15], s21 offen offset:0
v_mfma_f32_16x16x32_bf16 v[92:95], a[156:159], a[76:79], v[92:95]
ds_read_b128 a[68:71], v130 offset:1024
v_mfma_f32_16x16x32_bf16 v[88:91], a[152:155], a[76:79], v[88:91]
s_waitcnt lgkmcnt(4)
v_mfma_f32_16x16x32_bf16 v[96:99], a[152:155], a[80:83], v[96:99]
ds_read_b128 a[72:75], v130 offset:2048
v_mfma_f32_16x16x32_bf16 v[100:103], a[156:159], a[80:83], v[100:103]
v_mfma_f32_16x16x32_bf16 v[108:111], a[156:159], a[84:87], v[108:111]
ds_read_b128 a[76:79], v130 offset:3072
v_mfma_f32_16x16x32_bf16 v[104:107], a[152:155], a[84:87], v[104:107]
buffer_load_dwordx4 a[60:63], v128, s[12:15], s21 offen offset:1024
s_add_u32 s21, s21, 4096
s_waitcnt lgkmcnt(4)
v_mfma_f32_16x16x32_bf16 v[112:115], a[152:155], a[88:91], v[112:115]
ds_read_b128 a[80:83], v130 offset:4096
v_mfma_f32_16x16x32_bf16 v[116:119], a[156:159], a[88:91], v[116:119]
v_mfma_f32_16x16x32_bf16 v[124:127], a[156:159], a[92:95], v[124:127]
ds_read_b128 a[84:87], v130 offset:5120
v_mfma_f32_16x16x32_bf16 v[120:123], a[152:155], a[92:95], v[120:123]
s_sub_u32 s35, s35, 1
s_cmp_lg_u32 s35, 0
s_cbranch_scc1 interleave_layers__ssm_conv_h3__geglu_ffn__prompt_kernel_g2loop
s_waitcnt vmcnt(28) lgkmcnt(4)
v_mfma_f32_16x16x32_bf16 v[64:67], a[0:3], a[64:67], v[64:67]
ds_read_b128 a[88:91], v130 offset:6144
v_mfma_f32_16x16x32_bf16 v[68:71], a[4:7], a[64:67], v[68:71]
v_mfma_f32_16x16x32_bf16 v[76:79], a[4:7], a[68:71], v[76:79]
ds_read_b128 a[92:95], v130 offset:7168
v_mfma_f32_16x16x32_bf16 v[72:75], a[0:3], a[68:71], v[72:75]
s_waitcnt lgkmcnt(4)
v_mfma_f32_16x16x32_bf16 v[80:83], a[0:3], a[72:75], v[80:83]
ds_read_b128 a[64:67], v130 offset:8192
v_mfma_f32_16x16x32_bf16 v[84:87], a[4:7], a[72:75], v[84:87]
v_mfma_f32_16x16x32_bf16 v[92:95], a[4:7], a[76:79], v[92:95]
ds_read_b128 a[68:71], v130 offset:9216
v_mfma_f32_16x16x32_bf16 v[88:91], a[0:3], a[76:79], v[88:91]
s_waitcnt lgkmcnt(4)
v_mfma_f32_16x16x32_bf16 v[96:99], a[0:3], a[80:83], v[96:99]
ds_read_b128 a[72:75], v130 offset:10240
v_mfma_f32_16x16x32_bf16 v[100:103], a[4:7], a[80:83], v[100:103]
v_mfma_f32_16x16x32_bf16 v[108:111], a[4:7], a[84:87], v[108:111]
ds_read_b128 a[76:79], v130 offset:11264
v_mfma_f32_16x16x32_bf16 v[104:107], a[0:3], a[84:87], v[104:107]
s_waitcnt lgkmcnt(4)
v_mfma_f32_16x16x32_bf16 v[112:115], a[0:3], a[88:91], v[112:115]
ds_read_b128 a[80:83], v130 offset:12288
v_mfma_f32_16x16x32_bf16 v[116:119], a[4:7], a[88:91], v[116:119]
v_mfma_f32_16x16x32_bf16 v[124:127], a[4:7], a[92:95], v[124:127]
ds_read_b128 a[84:87], v130 offset:13312
v_mfma_f32_16x16x32_bf16 v[120:123], a[0:3], a[92:95], v[120:123]
s_waitcnt vmcnt(23) lgkmcnt(4)
v_mfma_f32_16x16x32_bf16 v[64:67], a[8:11], a[64:67], v[64:67]
ds_read_b128 a[88:91], v130 offset:14336
v_mfma_f32_16x16x32_bf16 v[68:71], a[12:15], a[64:67], v[68:71]
v_mfma_f32_16x16x32_bf16 v[76:79], a[12:15], a[68:71], v[76:79]
ds_read_b128 a[92:95], v130 offset:15360
v_mfma_f32_16x16x32_bf16 v[72:75], a[8:11], a[68:71], v[72:75]
s_waitcnt lgkmcnt(4)
v_mfma_f32_16x16x32_bf16 v[80:83], a[8:11], a[72:75], v[80:83]
ds_read_b128 a[64:67], v130 offset:16384
v_mfma_f32_16x16x32_bf16 v[84:87], a[12:15], a[72:75], v[84:87]
v_mfma_f32_16x16x32_bf16 v[92:95], a[12:15], a[76:79], v[92:95]
ds_read_b128 a[68:71], v130 offset:17408
v_mfma_f32_16x16x32_bf16 v[88:91], a[8:11], a[76:79], v[88:91]
s_waitcnt lgkmcnt(4)
v_mfma_f32_16x16x32_bf16 v[96:99], a[8:11], a[80:83], v[96:99]
ds_read_b128 a[72:75], v130 offset:18432
v_mfma_f32_16x16x32_bf16 v[100:103], a[12:15], a[80:83], v[100:103]
buffer_load_dwordx4 v[140:143], v133, s[56:59], s36 offen offset:0
v_mfma_f32_16x16x32_bf16 v[108:111], a[12:15], a[84:87], v[108:111]
ds_read_b128 a[76:79], v130 offset:19456
v_mfma_f32_16x16x32_bf16 v[104:107], a[8:11], a[84:87], v[104:107]
s_waitcnt lgkmcnt(4)
v_mfma_f32_16x16x32_bf16 v[112:115], a[8:11], a[88:91], v[112:115]
ds_read_b128 a[80:83], v130 offset:24576
v_mfma_f32_16x16x32_bf16 v[116:119], a[12:15], a[88:91], v[116:119]
buffer_load_dwordx4 v[144:147], v133, s[56:59], s36 offen offset:1024
v_mfma_f32_16x16x32_bf16 v[124:127], a[12:15], a[92:95], v[124:127]
ds_read_b128 a[84:87], v130 offset:25600
v_mfma_f32_16x16x32_bf16 v[120:123], a[8:11], a[92:95], v[120:123]
s_waitcnt vmcnt(5) lgkmcnt(4)
s_barrier
v_mfma_f32_16x16x32_bf16 v[64:67], a[16:19], a[64:67], v[64:67]
ds_read_b128 a[88:91], v130 offset:26624
v_mfma_f32_16x16x32_bf16 v[68:71], a[20:23], a[64:67], v[68:71]
buffer_load_dwordx4 v[148:151], v133, s[56:59], s36 offen offset:2048
v_mfma_f32_16x16x32_bf16 v[76:79], a[20:23], a[68:71], v[76:79]
ds_read_b128 a[92:95], v130 offset:27648
v_mfma_f32_16x16x32_bf16 v[72:75], a[16:19], a[68:71], v[72:75]
s_waitcnt lgkmcnt(4)
v_mfma_f32_16x16x32_bf16 v[80:83], a[16:19], a[72:75], v[80:83]
ds_read_b128 a[64:67], v130 offset:32768
v_mfma_f32_16x16x32_bf16 v[84:87], a[20:23], a[72:75], v[84:87]
buffer_load_dwordx4 v[152:155], v133, s[56:59], s36 offen offset:3072
v_mfma_f32_16x16x32_bf16 v[92:95], a[20:23], a[76:79], v[92:95]
ds_read_b128 a[68:71], v130 offset:40960
v_mfma_f32_16x16x32_bf16 v[88:91], a[16:19], a[76:79], v[88:91]
s_waitcnt vmcnt(20) lgkmcnt(4)
v_mfma_f32_16x16x32_bf16 v[64:67], a[24:27], a[80:83], v[64:67]
ds_read_b128 a[72:75], v130 offset:49152
v_mfma_f32_16x16x32_bf16 v[68:71], a[28:31], a[80:83], v[68:71]
v_mfma_f32_16x16x32_bf16 v[76:79], a[28:31], a[84:87], v[76:79]
ds_read_b128 a[76:79], v130 offset:57344
v_mfma_f32_16x16x32_bf16 v[72:75], a[24:27], a[84:87], v[72:75]
s_waitcnt lgkmcnt(4)
v_mfma_f32_16x16x32_bf16 v[80:83], a[24:27], a[88:91], v[80:83]
ds_read_b128 a[80:83], v130 offset:33792
v_mfma_f32_16x16x32_bf16 v[84:87], a[28:31], a[88:91], v[84:87]
v_mfma_f32_16x16x32_bf16 v[92:95], a[28:31], a[92:95], v[92:95]
ds_read_b128 a[84:87], v130 offset:41984
v_mfma_f32_16x16x32_bf16 v[88:91], a[24:27], a[92:95], v[88:91]
s_waitcnt vmcnt(4) lgkmcnt(4)
v_mfma_f32_16x16x32_bf16 v[64:67], a[32:35], a[64:67], v[64:67]
ds_read_b128 a[88:91], v130 offset:50176
v_mfma_f32_16x16x32_bf16 v[68:71], a[36:39], a[64:67], v[68:71]
v_mfma_f32_16x16x32_bf16 v[68:71], a[44:47], a[68:71], v[68:71]
ds_read_b128 a[92:95], v130 offset:58368
v_mfma_f32_16x16x32_bf16 v[64:67], a[40:43], a[68:71], v[64:67]
s_waitcnt lgkmcnt(4)
v_mfma_f32_16x16x32_bf16 v[64:67], a[48:51], a[72:75], v[64:67]
ds_read_b128 a[64:67], v130 offset:34816
v_mfma_f32_16x16x32_bf16 v[68:71], a[52:55], a[72:75], v[68:71]
v_mfma_f32_16x16x32_bf16 v[68:71], a[60:63], a[76:79], v[68:71]
ds_read_b128 a[68:71], v130 offset:43008
v_mfma_f32_16x16x32_bf16 v[64:67], a[56:59], a[76:79], v[64:67]
s_waitcnt lgkmcnt(4)
v_mfma_f32_16x16x32_bf16 v[72:75], a[32:35], a[80:83], v[72:75]
ds_read_b128 a[72:75], v130 offset:51200
v_mfma_f32_16x16x32_bf16 v[76:79], a[36:39], a[80:83], v[76:79]
v_mfma_f32_16x16x32_bf16 v[76:79], a[44:47], a[84:87], v[76:79]
ds_read_b128 a[76:79], v130 offset:59392
v_mfma_f32_16x16x32_bf16 v[72:75], a[40:43], a[84:87], v[72:75]
s_waitcnt lgkmcnt(4)
v_mfma_f32_16x16x32_bf16 v[72:75], a[48:51], a[88:91], v[72:75]
ds_read_b128 a[80:83], v130 offset:35840
v_cvt_pk_bf16_f32 v32, v64, v65
v_mfma_f32_16x16x32_bf16 v[76:79], a[52:55], a[88:91], v[76:79]
v_cvt_pk_bf16_f32 v33, v66, v67
v_mfma_f32_16x16x32_bf16 v[76:79], a[60:63], a[92:95], v[76:79]
ds_read_b128 a[84:87], v130 offset:44032
v_cvt_pk_bf16_f32 v34, v68, v69
v_mfma_f32_16x16x32_bf16 v[72:75], a[56:59], a[92:95], v[72:75]
v_cvt_pk_bf16_f32 v35, v70, v71
s_waitcnt lgkmcnt(4)
v_mfma_f32_16x16x32_bf16 v[80:83], a[32:35], a[64:67], v[80:83]
ds_read_b128 a[88:91], v130 offset:52224
v_mfma_f32_16x16x32_bf16 v[84:87], a[36:39], a[64:67], v[84:87]
v_permlane16_swap_b32 v32, v34
v_mfma_f32_16x16x32_bf16 v[84:87], a[44:47], a[68:71], v[84:87]
ds_read_b128 a[92:95], v130 offset:60416
v_permlane16_swap_b32 v33, v35
v_mfma_f32_16x16x32_bf16 v[80:83], a[40:43], a[68:71], v[80:83]
buffer_store_dwordx4 v[32:35], v132, s[16:19], s36 offen offset:0 sc1
s_waitcnt lgkmcnt(4)
v_mfma_f32_16x16x32_bf16 v[80:83], a[48:51], a[72:75], v[80:83]
ds_read_b128 a[64:67], v130 offset:20480
v_cvt_pk_bf16_f32 v36, v72, v73
v_mfma_f32_16x16x32_bf16 v[84:87], a[52:55], a[72:75], v[84:87]
v_cvt_pk_bf16_f32 v37, v74, v75
v_mfma_f32_16x16x32_bf16 v[84:87], a[60:63], a[76:79], v[84:87]
ds_read_b128 a[68:71], v130 offset:28672
v_cvt_pk_bf16_f32 v38, v76, v77
v_mfma_f32_16x16x32_bf16 v[80:83], a[56:59], a[76:79], v[80:83]
v_cvt_pk_bf16_f32 v39, v78, v79
s_waitcnt lgkmcnt(4)
v_mfma_f32_16x16x32_bf16 v[88:91], a[32:35], a[80:83], v[88:91]
ds_read_b128 a[72:75], v130 offset:36864
v_mfma_f32_16x16x32_bf16 v[92:95], a[36:39], a[80:83], v[92:95]
v_permlane16_swap_b32 v36, v38
v_mfma_f32_16x16x32_bf16 v[92:95], a[44:47], a[84:87], v[92:95]
ds_read_b128 a[76:79], v130 offset:45056
v_permlane16_swap_b32 v37, v39
v_mfma_f32_16x16x32_bf16 v[88:91], a[40:43], a[84:87], v[88:91]
buffer_store_dwordx4 v[36:39], v132, s[16:19], s36 offen offset:1024 sc1
s_waitcnt lgkmcnt(4)
v_mfma_f32_16x16x32_bf16 v[88:91], a[48:51], a[88:91], v[88:91]
ds_read_b128 a[80:83], v130 offset:53248
v_cvt_pk_bf16_f32 v40, v80, v81
v_mfma_f32_16x16x32_bf16 v[92:95], a[52:55], a[88:91], v[92:95]
v_cvt_pk_bf16_f32 v41, v82, v83
v_mfma_f32_16x16x32_bf16 v[92:95], a[60:63], a[92:95], v[92:95]
ds_read_b128 a[84:87], v130 offset:61440
v_cvt_pk_bf16_f32 v42, v84, v85
v_mfma_f32_16x16x32_bf16 v[88:91], a[56:59], a[92:95], v[88:91]
v_cvt_pk_bf16_f32 v43, v86, v87
s_waitcnt lgkmcnt(4)
v_mfma_f32_16x16x32_bf16 v[96:99], a[16:19], a[64:67], v[96:99]
ds_read_b128 a[88:91], v130 offset:21504
v_mfma_f32_16x16x32_bf16 v[100:103], a[20:23], a[64:67], v[100:103]
v_permlane16_swap_b32 v40, v42
v_mfma_f32_16x16x32_bf16 v[100:103], a[28:31], a[68:71], v[100:103]
ds_read_b128 a[92:95], v130 offset:29696
v_permlane16_swap_b32 v41, v43
v_mfma_f32_16x16x32_bf16 v[96:99], a[24:27], a[68:71], v[96:99]
buffer_store_dwordx4 v[40:43], v132, s[16:19], s36 offen offset:2048 sc1
s_waitcnt lgkmcnt(4)
v_mfma_f32_16x16x32_bf16 v[96:99], a[32:35], a[72:75], v[96:99]
ds_read_b128 a[64:67], v130 offset:37888
v_cvt_pk_bf16_f32 v44, v88, v89
v_mfma_f32_16x16x32_bf16 v[100:103], a[36:39], a[72:75], v[100:103]
v_cvt_pk_bf16_f32 v45, v90, v91
v_mfma_f32_16x16x32_bf16 v[100:103], a[44:47], a[76:79], v[100:103]
ds_read_b128 a[68:71], v130 offset:46080
v_cvt_pk_bf16_f32 v46, v92, v93
v_mfma_f32_16x16x32_bf16 v[96:99], a[40:43], a[76:79], v[96:99]
v_cvt_pk_bf16_f32 v47, v94, v95
s_waitcnt lgkmcnt(4)
v_mfma_f32_16x16x32_bf16 v[96:99], a[48:51], a[80:83], v[96:99]
ds_read_b128 a[72:75], v130 offset:54272
v_mfma_f32_16x16x32_bf16 v[100:103], a[52:55], a[80:83], v[100:103]
v_permlane16_swap_b32 v44, v46
v_mfma_f32_16x16x32_bf16 v[100:103], a[60:63], a[84:87], v[100:103]
ds_read_b128 a[76:79], v130 offset:62464
v_permlane16_swap_b32 v45, v47
v_mfma_f32_16x16x32_bf16 v[96:99], a[56:59], a[84:87], v[96:99]
buffer_store_dwordx4 v[44:47], v132, s[16:19], s36 offen offset:3072 sc1
s_waitcnt lgkmcnt(4)
v_mfma_f32_16x16x32_bf16 v[104:107], a[16:19], a[88:91], v[104:107]
ds_read_b128 a[80:83], v130 offset:22528
v_mfma_f32_16x16x32_bf16 v[108:111], a[20:23], a[88:91], v[108:111]
v_mfma_f32_16x16x32_bf16 v[108:111], a[28:31], a[92:95], v[108:111]
ds_read_b128 a[84:87], v130 offset:30720
v_mfma_f32_16x16x32_bf16 v[104:107], a[24:27], a[92:95], v[104:107]
s_waitcnt lgkmcnt(4)
v_mfma_f32_16x16x32_bf16 v[104:107], a[32:35], a[64:67], v[104:107]
ds_read_b128 a[88:91], v130 offset:38912
v_cvt_pk_bf16_f32 v48, v96, v97
v_mfma_f32_16x16x32_bf16 v[108:111], a[36:39], a[64:67], v[108:111]
v_cvt_pk_bf16_f32 v49, v98, v99
v_mfma_f32_16x16x32_bf16 v[108:111], a[44:47], a[68:71], v[108:111]
ds_read_b128 a[92:95], v130 offset:47104
v_cvt_pk_bf16_f32 v50, v100, v101
v_mfma_f32_16x16x32_bf16 v[104:107], a[40:43], a[68:71], v[104:107]
v_cvt_pk_bf16_f32 v51, v102, v103
s_waitcnt lgkmcnt(4)
v_mfma_f32_16x16x32_bf16 v[104:107], a[48:51], a[72:75], v[104:107]
ds_read_b128 a[64:67], v130 offset:55296
v_mfma_f32_16x16x32_bf16 v[108:111], a[52:55], a[72:75], v[108:111]
v_permlane16_swap_b32 v48, v50
v_mfma_f32_16x16x32_bf16 v[108:111], a[60:63], a[76:79], v[108:111]
ds_read_b128 a[68:71], v130 offset:63488
v_permlane16_swap_b32 v49, v51
v_mfma_f32_16x16x32_bf16 v[104:107], a[56:59], a[76:79], v[104:107]
buffer_store_dwordx4 v[48:51], v133, s[40:43], s36 offen offset:0 sc1
s_waitcnt lgkmcnt(4)
v_mfma_f32_16x16x32_bf16 v[112:115], a[16:19], a[80:83], v[112:115]
ds_read_b128 a[72:75], v130 offset:23552
v_mfma_f32_16x16x32_bf16 v[116:119], a[20:23], a[80:83], v[116:119]
v_mfma_f32_16x16x32_bf16 v[116:119], a[28:31], a[84:87], v[116:119]
ds_read_b128 a[76:79], v130 offset:31744
v_mfma_f32_16x16x32_bf16 v[112:115], a[24:27], a[84:87], v[112:115]
s_waitcnt lgkmcnt(4)
v_mfma_f32_16x16x32_bf16 v[112:115], a[32:35], a[88:91], v[112:115]
ds_read_b128 a[80:83], v130 offset:39936
v_cvt_pk_bf16_f32 v52, v104, v105
v_mfma_f32_16x16x32_bf16 v[116:119], a[36:39], a[88:91], v[116:119]
v_cvt_pk_bf16_f32 v53, v106, v107
v_mfma_f32_16x16x32_bf16 v[116:119], a[44:47], a[92:95], v[116:119]
ds_read_b128 a[84:87], v130 offset:48128
v_cvt_pk_bf16_f32 v54, v108, v109
v_mfma_f32_16x16x32_bf16 v[112:115], a[40:43], a[92:95], v[112:115]
v_cvt_pk_bf16_f32 v55, v110, v111
s_waitcnt lgkmcnt(4)
v_mfma_f32_16x16x32_bf16 v[112:115], a[48:51], a[64:67], v[112:115]
ds_read_b128 a[88:91], v130 offset:56320
v_mfma_f32_16x16x32_bf16 v[116:119], a[52:55], a[64:67], v[116:119]
v_permlane16_swap_b32 v52, v54
v_mfma_f32_16x16x32_bf16 v[116:119], a[60:63], a[68:71], v[116:119]
ds_read_b128 a[92:95], v130 offset:64512
v_permlane16_swap_b32 v53, v55
v_mfma_f32_16x16x32_bf16 v[112:115], a[56:59], a[68:71], v[112:115]
buffer_store_dwordx4 v[52:55], v133, s[40:43], s36 offen offset:1024 sc1
s_waitcnt lgkmcnt(4)
v_mfma_f32_16x16x32_bf16 v[120:123], a[16:19], a[72:75], v[120:123]
v_mfma_f32_16x16x32_bf16 v[124:127], a[20:23], a[72:75], v[124:127]
v_mfma_f32_16x16x32_bf16 v[124:127], a[28:31], a[76:79], v[124:127]
v_mfma_f32_16x16x32_bf16 v[120:123], a[24:27], a[76:79], v[120:123]
s_waitcnt lgkmcnt(2)
v_mfma_f32_16x16x32_bf16 v[120:123], a[32:35], a[80:83], v[120:123]
v_cvt_pk_bf16_f32 v56, v112, v113
v_mfma_f32_16x16x32_bf16 v[124:127], a[36:39], a[80:83], v[124:127]
v_cvt_pk_bf16_f32 v57, v114, v115
v_mfma_f32_16x16x32_bf16 v[124:127], a[44:47], a[84:87], v[124:127]
v_cvt_pk_bf16_f32 v58, v116, v117
v_mfma_f32_16x16x32_bf16 v[120:123], a[40:43], a[84:87], v[120:123]
v_cvt_pk_bf16_f32 v59, v118, v119
s_waitcnt lgkmcnt(0)
v_mfma_f32_16x16x32_bf16 v[120:123], a[48:51], a[88:91], v[120:123]
v_mfma_f32_16x16x32_bf16 v[124:127], a[52:55], a[88:91], v[124:127]
v_permlane16_swap_b32 v56, v58
v_mfma_f32_16x16x32_bf16 v[124:127], a[60:63], a[92:95], v[124:127]
v_permlane16_swap_b32 v57, v59
v_mfma_f32_16x16x32_bf16 v[120:123], a[56:59], a[92:95], v[120:123]
buffer_store_dwordx4 v[56:59], v133, s[40:43], s36 offen offset:2048 sc1
s_cmp_eq_u32 s60, 0
s_cbranch_scc1 interleave_layers__ssm_conv_h3__geglu_ffn__prompt_kernel_fin
s_nop 7
v_cvt_pk_bf16_f32 v60, v120, v121
v_cvt_pk_bf16_f32 v61, v122, v123
v_cvt_pk_bf16_f32 v62, v124, v125
v_cvt_pk_bf16_f32 v63, v126, v127
s_nop 1
v_permlane16_swap_b32 v60, v62
v_permlane16_swap_b32 v61, v63
buffer_store_dwordx4 v[60:63], v133, s[40:43], s36 offen offset:3072 sc1
s_waitcnt lgkmcnt(0)
v_and_b32 v26, 1, v31
v_lshlrev_b32 v26, 3, v26
v_lshrrev_b32 v27, 1, v31
v_lshl_add_u32 v26, v27, 0, v26
v_mul_u32_u24 v26, 10368, v26
v_mov_b32 v27, 1
s_waitcnt vmcnt(0)
s_barrier
s_cmp_lg_u32 s26, 0
s_cbranch_scc1 sig8
s_mov_b64 exec, 0xffff
buffer_store_byte v27, v26, s[88:91], s49 offen sc1
s_mov_b64 exec, -1
sig8:
s_mov_b32 s60, 0
s_mov_b32 s84, 32
s_mov_b32 s85, 2560
s_add_u32 s86, s86, 50331648
s_addc_u32 s87, s87, 0
s_branch interleave_layers__ssm_conv_h3__geglu_ffn__prompt_kernel_layer
interleave_layers__ssm_conv_h3__geglu_ffn__prompt_kernel_fin:
s_xor_b32 s29, s2, 1
s_mul_i32 s29, s29, 10368
s_add_u32 s29, s29, 155136
v_mov_b32 v26, 0
v_mov_b32 v27, 1
s_waitcnt vmcnt(3)
s_barrier
s_cmp_lg_u32 s26, 0
s_cbranch_scc1 sig9
s_mov_b64 exec, 0x1
buffer_store_byte v27, v26, s[88:91], s29 offen sc1
s_mov_b64 exec, -1
sig9:
s_sub_u32 s29, 1, s33
s_mul_i32 s29, s29, 6291456
s_add_u32 s29, s29, 20971520
s_add_u32 s8, s86, s29
s_addc_u32 s9, s87, 0
s_mov_b32 s10, 4194304
s_mov_b32 s11, 0x20000
s_mov_b32 s16, s82
s_mov_b32 s17, s83
s_mov_b32 s18, 4194304
s_mov_b32 s19, 0x20000
s_lshl_b32 s29, s27, 1
s_add_u32 s29, s29, s33
s_lshl_b32 s29, s29, 17
s_lshl_b32 s30, s28, 8
s_add_u32 s29, s29, s30
s_lshl_b32 s30, s26, 6
s_add_u32 s29, s29, s30
v_lshlrev_b32 v176, 16, v140
v_and_b32 v177, 0xffff0000, v140
v_lshlrev_b32 v178, 16, v141
v_and_b32 v179, 0xffff0000, v141
v_lshlrev_b32 v180, 16, v142
v_and_b32 v181, 0xffff0000, v142
v_lshlrev_b32 v182, 16, v143
v_and_b32 v183, 0xffff0000, v143
v_permlane16_swap_b32 v96, v100
v_permlane16_swap_b32 v97, v101
v_permlane16_swap_b32 v98, v102
v_permlane16_swap_b32 v99, v103
v_pk_add_f32 v[96:97], v[96:97], v[176:177]
v_pk_add_f32 v[98:99], v[98:99], v[178:179]
v_pk_add_f32 v[100:101], v[100:101], v[180:181]
v_pk_add_f32 v[102:103], v[102:103], v[182:183]
v_lshlrev_b32 v176, 16, v144
v_and_b32 v177, 0xffff0000, v144
v_lshlrev_b32 v178, 16, v145
v_and_b32 v179, 0xffff0000, v145
v_lshlrev_b32 v180, 16, v146
v_and_b32 v181, 0xffff0000, v146
v_lshlrev_b32 v182, 16, v147
v_and_b32 v183, 0xffff0000, v147
v_permlane16_swap_b32 v104, v108
v_permlane16_swap_b32 v105, v109
v_permlane16_swap_b32 v106, v110
v_permlane16_swap_b32 v107, v111
v_pk_add_f32 v[104:105], v[104:105], v[176:177]
v_pk_add_f32 v[106:107], v[106:107], v[178:179]
v_pk_add_f32 v[108:109], v[108:109], v[180:181]
v_pk_add_f32 v[110:111], v[110:111], v[182:183]
s_load_dword s92, s[74:75], 7680 glc
v_lshlrev_b32 v176, 16, v148
v_and_b32 v177, 0xffff0000, v148
v_lshlrev_b32 v178, 16, v149
v_and_b32 v179, 0xffff0000, v149
v_lshlrev_b32 v180, 16, v150
v_and_b32 v181, 0xffff0000, v150
v_lshlrev_b32 v182, 16, v151
v_and_b32 v183, 0xffff0000, v151
v_permlane16_swap_b32 v112, v116
v_permlane16_swap_b32 v113, v117
v_permlane16_swap_b32 v114, v118
v_permlane16_swap_b32 v115, v119
v_pk_add_f32 v[112:113], v[112:113], v[176:177]
v_pk_add_f32 v[114:115], v[114:115], v[178:179]
v_pk_add_f32 v[116:117], v[116:117], v[180:181]
v_pk_add_f32 v[118:119], v[118:119], v[182:183]
v_lshlrev_b32 v176, 16, v152
v_and_b32 v177, 0xffff0000, v152
v_lshlrev_b32 v178, 16, v153
v_and_b32 v179, 0xffff0000, v153
v_lshlrev_b32 v180, 16, v154
v_and_b32 v181, 0xffff0000, v154
v_lshlrev_b32 v182, 16, v155
v_and_b32 v183, 0xffff0000, v155
v_permlane16_swap_b32 v120, v124
v_permlane16_swap_b32 v121, v125
v_permlane16_swap_b32 v122, v126
v_permlane16_swap_b32 v123, v127
v_pk_add_f32 v[120:121], v[120:121], v[176:177]
v_pk_add_f32 v[122:123], v[122:123], v[178:179]
v_pk_add_f32 v[124:125], v[124:125], v[180:181]
v_pk_add_f32 v[126:127], v[126:127], v[182:183]
s_mov_b32 s100, 0x200000
interleave_layers__ssm_conv_h3__geglu_ffn__prompt_kernel_pl:
s_waitcnt lgkmcnt(0)
s_cmp_eq_u32 s92, 1
s_cbranch_scc1 interleave_layers__ssm_conv_h3__geglu_ffn__prompt_kernel_pw
s_load_dword s92, s[74:75], 7680 glc
s_sub_u32 s100, s100, 1
s_cmp_lg_u32 s100, 0
s_cbranch_scc1 interleave_layers__ssm_conv_h3__geglu_ffn__prompt_kernel_pl
interleave_layers__ssm_conv_h3__geglu_ffn__prompt_kernel_pw:
buffer_load_dwordx4 v[160:163], v133, s[8:11], s36 offen offset:0
buffer_load_dwordx4 v[164:167], v133, s[8:11], s36 offen offset:1024
buffer_load_dwordx4 v[168:171], v133, s[8:11], s36 offen offset:2048
buffer_load_dwordx4 v[172:175], v133, s[8:11], s36 offen offset:3072
s_waitcnt vmcnt(3)
v_lshlrev_b32 v176, 16, v160
v_and_b32 v177, 0xffff0000, v160
v_lshlrev_b32 v178, 16, v161
v_and_b32 v179, 0xffff0000, v161
v_lshlrev_b32 v180, 16, v162
v_and_b32 v181, 0xffff0000, v162
v_lshlrev_b32 v182, 16, v163
v_and_b32 v183, 0xffff0000, v163
v_pk_add_f32 v[96:97], v[96:97], v[176:177]
v_pk_add_f32 v[98:99], v[98:99], v[178:179]
v_pk_add_f32 v[100:101], v[100:101], v[180:181]
v_pk_add_f32 v[102:103], v[102:103], v[182:183]
v_cvt_pk_bf16_f32 v160, v96, v97
v_cvt_pk_bf16_f32 v161, v98, v99
v_cvt_pk_bf16_f32 v162, v100, v101
v_cvt_pk_bf16_f32 v163, v102, v103
buffer_store_dwordx4 v[160:163], v138, s[16:19], s29 offen
s_add_u32 s29, s29, 32768
s_waitcnt vmcnt(3)
v_lshlrev_b32 v176, 16, v164
v_and_b32 v177, 0xffff0000, v164
v_lshlrev_b32 v178, 16, v165
v_and_b32 v179, 0xffff0000, v165
v_lshlrev_b32 v180, 16, v166
v_and_b32 v181, 0xffff0000, v166
v_lshlrev_b32 v182, 16, v167
v_and_b32 v183, 0xffff0000, v167
v_pk_add_f32 v[104:105], v[104:105], v[176:177]
v_pk_add_f32 v[106:107], v[106:107], v[178:179]
v_pk_add_f32 v[108:109], v[108:109], v[180:181]
v_pk_add_f32 v[110:111], v[110:111], v[182:183]
v_cvt_pk_bf16_f32 v164, v104, v105
v_cvt_pk_bf16_f32 v165, v106, v107
v_cvt_pk_bf16_f32 v166, v108, v109
v_cvt_pk_bf16_f32 v167, v110, v111
buffer_store_dwordx4 v[164:167], v138, s[16:19], s29 offen
s_add_u32 s29, s29, 32768
s_waitcnt vmcnt(3)
v_lshlrev_b32 v176, 16, v168
v_and_b32 v177, 0xffff0000, v168
v_lshlrev_b32 v178, 16, v169
v_and_b32 v179, 0xffff0000, v169
v_lshlrev_b32 v180, 16, v170
v_and_b32 v181, 0xffff0000, v170
v_lshlrev_b32 v182, 16, v171
v_and_b32 v183, 0xffff0000, v171
v_pk_add_f32 v[112:113], v[112:113], v[176:177]
v_pk_add_f32 v[114:115], v[114:115], v[178:179]
v_pk_add_f32 v[116:117], v[116:117], v[180:181]
v_pk_add_f32 v[118:119], v[118:119], v[182:183]
v_cvt_pk_bf16_f32 v168, v112, v113
v_cvt_pk_bf16_f32 v169, v114, v115
v_cvt_pk_bf16_f32 v170, v116, v117
v_cvt_pk_bf16_f32 v171, v118, v119
buffer_store_dwordx4 v[168:171], v138, s[16:19], s29 offen
s_add_u32 s29, s29, 32768
s_waitcnt vmcnt(3)
v_lshlrev_b32 v176, 16, v172
v_and_b32 v177, 0xffff0000, v172
v_lshlrev_b32 v178, 16, v173
v_and_b32 v179, 0xffff0000, v173
v_lshlrev_b32 v180, 16, v174
v_and_b32 v181, 0xffff0000, v174
v_lshlrev_b32 v182, 16, v175
v_and_b32 v183, 0xffff0000, v175
v_pk_add_f32 v[120:121], v[120:121], v[176:177]
v_pk_add_f32 v[122:123], v[122:123], v[178:179]
v_pk_add_f32 v[124:125], v[124:125], v[180:181]
v_pk_add_f32 v[126:127], v[126:127], v[182:183]
v_cvt_pk_bf16_f32 v172, v120, v121
v_cvt_pk_bf16_f32 v173, v122, v123
v_cvt_pk_bf16_f32 v174, v124, v125
v_cvt_pk_bf16_f32 v175, v126, v127
buffer_store_dwordx4 v[172:175], v138, s[16:19], s29 offen
interleave_layers__ssm_conv_h3__geglu_ffn__prompt_kernel_end:
s_endpgm
interleave_layers__ssm_conv_h3__geglu_ffn__prompt_kernel_stats:
s_nop 2
v_pk_add_f32 v[160:161], v[160:161], v[162:163]
s_nop 1
v_add_f32_dpp v160, v160, v160 row_ror:8 row_mask:0xf bank_mask:0xf
v_add_f32_dpp v161, v161, v161 row_ror:8 row_mask:0xf bank_mask:0xf
v_mov_b32 v162, v160
v_mov_b32 v163, v161
s_nop 1
v_permlane16_swap_b32 v160, v162
v_permlane16_swap_b32 v161, v163
s_nop 0
v_pk_add_f32 v[160:161], v[160:161], v[162:163]
v_mov_b32 v162, v160
v_mov_b32 v163, v161
s_nop 1
v_permlane32_swap_b32 v160, v162
v_permlane32_swap_b32 v161, v163
s_nop 0
v_pk_add_f32 v[160:161], v[160:161], v[162:163]
ds_write_b64 v14, v[160:161]
s_waitcnt lgkmcnt(0)
s_barrier
ds_read_b128 v[96:99], v15 offset:0
ds_read_b128 v[100:103], v15 offset:16
s_waitcnt lgkmcnt(0)
v_pk_add_f32 v[96:97], v[96:97], v[98:99]
v_pk_add_f32 v[100:101], v[100:101], v[102:103]
v_pk_add_f32 v[160:161], v[96:97], v[100:101]
v_mul_f32 v160, s48, v160
v_mul_f32 v161, s48, v161
v_fma_f32 v161, -v160, v160, v161
v_max_f32 v161, 0, v161
v_cvt_pk_bf16_f32 v160, v160, v160
v_and_b32 v160, 0xffff0000, v160
v_cvt_pk_bf16_f32 v161, v161, v161
v_and_b32 v161, 0xffff0000, v161
v_add_f32 v161, s39, v161
v_cvt_pk_bf16_f32 v161, v161, v161
v_and_b32 v161, 0xffff0000, v161
v_sqrt_f32 v161, v161
s_nop 0
v_cvt_pk_bf16_f32 v161, v161, v161
v_and_b32 v161, 0xffff0000, v161
v_rcp_f32 v162, v161
s_nop 0
v_mul_f32 v160, -v160, v162
s_setpc_b64 s[54:55]
interleave_layers__ssm_conv_h3__geglu_ffn__prompt_kernel_codeend:
.section .rodata,"a"
.p2align 6
.amdhsa_kernel interleave_layers__ssm_conv_h3__geglu_ffn__prompt_kernel
  .amdhsa_next_free_vgpr 512
  .amdhsa_next_free_sgpr 102
  .amdhsa_accum_offset 256
  .amdhsa_group_segment_fixed_size 0
  .amdhsa_kernarg_size 104
  .amdhsa_user_sgpr_count 2
  .amdhsa_user_sgpr_kernarg_segment_ptr 1
  .amdhsa_system_sgpr_workgroup_id_x 1
  .amdhsa_float_denorm_mode_32 3
.end_amdhsa_kernel
```
